```python
import torch

def _softmax(x, axis=-1):
    return torch.softmax(x, dim=axis)
def _gelu(x):
    return torch.nn.functional.gelu(x, approximate="tanh")
def _silu(x):
    return torch.nn.functional.silu(x)
def _sigmoid(x):
    return torch.sigmoid(x)
def _layernorm(x, axis=-1, eps=1e-5):
    m = x.mean(dim=axis, keepdim=True)
    v = x.var(dim=axis, keepdim=True, unbiased=False)
    return (x - m) / torch.sqrt(v + eps)
def _scatter_add(tgt, idx, src, axis=0):
    return tgt.clone().index_add_(axis, idx, src)
def _segment_sum(src, seg, n):
    out = torch.zeros((n,) + src.shape[1:], dtype=src.dtype)
    return out.index_add_(0, seg, src)
def _pad(x, pw):
    flat = tuple(v for pair in reversed(pw) for v in pair)
    return torch.nn.functional.pad(x, flat)

kernel_name = 'interleave_layers__grouped_kv_mqa__glu_gated_glu__prompt'

def setup_inputs():

    _w = (lambda a: (lambda t: t.to(torch.bfloat16) if t.is_floating_point() else t)(torch.as_tensor(a)))
    def _A_setup():
        B, S, D, H = 1, 2048, 448, 16
        Dh = D // H
        return {
            "x": _w((lambda *s: torch.randn(*s, dtype=torch.bfloat16) * 0.05)(B, S, D)),
            "wq": _w((lambda *s: torch.randn(*s, dtype=torch.bfloat16) * 0.05)(D, H * Dh)),
            "wk": _w((lambda *s: torch.randn(*s, dtype=torch.bfloat16) * 0.05)(D, Dh)),
            "wv": _w((lambda *s: torch.randn(*s, dtype=torch.bfloat16) * 0.05)(D, Dh)),
            "wo": _w((lambda *s: torch.randn(*s, dtype=torch.bfloat16) * 0.05)(H * Dh, D)),
        }
    _A_in = _A_setup()

    def _B_setup():
        B, S, D, F = 1, 2048, 448, 1792
        return {
            "x": _w((lambda *s: torch.randn(*s, dtype=torch.bfloat16) * 0.05)(B, S, D)),
            "w_gate": _w((lambda *s: torch.randn(*s, dtype=torch.bfloat16) * 0.05)(D, F)),
            "w_up": _w((lambda *s: torch.randn(*s, dtype=torch.bfloat16) * 0.05)(D, F)),
            "w_down": _w((lambda *s: torch.randn(*s, dtype=torch.bfloat16) * 0.05)(F, D)),
        }
    _B_in = _B_setup()

    return {
        "A_x": _A_in["x"],
        "A_wq": _A_in["wq"],
        "A_wk": _A_in["wk"],
        "A_wv": _A_in["wv"],
        "A_wo": _A_in["wo"],
        "B_x": _B_in["x"],
        "B_w_gate": _B_in["w_gate"],
        "B_w_up": _B_in["w_up"],
        "B_w_down": _B_in["w_down"],
    }

def reference(A_x, A_wq, A_wk, A_wv, A_wo, B_x, B_w_gate, B_w_up, B_w_down):
    def _A_ref(x, wq, wk, wv, wo):
        B, S, D = x.shape
        H = 16
        Dh = D // H
        q = (lambda x, *d: x.permute(*d))((x @ wq).reshape(B, S, H, Dh), 0, 2, 1, 3)
        k = x @ wk
        v = x @ wv
        scores = torch.einsum("bhqd,bkd->bhqk", q, k) * (Dh ** -0.5)
        p = _softmax(scores, axis=-1)
        o = torch.einsum("bhqk,bkd->bhqd", p, v)
        return (lambda x, *d: x.permute(*d))(o, 0, 2, 1, 3).reshape(B, S, H * Dh) @ wo

    def _B_ref(x, w_gate, w_up, w_down):
        g = torch.einsum("bsd,df->bsf", x, w_gate)
        u = torch.einsum("bsd,df->bsf", x, w_up)
        h = _sigmoid(g) * u
        return torch.einsum("bsf,fd->bsd", h, w_down)

    x = A_x
    x = x + _A_ref(_layernorm(x, axis=-1), A_wq, A_wk, A_wv, A_wo)
    x = x + _B_ref(_layernorm(x, axis=-1), B_w_gate, B_w_up, B_w_down)
    x = x + _A_ref(_layernorm(x, axis=-1), A_wq, A_wk, A_wv, A_wo)
    x = x + _B_ref(_layernorm(x, axis=-1), B_w_gate, B_w_up, B_w_down)
    return x
```

```asm
; @launch grid=(256,1,1) block=(256,1,1) lds=163840
.amdgcn_target "amdgcn-amd-amdhsa--gfx950"
.text
.globl interleave_layers__grouped_kv_mqa__glu_gated_glu__prompt_kernel
.p2align 8
.type interleave_layers__grouped_kv_mqa__glu_gated_glu__prompt_kernel,@function
interleave_layers__grouped_kv_mqa__glu_gated_glu__prompt_kernel:

  s_cmp_ge_u32 s2, 256
  s_cbranch_scc1 L_exit
  s_load_dwordx16 s[40:55], s[0:1], 0
  s_load_dwordx4 s[56:59], s[0:1], 64
  s_load_dwordx4 s[4:7], s[0:1], 80
  s_memrealtime s[8:9]
  s_getpc_b64 s[20:21]
L_pc:
  s_mov_b32 s22, L_end-L_pc
  s_mov_b32 s23, 0x20000
  s_lshr_b32 s24, s2, 3
  s_mul_i32 s24, s24, 3072
  v_mul_u32_u24 v5, 3, v0
  v_lshrrev_b32 v5, 5, v5
  v_lshlrev_b32 v5, 7, v5
  v_add_u32 v5, s24, v5
  buffer_load_dword v31, v5, s[20:23], 0 offen
  v_lshrrev_b32 v1, 6, v0
  v_and_b32 v2, 63, v0
  v_and_b32 v3, 31, v0
  v_readfirstlane_b32 s3, v1
  v_lshrrev_b32 v4, 5, v2
  v_lshlrev_b32 v9, 4, v2
  v_cmp_eq_u32 s[62:63], 1, v4
  s_waitcnt lgkmcnt(0)
  s_mov_b32 s15, 0
  s_mov_b32 s61, 0
  s_getreg_b32 s10, hwreg(HW_REG_XCC_ID, 0, 4)
  s_mov_b32 s12, s6
  s_mov_b32 s13, s7
  s_mov_b32 s6, 256
  s_mov_b32 s7, 0x20000
  s_mov_b32 s16, s12
  s_mov_b32 s17, s13
  s_mov_b32 s18, 0x24ab000
  s_mov_b32 s19, 0x20000
  s_mov_b32 s101, s2
  s_and_b32 s9, s2, 7
  s_lshl_b32 s9, s9, 5
  s_lshr_b32 s11, s2, 3
  s_add_u32 s9, s9, s11
  s_lshl_b32 s9, s9, 2
  s_add_u32 s9, s9, s3
  s_lshl_b32 s9, s9, 3
  s_or_b32 s11, s101, s3
  s_cmp_lg_u32 s11, 0
  s_cbranch_scc1 L_notag
  s_lshl_b32 s8, s8, 5
  s_or_b32 s8, s8, 16
  v_mov_b32 v10, s8
  v_mov_b32 v1, 0
  buffer_store_dword v10, v1, s[4:7], 0 offen sc1
L_notag:
  s_and_b32 s24, s2, 7
  s_lshr_b32 s25, s2, 5
  s_lshl_b32 s24, s24, 3
  s_add_u32 s24, s24, s25
  s_bfe_u32 s26, s2, 0x20003
  s_mov_b32 s20, s40
  s_mov_b32 s21, s41
  s_mov_b32 s22, 0x1c0000
  s_mov_b32 s23, 0x20000
  v_mul_u32_u24 v5, 896, v3
  v_lshl_add_u32 v5, v4, 4, v5
  s_mul_i32 s27, s24, 28672
  s_mul_i32 s32, s3, 224
  s_add_u32 s27, s27, s32
  buffer_load_dwordx4 v[32:35], v5, s[20:23], s27 offen offset:0
  buffer_load_dwordx4 v[36:39], v5, s[20:23], s27 offen offset:32
  buffer_load_dwordx4 v[40:43], v5, s[20:23], s27 offen offset:64
  buffer_load_dwordx4 v[44:47], v5, s[20:23], s27 offen offset:96
  buffer_load_dwordx4 v[48:51], v5, s[20:23], s27 offen offset:128
  buffer_load_dwordx4 v[52:55], v5, s[20:23], s27 offen offset:160
  buffer_load_dwordx4 v[56:59], v5, s[20:23], s27 offen offset:192
  s_lshl_b32 s26, s26, 2
  s_add_u32 s26, s26, s3
  s_cmp_eq_u32 s26, 14
  s_cselect_b32 s20, s44, s42
  s_cselect_b32 s21, s45, s43
  s_cmp_eq_u32 s26, 15
  s_cselect_b32 s20, s46, s20
  s_cselect_b32 s21, s47, s21
  s_cmp_ge_u32 s26, 14
  s_mov_b32 s22, 401408
  s_cselect_b32 s22, 25088, s22
  s_cselect_b32 s33, 56, 896
  s_cselect_b32 s32, 0, s26
  s_mov_b32 s23, 0x20000
  s_lshl_b32 s32, s32, 6
  v_lshrrev_b32 v6, 2, v2
  v_and_b32 v8, 3, v2
  v_mul_lo_u32 v6, v6, s33
  v_lshl_add_u32 v6, v8, 4, v6
  s_lshl_b32 s33, s33, 4
  s_mul_i32 s25, s3, 28672
  s_mov_b32 m0, s25
  buffer_load_dwordx4 v6, s[20:23], s32 offen lds
  s_add_u32 m0, m0, 1024
  s_add_u32 s32, s32, s33
  buffer_load_dwordx4 v6, s[20:23], s32 offen lds
  s_add_u32 m0, m0, 1024
  s_add_u32 s32, s32, s33
  buffer_load_dwordx4 v6, s[20:23], s32 offen lds
  s_add_u32 m0, m0, 1024
  s_add_u32 s32, s32, s33
  buffer_load_dwordx4 v6, s[20:23], s32 offen lds
  s_add_u32 m0, m0, 1024
  s_add_u32 s32, s32, s33
  buffer_load_dwordx4 v6, s[20:23], s32 offen lds
  s_add_u32 m0, m0, 1024
  s_add_u32 s32, s32, s33
  buffer_load_dwordx4 v6, s[20:23], s32 offen lds
  s_add_u32 m0, m0, 1024
  s_add_u32 s32, s32, s33
  buffer_load_dwordx4 v6, s[20:23], s32 offen lds
  s_add_u32 m0, m0, 1024
  s_add_u32 s32, s32, s33
  buffer_load_dwordx4 v6, s[20:23], s32 offen lds
  s_add_u32 m0, m0, 1024
  s_add_u32 s32, s32, s33
  buffer_load_dwordx4 v6, s[20:23], s32 offen lds
  s_add_u32 m0, m0, 1024
  s_add_u32 s32, s32, s33
  buffer_load_dwordx4 v6, s[20:23], s32 offen lds
  s_add_u32 m0, m0, 1024
  s_add_u32 s32, s32, s33
  buffer_load_dwordx4 v6, s[20:23], s32 offen lds
  s_add_u32 m0, m0, 1024
  s_add_u32 s32, s32, s33
  buffer_load_dwordx4 v6, s[20:23], s32 offen lds
  s_add_u32 m0, m0, 1024
  s_add_u32 s32, s32, s33
  buffer_load_dwordx4 v6, s[20:23], s32 offen lds
  s_add_u32 m0, m0, 1024
  s_add_u32 s32, s32, s33
  buffer_load_dwordx4 v6, s[20:23], s32 offen lds
  s_add_u32 m0, m0, 1024
  s_add_u32 s32, s32, s33
  buffer_load_dwordx4 v6, s[20:23], s32 offen lds
  s_add_u32 m0, m0, 1024
  s_add_u32 s32, s32, s33
  buffer_load_dwordx4 v6, s[20:23], s32 offen lds
  s_add_u32 m0, m0, 1024
  s_add_u32 s32, s32, s33
  v_lshrrev_b32 v13, 3, v2
  v_and_b32 v14, 7, v2
  v_lshlrev_b32 v14, 4, v14
  s_mov_b32 s31, 0x20000
  s_cmp_ge_u32 s101, 112
  s_cbranch_scc1 L_ps_b
  s_cmp_ge_u32 s3, 2
  s_cselect_b32 s28, s54, s52
  s_cselect_b32 s29, s55, s53
  s_mov_b32 s30, 1605632
  s_and_b32 s34, s101, 3
  s_mul_i32 s34, s34, 112
  s_and_b32 s35, s3, 1
  s_mul_i32 s35, s35, 56
  s_add_u32 s34, s34, s35
  s_mul_i32 s34, s34, 3584
  s_lshr_b32 s35, s101, 2
  s_lshl_b32 s35, s35, 7
  s_add_u32 s34, s34, s35
  s_mov_b32 s35, 3584
  s_branch L_ps_e
L_ps_b:
  s_sub_u32 s34, s101, 112
  s_cmp_ge_u32 s34, 98
  s_cselect_b32 s28, s48, s56
  s_cselect_b32 s29, s49, s57
  s_mov_b32 s30, 1605632
  s_cselect_b32 s30, 401408, s30
  s_cselect_b32 s36, 28, 32
  s_cselect_b32 s37, 98, 0
  s_cmp_ge_u32 s101, 238
  s_cselect_b32 s30, 0, s30
  s_sub_u32 s34, s34, s37
  s_mul_i32 s35, s34, 9363
  s_lshr_b32 s35, s35, 16
  s_mul_i32 s37, s35, 7
  s_sub_u32 s34, s34, s37
  s_lshl_b32 s35, s35, 2
  s_add_u32 s35, s35, s3
  s_mul_i32 s35, s35, s36
  s_mul_i32 s35, s35, 896
  s_lshl_b32 s34, s34, 7
  s_add_u32 s34, s34, s35
  s_mov_b32 s35, 896
L_ps_e:
  v_mul_lo_u32 v7, v13, s35
  s_lshl_b32 s35, s35, 3
  v_add_u32 v7, v7, v14
  v_bfe_u32 v10, v2, 2, 2
  v_lshl_add_u32 v10, v4, 3, v10
  v_lshlrev_b32 v10, 6, v10
  v_bfe_u32 v11, v2, 4, 1
  v_lshl_add_u32 v10, v11, 5, v10
  v_lshl_add_u32 v10, v8, 3, v10
  v_add_u32 v10, s25, v10
  v_mov_b32 v12, 0
  v_mov_b32 v13, 0
  v_mov_b32 v14, 0
  v_mov_b32 v15, 0
  s_waitcnt vmcnt(16)
  v_lshlrev_b32 v64, 16, v32
  v_and_b32 v65, 0xffff0000, v32
  v_pk_add_f32 v[12:13], v[12:13], v[64:65]
  v_pk_fma_f32 v[14:15], v[64:65], v[64:65], v[14:15]
  v_lshlrev_b32 v66, 16, v33
  v_and_b32 v67, 0xffff0000, v33
  v_pk_add_f32 v[12:13], v[12:13], v[66:67]
  v_pk_fma_f32 v[14:15], v[66:67], v[66:67], v[14:15]
  buffer_load_dwordx4 v6, s[20:23], s32 offen lds
  s_add_u32 m0, m0, 1024
  s_add_u32 s32, s32, s33
  v_lshlrev_b32 v68, 16, v34
  v_and_b32 v69, 0xffff0000, v34
  v_pk_add_f32 v[12:13], v[12:13], v[68:69]
  v_pk_fma_f32 v[14:15], v[68:69], v[68:69], v[14:15]
  v_lshlrev_b32 v70, 16, v35
  v_and_b32 v71, 0xffff0000, v35
  v_pk_add_f32 v[12:13], v[12:13], v[70:71]
  v_pk_fma_f32 v[14:15], v[70:71], v[70:71], v[14:15]
  buffer_load_dwordx4 v6, s[20:23], s32 offen lds
  s_add_u32 m0, m0, 1024
  s_add_u32 s32, s32, s33
  v_lshlrev_b32 v72, 16, v36
  v_and_b32 v73, 0xffff0000, v36
  v_pk_add_f32 v[12:13], v[12:13], v[72:73]
  v_pk_fma_f32 v[14:15], v[72:73], v[72:73], v[14:15]
  v_lshlrev_b32 v74, 16, v37
  v_and_b32 v75, 0xffff0000, v37
  v_pk_add_f32 v[12:13], v[12:13], v[74:75]
  v_pk_fma_f32 v[14:15], v[74:75], v[74:75], v[14:15]
  buffer_load_dwordx4 v6, s[20:23], s32 offen lds
  s_add_u32 m0, m0, 1024
  s_add_u32 s32, s32, s33
  v_lshlrev_b32 v76, 16, v38
  v_and_b32 v77, 0xffff0000, v38
  v_pk_add_f32 v[12:13], v[12:13], v[76:77]
  v_pk_fma_f32 v[14:15], v[76:77], v[76:77], v[14:15]
  v_lshlrev_b32 v78, 16, v39
  v_and_b32 v79, 0xffff0000, v39
  v_pk_add_f32 v[12:13], v[12:13], v[78:79]
  v_pk_fma_f32 v[14:15], v[78:79], v[78:79], v[14:15]
  buffer_load_dwordx4 v6, s[20:23], s32 offen lds
  s_add_u32 m0, m0, 1024
  s_add_u32 s32, s32, s33
  v_lshlrev_b32 v80, 16, v40
  v_and_b32 v81, 0xffff0000, v40
  v_pk_add_f32 v[12:13], v[12:13], v[80:81]
  v_pk_fma_f32 v[14:15], v[80:81], v[80:81], v[14:15]
  v_lshlrev_b32 v82, 16, v41
  v_and_b32 v83, 0xffff0000, v41
  v_pk_add_f32 v[12:13], v[12:13], v[82:83]
  v_pk_fma_f32 v[14:15], v[82:83], v[82:83], v[14:15]
  buffer_load_dwordx4 v6, s[20:23], s32 offen lds
  s_add_u32 m0, m0, 1024
  s_add_u32 s32, s32, s33
  v_lshlrev_b32 v84, 16, v42
  v_and_b32 v85, 0xffff0000, v42
  v_pk_add_f32 v[12:13], v[12:13], v[84:85]
  v_pk_fma_f32 v[14:15], v[84:85], v[84:85], v[14:15]
  v_lshlrev_b32 v86, 16, v43
  v_and_b32 v87, 0xffff0000, v43
  v_pk_add_f32 v[12:13], v[12:13], v[86:87]
  v_pk_fma_f32 v[14:15], v[86:87], v[86:87], v[14:15]
  buffer_load_dwordx4 v6, s[20:23], s32 offen lds
  s_add_u32 m0, m0, 1024
  s_add_u32 s32, s32, s33
  v_lshlrev_b32 v88, 16, v44
  v_and_b32 v89, 0xffff0000, v44
  v_pk_add_f32 v[12:13], v[12:13], v[88:89]
  v_pk_fma_f32 v[14:15], v[88:89], v[88:89], v[14:15]
  v_lshlrev_b32 v90, 16, v45
  v_and_b32 v91, 0xffff0000, v45
  v_pk_add_f32 v[12:13], v[12:13], v[90:91]
  v_pk_fma_f32 v[14:15], v[90:91], v[90:91], v[14:15]
  buffer_load_dwordx4 v6, s[20:23], s32 offen lds
  s_add_u32 m0, m0, 1024
  s_add_u32 s32, s32, s33
  v_lshlrev_b32 v92, 16, v46
  v_and_b32 v93, 0xffff0000, v46
  v_pk_add_f32 v[12:13], v[12:13], v[92:93]
  v_pk_fma_f32 v[14:15], v[92:93], v[92:93], v[14:15]
  v_lshlrev_b32 v94, 16, v47
  v_and_b32 v95, 0xffff0000, v47
  v_pk_add_f32 v[12:13], v[12:13], v[94:95]
  v_pk_fma_f32 v[14:15], v[94:95], v[94:95], v[14:15]
  buffer_load_dwordx4 v6, s[20:23], s32 offen lds
  s_add_u32 m0, m0, 1024
  s_add_u32 s32, s32, s33
  v_lshlrev_b32 v96, 16, v48
  v_and_b32 v97, 0xffff0000, v48
  v_pk_add_f32 v[12:13], v[12:13], v[96:97]
  v_pk_fma_f32 v[14:15], v[96:97], v[96:97], v[14:15]
  v_lshlrev_b32 v98, 16, v49
  v_and_b32 v99, 0xffff0000, v49
  v_pk_add_f32 v[12:13], v[12:13], v[98:99]
  v_pk_fma_f32 v[14:15], v[98:99], v[98:99], v[14:15]
  buffer_load_dwordx4 v6, s[20:23], s32 offen lds
  s_add_u32 m0, m0, 1024
  s_add_u32 s32, s32, s33
  v_lshlrev_b32 v100, 16, v50
  v_and_b32 v101, 0xffff0000, v50
  v_pk_add_f32 v[12:13], v[12:13], v[100:101]
  v_pk_fma_f32 v[14:15], v[100:101], v[100:101], v[14:15]
  v_lshlrev_b32 v102, 16, v51
  v_and_b32 v103, 0xffff0000, v51
  v_pk_add_f32 v[12:13], v[12:13], v[102:103]
  v_pk_fma_f32 v[14:15], v[102:103], v[102:103], v[14:15]
  buffer_load_dwordx4 v6, s[20:23], s32 offen lds
  s_add_u32 m0, m0, 1024
  s_add_u32 s32, s32, s33
  v_lshlrev_b32 v104, 16, v52
  v_and_b32 v105, 0xffff0000, v52
  v_pk_add_f32 v[12:13], v[12:13], v[104:105]
  v_pk_fma_f32 v[14:15], v[104:105], v[104:105], v[14:15]
  v_lshlrev_b32 v106, 16, v53
  v_and_b32 v107, 0xffff0000, v53
  v_pk_add_f32 v[12:13], v[12:13], v[106:107]
  v_pk_fma_f32 v[14:15], v[106:107], v[106:107], v[14:15]
  buffer_load_dwordx4 v6, s[20:23], s32 offen lds
  s_add_u32 m0, m0, 1024
  s_add_u32 s32, s32, s33
  v_lshlrev_b32 v108, 16, v54
  v_and_b32 v109, 0xffff0000, v54
  v_pk_add_f32 v[12:13], v[12:13], v[108:109]
  v_pk_fma_f32 v[14:15], v[108:109], v[108:109], v[14:15]
  v_lshlrev_b32 v110, 16, v55
  v_and_b32 v111, 0xffff0000, v55
  v_pk_add_f32 v[12:13], v[12:13], v[110:111]
  v_pk_fma_f32 v[14:15], v[110:111], v[110:111], v[14:15]
  buffer_load_dwordx4 v6, s[20:23], s32 offen lds
  s_add_u32 m0, m0, 1024
  s_add_u32 s32, s32, s33
  v_lshlrev_b32 v112, 16, v56
  v_and_b32 v113, 0xffff0000, v56
  v_pk_add_f32 v[12:13], v[12:13], v[112:113]
  v_pk_fma_f32 v[14:15], v[112:113], v[112:113], v[14:15]
  v_lshlrev_b32 v114, 16, v57
  v_and_b32 v115, 0xffff0000, v57
  v_pk_add_f32 v[12:13], v[12:13], v[114:115]
  v_pk_fma_f32 v[14:15], v[114:115], v[114:115], v[14:15]
  v_lshlrev_b32 v116, 16, v58
  v_and_b32 v117, 0xffff0000, v58
  v_pk_add_f32 v[12:13], v[12:13], v[116:117]
  v_pk_fma_f32 v[14:15], v[116:117], v[116:117], v[14:15]
  v_lshlrev_b32 v118, 16, v59
  v_and_b32 v119, 0xffff0000, v59
  v_pk_add_f32 v[12:13], v[12:13], v[118:119]
  v_pk_fma_f32 v[14:15], v[118:119], v[118:119], v[14:15]
  v_add_f32 v12, v12, v13
  v_add_f32 v13, v14, v15
  s_lshl_b32 s36, s3, 9
  v_lshlrev_b32 v14, 3, v2
  s_add_u32 s36, s36, 142336
  v_add_u32 v15, s36, v14
  ds_write_b64 v15, v[12:13]
  v_lshlrev_b32 v14, 3, v3
  v_add_u32 v14, 142336, v14
  v_add_u32 v8, 114688, v9
  s_waitcnt lgkmcnt(0)
  s_barrier
  ds_read_b64 v[16:17], v14 offset:0
  ds_read_b64 v[18:19], v14 offset:256
  ds_read_b64 v[20:21], v14 offset:512
  ds_read_b64 v[22:23], v14 offset:768
  ds_read_b64 v[24:25], v14 offset:1024
  ds_read_b64 v[26:27], v14 offset:1280
  ds_read_b64 v[28:29], v14 offset:1536
  ds_read_b64 v[30:31], v14 offset:1792
  v_mov_b32 v1, 0
  buffer_load_dword v120, v1, s[4:7], 0 offen sc1
  s_waitcnt lgkmcnt(0)
  s_barrier
  v_pk_add_f32 v[16:17], v[16:17], v[18:19]
  v_pk_add_f32 v[16:17], v[16:17], v[20:21]
  v_pk_add_f32 v[16:17], v[16:17], v[22:23]
  v_pk_add_f32 v[16:17], v[16:17], v[24:25]
  v_pk_add_f32 v[16:17], v[16:17], v[26:27]
  v_pk_add_f32 v[16:17], v[16:17], v[28:29]
  v_pk_add_f32 v[16:17], v[16:17], v[30:31]
  v_mul_f32 v16, 0x3b124925, v16
  v_mul_f32 v17, 0x3b124925, v17
  v_fma_f32 v17, -v16, v16, v17
  v_max_f32 v17, 0, v17
  v_add_f32 v17, 0x3727c5ac, v17
  v_rsq_f32 v17, v17
  s_mul_i32 s36, s3, 7168
  v_add_u32 v15, s36, v8
  v_mul_f32 v16, v16, v17
  v_pk_fma_f32 v[64:65], v[64:65], v[16:17], v[16:17] op_sel:[0,1,0] op_sel_hi:[1,1,0] neg_lo:[0,0,1] neg_hi:[0,0,1]
  v_cvt_pk_bf16_f32 v32, v64, v65
  v_pk_fma_f32 v[66:67], v[66:67], v[16:17], v[16:17] op_sel:[0,1,0] op_sel_hi:[1,1,0] neg_lo:[0,0,1] neg_hi:[0,0,1]
  v_cvt_pk_bf16_f32 v33, v66, v67
  v_pk_fma_f32 v[68:69], v[68:69], v[16:17], v[16:17] op_sel:[0,1,0] op_sel_hi:[1,1,0] neg_lo:[0,0,1] neg_hi:[0,0,1]
  v_cvt_pk_bf16_f32 v34, v68, v69
  v_pk_fma_f32 v[70:71], v[70:71], v[16:17], v[16:17] op_sel:[0,1,0] op_sel_hi:[1,1,0] neg_lo:[0,0,1] neg_hi:[0,0,1]
  v_cvt_pk_bf16_f32 v35, v70, v71
  ds_write_b128 v15, v[32:35] offset:0
  buffer_load_dwordx4 a[0:3], v7, s[28:31], s34 offen
  s_add_u32 s34, s34, s35
  v_pk_fma_f32 v[72:73], v[72:73], v[16:17], v[16:17] op_sel:[0,1,0] op_sel_hi:[1,1,0] neg_lo:[0,0,1] neg_hi:[0,0,1]
  v_cvt_pk_bf16_f32 v36, v72, v73
  v_pk_fma_f32 v[74:75], v[74:75], v[16:17], v[16:17] op_sel:[0,1,0] op_sel_hi:[1,1,0] neg_lo:[0,0,1] neg_hi:[0,0,1]
  v_cvt_pk_bf16_f32 v37, v74, v75
  v_pk_fma_f32 v[76:77], v[76:77], v[16:17], v[16:17] op_sel:[0,1,0] op_sel_hi:[1,1,0] neg_lo:[0,0,1] neg_hi:[0,0,1]
  v_cvt_pk_bf16_f32 v38, v76, v77
  v_pk_fma_f32 v[78:79], v[78:79], v[16:17], v[16:17] op_sel:[0,1,0] op_sel_hi:[1,1,0] neg_lo:[0,0,1] neg_hi:[0,0,1]
  v_cvt_pk_bf16_f32 v39, v78, v79
  ds_write_b128 v15, v[36:39] offset:1024
  buffer_load_dwordx4 a[4:7], v7, s[28:31], s34 offen
  s_add_u32 s34, s34, s35
  v_pk_fma_f32 v[80:81], v[80:81], v[16:17], v[16:17] op_sel:[0,1,0] op_sel_hi:[1,1,0] neg_lo:[0,0,1] neg_hi:[0,0,1]
  v_cvt_pk_bf16_f32 v40, v80, v81
  v_pk_fma_f32 v[82:83], v[82:83], v[16:17], v[16:17] op_sel:[0,1,0] op_sel_hi:[1,1,0] neg_lo:[0,0,1] neg_hi:[0,0,1]
  v_cvt_pk_bf16_f32 v41, v82, v83
  v_pk_fma_f32 v[84:85], v[84:85], v[16:17], v[16:17] op_sel:[0,1,0] op_sel_hi:[1,1,0] neg_lo:[0,0,1] neg_hi:[0,0,1]
  v_cvt_pk_bf16_f32 v42, v84, v85
  v_pk_fma_f32 v[86:87], v[86:87], v[16:17], v[16:17] op_sel:[0,1,0] op_sel_hi:[1,1,0] neg_lo:[0,0,1] neg_hi:[0,0,1]
  v_cvt_pk_bf16_f32 v43, v86, v87
  ds_write_b128 v15, v[40:43] offset:2048
  buffer_load_dwordx4 a[8:11], v7, s[28:31], s34 offen
  s_add_u32 s34, s34, s35
  v_pk_fma_f32 v[88:89], v[88:89], v[16:17], v[16:17] op_sel:[0,1,0] op_sel_hi:[1,1,0] neg_lo:[0,0,1] neg_hi:[0,0,1]
  v_cvt_pk_bf16_f32 v44, v88, v89
  v_pk_fma_f32 v[90:91], v[90:91], v[16:17], v[16:17] op_sel:[0,1,0] op_sel_hi:[1,1,0] neg_lo:[0,0,1] neg_hi:[0,0,1]
  v_cvt_pk_bf16_f32 v45, v90, v91
  v_pk_fma_f32 v[92:93], v[92:93], v[16:17], v[16:17] op_sel:[0,1,0] op_sel_hi:[1,1,0] neg_lo:[0,0,1] neg_hi:[0,0,1]
  v_cvt_pk_bf16_f32 v46, v92, v93
  v_pk_fma_f32 v[94:95], v[94:95], v[16:17], v[16:17] op_sel:[0,1,0] op_sel_hi:[1,1,0] neg_lo:[0,0,1] neg_hi:[0,0,1]
  v_cvt_pk_bf16_f32 v47, v94, v95
  ds_write_b128 v15, v[44:47] offset:3072
  buffer_load_dwordx4 a[12:15], v7, s[28:31], s34 offen
  s_add_u32 s34, s34, s35
  v_pk_fma_f32 v[96:97], v[96:97], v[16:17], v[16:17] op_sel:[0,1,0] op_sel_hi:[1,1,0] neg_lo:[0,0,1] neg_hi:[0,0,1]
  v_cvt_pk_bf16_f32 v48, v96, v97
  v_pk_fma_f32 v[98:99], v[98:99], v[16:17], v[16:17] op_sel:[0,1,0] op_sel_hi:[1,1,0] neg_lo:[0,0,1] neg_hi:[0,0,1]
  v_cvt_pk_bf16_f32 v49, v98, v99
  v_pk_fma_f32 v[100:101], v[100:101], v[16:17], v[16:17] op_sel:[0,1,0] op_sel_hi:[1,1,0] neg_lo:[0,0,1] neg_hi:[0,0,1]
  v_cvt_pk_bf16_f32 v50, v100, v101
  v_pk_fma_f32 v[102:103], v[102:103], v[16:17], v[16:17] op_sel:[0,1,0] op_sel_hi:[1,1,0] neg_lo:[0,0,1] neg_hi:[0,0,1]
  v_cvt_pk_bf16_f32 v51, v102, v103
  ds_write_b128 v15, v[48:51] offset:4096
  buffer_load_dwordx4 a[16:19], v7, s[28:31], s34 offen
  s_add_u32 s34, s34, s35
  v_pk_fma_f32 v[104:105], v[104:105], v[16:17], v[16:17] op_sel:[0,1,0] op_sel_hi:[1,1,0] neg_lo:[0,0,1] neg_hi:[0,0,1]
  v_cvt_pk_bf16_f32 v52, v104, v105
  v_pk_fma_f32 v[106:107], v[106:107], v[16:17], v[16:17] op_sel:[0,1,0] op_sel_hi:[1,1,0] neg_lo:[0,0,1] neg_hi:[0,0,1]
  v_cvt_pk_bf16_f32 v53, v106, v107
  v_pk_fma_f32 v[108:109], v[108:109], v[16:17], v[16:17] op_sel:[0,1,0] op_sel_hi:[1,1,0] neg_lo:[0,0,1] neg_hi:[0,0,1]
  v_cvt_pk_bf16_f32 v54, v108, v109
  v_pk_fma_f32 v[110:111], v[110:111], v[16:17], v[16:17] op_sel:[0,1,0] op_sel_hi:[1,1,0] neg_lo:[0,0,1] neg_hi:[0,0,1]
  v_cvt_pk_bf16_f32 v55, v110, v111
  ds_write_b128 v15, v[52:55] offset:5120
  buffer_load_dwordx4 a[20:23], v7, s[28:31], s34 offen
  s_add_u32 s34, s34, s35
  v_pk_fma_f32 v[112:113], v[112:113], v[16:17], v[16:17] op_sel:[0,1,0] op_sel_hi:[1,1,0] neg_lo:[0,0,1] neg_hi:[0,0,1]
  v_cvt_pk_bf16_f32 v56, v112, v113
  v_pk_fma_f32 v[114:115], v[114:115], v[16:17], v[16:17] op_sel:[0,1,0] op_sel_hi:[1,1,0] neg_lo:[0,0,1] neg_hi:[0,0,1]
  v_cvt_pk_bf16_f32 v57, v114, v115
  v_pk_fma_f32 v[116:117], v[116:117], v[16:17], v[16:17] op_sel:[0,1,0] op_sel_hi:[1,1,0] neg_lo:[0,0,1] neg_hi:[0,0,1]
  v_cvt_pk_bf16_f32 v58, v116, v117
  v_pk_fma_f32 v[118:119], v[118:119], v[16:17], v[16:17] op_sel:[0,1,0] op_sel_hi:[1,1,0] neg_lo:[0,0,1] neg_hi:[0,0,1]
  v_cvt_pk_bf16_f32 v59, v118, v119
  ds_write_b128 v15, v[56:59] offset:6144
  buffer_load_dwordx4 a[24:27], v7, s[28:31], s34 offen
  s_add_u32 s34, s34, s35
  s_waitcnt vmcnt(7) lgkmcnt(0)
  s_barrier
  s_cmp_eq_u32 s26, 15
  s_cbranch_scc1 q0_v
  ds_read_b64_tr_b16 v[32:33], v10 offset:0
  ds_read_b64_tr_b16 v[34:35], v10 offset:256
  ds_read_b128 v[36:39], v8 offset:0
  ds_read_b64_tr_b16 v[40:41], v10 offset:1024
  ds_read_b64_tr_b16 v[42:43], v10 offset:1280
  ds_read_b128 v[44:47], v8 offset:1024
  ds_read_b64_tr_b16 v[48:49], v10 offset:2048
  ds_read_b64_tr_b16 v[50:51], v10 offset:2304
  ds_read_b128 v[52:55], v8 offset:2048
  ds_read_b64_tr_b16 v[56:57], v10 offset:3072
  ds_read_b64_tr_b16 v[58:59], v10 offset:3328
  ds_read_b128 v[60:63], v8 offset:3072
  s_waitcnt lgkmcnt(9)
  v_mfma_f32_32x32x16_bf16 v[64:79], v[32:35], v[36:39], 0
  ds_read_b64_tr_b16 v[32:33], v10 offset:4096
  ds_read_b64_tr_b16 v[34:35], v10 offset:4352
  ds_read_b128 v[36:39], v8 offset:4096
  s_waitcnt lgkmcnt(9)
  v_mfma_f32_32x32x16_bf16 v[64:79], v[40:43], v[44:47], v[64:79]
  ds_read_b64_tr_b16 v[40:41], v10 offset:5120
  ds_read_b64_tr_b16 v[42:43], v10 offset:5376
  ds_read_b128 v[44:47], v8 offset:5120
  s_waitcnt lgkmcnt(9)
  v_mfma_f32_32x32x16_bf16 v[64:79], v[48:51], v[52:55], v[64:79]
  ds_read_b64_tr_b16 v[48:49], v10 offset:6144
  ds_read_b64_tr_b16 v[50:51], v10 offset:6400
  ds_read_b128 v[52:55], v8 offset:6144
  s_waitcnt lgkmcnt(9)
  v_mfma_f32_32x32x16_bf16 v[64:79], v[56:59], v[60:63], v[64:79]
  ds_read_b64_tr_b16 v[56:57], v10 offset:7168
  ds_read_b64_tr_b16 v[58:59], v10 offset:7424
  ds_read_b128 v[60:63], v8 offset:7168
  s_waitcnt lgkmcnt(9)
  v_mfma_f32_32x32x16_bf16 v[64:79], v[32:35], v[36:39], v[64:79]
  ds_read_b64_tr_b16 v[32:33], v10 offset:8192
  ds_read_b64_tr_b16 v[34:35], v10 offset:8448
  ds_read_b128 v[36:39], v8 offset:8192
  s_waitcnt lgkmcnt(9)
  v_mfma_f32_32x32x16_bf16 v[64:79], v[40:43], v[44:47], v[64:79]
  ds_read_b64_tr_b16 v[40:41], v10 offset:9216
  ds_read_b64_tr_b16 v[42:43], v10 offset:9472
  ds_read_b128 v[44:47], v8 offset:9216
  s_waitcnt lgkmcnt(9)
  v_mfma_f32_32x32x16_bf16 v[64:79], v[48:51], v[52:55], v[64:79]
  ds_read_b64_tr_b16 v[48:49], v10 offset:10240
  ds_read_b64_tr_b16 v[50:51], v10 offset:10496
  ds_read_b128 v[52:55], v8 offset:10240
  s_waitcnt lgkmcnt(9)
  v_mfma_f32_32x32x16_bf16 v[64:79], v[56:59], v[60:63], v[64:79]
  ds_read_b64_tr_b16 v[56:57], v10 offset:11264
  ds_read_b64_tr_b16 v[58:59], v10 offset:11520
  ds_read_b128 v[60:63], v8 offset:11264
  s_waitcnt lgkmcnt(9)
  v_mfma_f32_32x32x16_bf16 v[64:79], v[32:35], v[36:39], v[64:79]
  ds_read_b64_tr_b16 v[32:33], v10 offset:12288
  ds_read_b64_tr_b16 v[34:35], v10 offset:12544
  ds_read_b128 v[36:39], v8 offset:12288
  s_waitcnt lgkmcnt(9)
  v_mfma_f32_32x32x16_bf16 v[64:79], v[40:43], v[44:47], v[64:79]
  ds_read_b64_tr_b16 v[40:41], v10 offset:13312
  ds_read_b64_tr_b16 v[42:43], v10 offset:13568
  ds_read_b128 v[44:47], v8 offset:13312
  s_waitcnt lgkmcnt(9)
  v_mfma_f32_32x32x16_bf16 v[64:79], v[48:51], v[52:55], v[64:79]
  ds_read_b64_tr_b16 v[48:49], v10 offset:14336
  ds_read_b64_tr_b16 v[50:51], v10 offset:14592
  ds_read_b128 v[52:55], v8 offset:14336
  s_waitcnt lgkmcnt(9)
  v_mfma_f32_32x32x16_bf16 v[64:79], v[56:59], v[60:63], v[64:79]
  ds_read_b64_tr_b16 v[56:57], v10 offset:15360
  ds_read_b64_tr_b16 v[58:59], v10 offset:15616
  ds_read_b128 v[60:63], v8 offset:15360
  s_waitcnt lgkmcnt(9)
  v_mfma_f32_32x32x16_bf16 v[64:79], v[32:35], v[36:39], v[64:79]
  ds_read_b64_tr_b16 v[32:33], v10 offset:16384
  ds_read_b64_tr_b16 v[34:35], v10 offset:16640
  ds_read_b128 v[36:39], v8 offset:16384
  s_waitcnt lgkmcnt(9)
  v_mfma_f32_32x32x16_bf16 v[64:79], v[40:43], v[44:47], v[64:79]
  ds_read_b64_tr_b16 v[40:41], v10 offset:17408
  ds_read_b64_tr_b16 v[42:43], v10 offset:17664
  ds_read_b128 v[44:47], v8 offset:17408
  s_waitcnt lgkmcnt(9)
  v_mfma_f32_32x32x16_bf16 v[64:79], v[48:51], v[52:55], v[64:79]
  ds_read_b64_tr_b16 v[48:49], v10 offset:18432
  ds_read_b64_tr_b16 v[50:51], v10 offset:18688
  ds_read_b128 v[52:55], v8 offset:18432
  s_waitcnt lgkmcnt(9)
  v_mfma_f32_32x32x16_bf16 v[64:79], v[56:59], v[60:63], v[64:79]
  ds_read_b64_tr_b16 v[56:57], v10 offset:19456
  ds_read_b64_tr_b16 v[58:59], v10 offset:19712
  ds_read_b128 v[60:63], v8 offset:19456
  s_waitcnt lgkmcnt(9)
  v_mfma_f32_32x32x16_bf16 v[64:79], v[32:35], v[36:39], v[64:79]
  ds_read_b64_tr_b16 v[32:33], v10 offset:20480
  ds_read_b64_tr_b16 v[34:35], v10 offset:20736
  ds_read_b128 v[36:39], v8 offset:20480
  s_waitcnt lgkmcnt(9)
  v_mfma_f32_32x32x16_bf16 v[64:79], v[40:43], v[44:47], v[64:79]
  ds_read_b64_tr_b16 v[40:41], v10 offset:21504
  ds_read_b64_tr_b16 v[42:43], v10 offset:21760
  ds_read_b128 v[44:47], v8 offset:21504
  s_waitcnt lgkmcnt(9)
  v_mfma_f32_32x32x16_bf16 v[64:79], v[48:51], v[52:55], v[64:79]
  ds_read_b64_tr_b16 v[48:49], v10 offset:22528
  ds_read_b64_tr_b16 v[50:51], v10 offset:22784
  ds_read_b128 v[52:55], v8 offset:22528
  s_waitcnt lgkmcnt(9)
  v_mfma_f32_32x32x16_bf16 v[64:79], v[56:59], v[60:63], v[64:79]
  ds_read_b64_tr_b16 v[56:57], v10 offset:23552
  ds_read_b64_tr_b16 v[58:59], v10 offset:23808
  ds_read_b128 v[60:63], v8 offset:23552
  s_waitcnt lgkmcnt(9)
  v_mfma_f32_32x32x16_bf16 v[64:79], v[32:35], v[36:39], v[64:79]
  ds_read_b64_tr_b16 v[32:33], v10 offset:24576
  ds_read_b64_tr_b16 v[34:35], v10 offset:24832
  ds_read_b128 v[36:39], v8 offset:24576
  s_waitcnt lgkmcnt(9)
  v_mfma_f32_32x32x16_bf16 v[64:79], v[40:43], v[44:47], v[64:79]
  ds_read_b64_tr_b16 v[40:41], v10 offset:25600
  ds_read_b64_tr_b16 v[42:43], v10 offset:25856
  ds_read_b128 v[44:47], v8 offset:25600
  s_waitcnt lgkmcnt(9)
  v_mfma_f32_32x32x16_bf16 v[64:79], v[48:51], v[52:55], v[64:79]
  ds_read_b64_tr_b16 v[48:49], v10 offset:26624
  ds_read_b64_tr_b16 v[50:51], v10 offset:26880
  ds_read_b128 v[52:55], v8 offset:26624
  s_waitcnt lgkmcnt(9)
  v_mfma_f32_32x32x16_bf16 v[64:79], v[56:59], v[60:63], v[64:79]
  ds_read_b64_tr_b16 v[56:57], v10 offset:27648
  ds_read_b64_tr_b16 v[58:59], v10 offset:27904
  ds_read_b128 v[60:63], v8 offset:27648
  s_waitcnt lgkmcnt(9)
  v_mfma_f32_32x32x16_bf16 v[64:79], v[32:35], v[36:39], v[64:79]
  s_waitcnt lgkmcnt(6)
  v_mfma_f32_32x32x16_bf16 v[64:79], v[40:43], v[44:47], v[64:79]
  s_waitcnt lgkmcnt(3)
  v_mfma_f32_32x32x16_bf16 v[64:79], v[48:51], v[52:55], v[64:79]
  s_waitcnt lgkmcnt(0)
  v_mfma_f32_32x32x16_bf16 v[64:79], v[56:59], v[60:63], v[64:79]
  s_cmp_eq_u32 s26, 14
  s_cbranch_scc1 q0_k
  s_lshl_b32 s27, s24, 15
  s_add_u32 s27, s27, 5869568
  s_lshl_b32 s32, s26, 3
  v_add_u32 v5, s32, v4
  s_mov_b32 s33, 9363
  s_mov_b32 s32, 0x3e8b97f6
  v_add_u32 v6, 0, v5
  v_mul_u32_u24 v7, s33, v6
  v_lshrrev_b32 v7, 16, v7
  v_mul_u32_u24 v11, 7, v7
  v_sub_u32 v6, v6, v11
  v_lshlrev_b32 v7, 11, v7
  v_lshrrev_b32 v11, 2, v6
  v_lshl_add_u32 v7, v11, 10, v7
  v_and_b32 v11, 1, v6
  v_lshl_add_u32 v7, v11, 9, v7
  v_bfe_u32 v11, v6, 1, 1
  v_lshl_add_u32 v7, v11, 3, v7
  v_lshl_add_u32 v16, v3, 4, v7
  v_add_u32 v6, 2, v5
  v_mul_u32_u24 v7, s33, v6
  v_lshrrev_b32 v7, 16, v7
  v_mul_u32_u24 v11, 7, v7
  v_sub_u32 v6, v6, v11
  v_lshlrev_b32 v7, 11, v7
  v_lshrrev_b32 v11, 2, v6
  v_lshl_add_u32 v7, v11, 10, v7
  v_and_b32 v11, 1, v6
  v_lshl_add_u32 v7, v11, 9, v7
  v_bfe_u32 v11, v6, 1, 1
  v_lshl_add_u32 v7, v11, 3, v7
  v_lshl_add_u32 v17, v3, 4, v7
  v_add_u32 v6, 4, v5
  v_mul_u32_u24 v7, s33, v6
  v_lshrrev_b32 v7, 16, v7
  v_mul_u32_u24 v11, 7, v7
  v_sub_u32 v6, v6, v11
  v_lshlrev_b32 v7, 11, v7
  v_lshrrev_b32 v11, 2, v6
  v_lshl_add_u32 v7, v11, 10, v7
  v_and_b32 v11, 1, v6
  v_lshl_add_u32 v7, v11, 9, v7
  v_bfe_u32 v11, v6, 1, 1
  v_lshl_add_u32 v7, v11, 3, v7
  v_lshl_add_u32 v18, v3, 4, v7
  v_add_u32 v6, 6, v5
  v_mul_u32_u24 v7, s33, v6
  v_lshrrev_b32 v7, 16, v7
  v_mul_u32_u24 v11, 7, v7
  v_sub_u32 v6, v6, v11
  v_lshlrev_b32 v7, 11, v7
  v_lshrrev_b32 v11, 2, v6
  v_lshl_add_u32 v7, v11, 10, v7
  v_and_b32 v11, 1, v6
  v_lshl_add_u32 v7, v11, 9, v7
  v_bfe_u32 v11, v6, 1, 1
  v_lshl_add_u32 v7, v11, 3, v7
  v_lshl_add_u32 v19, v3, 4, v7
  v_mul_f32 v64, s32, v64
  v_mul_f32 v65, s32, v65
  v_mul_f32 v66, s32, v66
  v_mul_f32 v67, s32, v67
  v_cvt_pk_bf16_f32 v32, v64, v65
  v_cvt_pk_bf16_f32 v33, v66, v67
  v_mul_f32 v68, s32, v68
  v_mul_f32 v69, s32, v69
  v_mul_f32 v70, s32, v70
  v_mul_f32 v71, s32, v71
  v_cvt_pk_bf16_f32 v34, v68, v69
  v_cvt_pk_bf16_f32 v35, v70, v71
  v_mul_f32 v72, s32, v72
  v_mul_f32 v73, s32, v73
  v_mul_f32 v74, s32, v74
  v_mul_f32 v75, s32, v75
  v_cvt_pk_bf16_f32 v36, v72, v73
  v_cvt_pk_bf16_f32 v37, v74, v75
  v_mul_f32 v76, s32, v76
  v_mul_f32 v77, s32, v77
  v_mul_f32 v78, s32, v78
  v_mul_f32 v79, s32, v79
  v_cvt_pk_bf16_f32 v38, v76, v77
  v_cvt_pk_bf16_f32 v39, v78, v79
  buffer_store_dwordx2 v[32:33], v16, s[16:19], s27 offen sc1
  buffer_store_dwordx2 v[34:35], v17, s[16:19], s27 offen sc1
  buffer_store_dwordx2 v[36:37], v18, s[16:19], s27 offen sc1
  buffer_store_dwordx2 v[38:39], v19, s[16:19], s27 offen sc1
  v_dot2_f32_bf16 v12, v32, v32, 0
  v_dot2_f32_bf16 v12, v33, v33, v12
  v_dot2_f32_bf16 v12, v34, v34, v12
  v_dot2_f32_bf16 v12, v35, v35, v12
  v_dot2_f32_bf16 v12, v36, v36, v12
  v_dot2_f32_bf16 v12, v37, v37, v12
  v_dot2_f32_bf16 v12, v38, v38, v12
  v_dot2_f32_bf16 v12, v39, v39, v12
  s_nop 2
  v_mov_b32 v13, v12
  s_nop 1
  v_permlane32_swap_b32 v12, v13
  s_nop 1
  v_add_f32 v12, v12, v13
  s_nop 1
  v_max_f32_dpp v12, v12, v12 row_shr:1 row_mask:0xf bank_mask:0xf
  s_nop 1
  v_max_f32_dpp v12, v12, v12 row_shr:2 row_mask:0xf bank_mask:0xf
  s_nop 1
  v_max_f32_dpp v12, v12, v12 row_shr:4 row_mask:0xf bank_mask:0xf
  s_nop 1
  v_max_f32_dpp v12, v12, v12 row_shr:8 row_mask:0xf bank_mask:0xf
  s_nop 1
  v_readlane_b32 s36, v12, 15
  v_readlane_b32 s37, v12, 31
  s_nop 3
  s_max_u32 s36, s36, s37
  v_readfirstlane_b32 s14, v120
  v_mov_b32 v1, 0
  s_mov_b32 s39, 200000
  s_cmp_lg_u32 s14, 0
  s_cbranch_scc1 L_tagdT1
L_tagT1:
  buffer_load_dword v10, v1, s[4:7], 0 offen sc1
  s_waitcnt vmcnt(0)
  v_readfirstlane_b32 s14, v10
  s_sub_u32 s39, s39, 1
  s_cmp_eq_u32 s39, 0
  s_cbranch_scc1 L_tagdT1
  s_cmp_eq_u32 s14, 0
  s_cbranch_scc1 L_tagT1
L_tagdT1:
  s_add_u32 s38, s9, 21569536
  s_add_u32 s38, s38, s15
  v_mov_b32 v10, s14
  v_mov_b32 v11, s36
  v_mov_b32 v1, 0
  s_waitcnt vmcnt(0)
  s_mov_b64 exec, 1
  buffer_store_dwordx2 v[10:11], v1, s[16:19], s38 offen sc1
  s_mov_b64 exec, -1
  s_branch q0_fin
q0_k:
  s_lshl_b32 s27, s24, 12
  s_add_u32 s27, s27, 7966720
  v_mov_b32 v13, 0x3f803f80
  v_mov_b32 v14, 0x3f80
  s_nop 7
  v_cvt_pk_bf16_f32 v32, v64, v65
  v_cvt_pk_bf16_f32 v33, v66, v67
  v_cvt_pk_bf16_f32 v34, v68, v69
  v_cvt_pk_bf16_f32 v35, v70, v71
  v_cvt_pk_bf16_f32 v36, v72, v73
  v_cvt_pk_bf16_f32 v37, v74, v75
  v_cvt_pk_bf16_f32 v38, v76, v77
  v_cvt_pk_bf16_f32 v39, v78, v79
  v_cndmask_b32 v42, v38, v13, s[62:63]
  v_cndmask_b32 v43, v39, v14, s[62:63]
  v_mov_b32 v40, v36
  v_mov_b32 v41, v37
  buffer_store_dwordx4 v[32:35], v9, s[16:19], s27 offen sc1
  buffer_store_dwordx4 v[40:43], v9, s[16:19], s27 offen offset:1024 sc1
  v_cndmask_b32 v38, v38, 0, s[62:63]
  v_cndmask_b32 v39, v39, 0, s[62:63]
  v_dot2_f32_bf16 v12, v32, v32, 0
  v_dot2_f32_bf16 v12, v33, v33, v12
  v_dot2_f32_bf16 v12, v34, v34, v12
  v_dot2_f32_bf16 v12, v35, v35, v12
  v_dot2_f32_bf16 v12, v36, v36, v12
  v_dot2_f32_bf16 v12, v37, v37, v12
  v_dot2_f32_bf16 v12, v38, v38, v12
  v_dot2_f32_bf16 v12, v39, v39, v12
  s_nop 2
  v_mov_b32 v13, v12
  s_nop 1
  v_permlane32_swap_b32 v12, v13
  s_nop 1
  v_add_f32 v12, v12, v13
  s_nop 1
  v_max_f32_dpp v12, v12, v12 row_shr:1 row_mask:0xf bank_mask:0xf
  s_nop 1
  v_max_f32_dpp v12, v12, v12 row_shr:2 row_mask:0xf bank_mask:0xf
  s_nop 1
  v_max_f32_dpp v12, v12, v12 row_shr:4 row_mask:0xf bank_mask:0xf
  s_nop 1
  v_max_f32_dpp v12, v12, v12 row_shr:8 row_mask:0xf bank_mask:0xf
  s_nop 1
  v_readlane_b32 s36, v12, 15
  v_readlane_b32 s37, v12, 31
  s_nop 3
  s_max_u32 s36, s36, s37
  s_branch q0_end
q0_v:
  ds_read_b64_tr_b16 v[32:33], v10 offset:0
  ds_read_b64_tr_b16 v[34:35], v10 offset:256
  ds_read_b128 v[36:39], v8 offset:0
  ds_read_b64_tr_b16 v[40:41], v10 offset:1024
  ds_read_b64_tr_b16 v[42:43], v10 offset:1280
  ds_read_b128 v[44:47], v8 offset:1024
  ds_read_b64_tr_b16 v[48:49], v10 offset:2048
  ds_read_b64_tr_b16 v[50:51], v10 offset:2304
  ds_read_b128 v[52:55], v8 offset:2048
  ds_read_b64_tr_b16 v[56:57], v10 offset:3072
  ds_read_b64_tr_b16 v[58:59], v10 offset:3328
  ds_read_b128 v[60:63], v8 offset:3072
  s_waitcnt lgkmcnt(9)
  v_mfma_f32_32x32x16_bf16 v[64:79], v[36:39], v[32:35], 0
  ds_read_b64_tr_b16 v[32:33], v10 offset:4096
  ds_read_b64_tr_b16 v[34:35], v10 offset:4352
  ds_read_b128 v[36:39], v8 offset:4096
  s_waitcnt lgkmcnt(9)
  v_mfma_f32_32x32x16_bf16 v[64:79], v[44:47], v[40:43], v[64:79]
  ds_read_b64_tr_b16 v[40:41], v10 offset:5120
  ds_read_b64_tr_b16 v[42:43], v10 offset:5376
  ds_read_b128 v[44:47], v8 offset:5120
  s_waitcnt lgkmcnt(9)
  v_mfma_f32_32x32x16_bf16 v[64:79], v[52:55], v[48:51], v[64:79]
  ds_read_b64_tr_b16 v[48:49], v10 offset:6144
  ds_read_b64_tr_b16 v[50:51], v10 offset:6400
  ds_read_b128 v[52:55], v8 offset:6144
  s_waitcnt lgkmcnt(9)
  v_mfma_f32_32x32x16_bf16 v[64:79], v[60:63], v[56:59], v[64:79]
  ds_read_b64_tr_b16 v[56:57], v10 offset:7168
  ds_read_b64_tr_b16 v[58:59], v10 offset:7424
  ds_read_b128 v[60:63], v8 offset:7168
  s_waitcnt lgkmcnt(9)
  v_mfma_f32_32x32x16_bf16 v[64:79], v[36:39], v[32:35], v[64:79]
  ds_read_b64_tr_b16 v[32:33], v10 offset:8192
  ds_read_b64_tr_b16 v[34:35], v10 offset:8448
  ds_read_b128 v[36:39], v8 offset:8192
  s_waitcnt lgkmcnt(9)
  v_mfma_f32_32x32x16_bf16 v[64:79], v[44:47], v[40:43], v[64:79]
  ds_read_b64_tr_b16 v[40:41], v10 offset:9216
  ds_read_b64_tr_b16 v[42:43], v10 offset:9472
  ds_read_b128 v[44:47], v8 offset:9216
  s_waitcnt lgkmcnt(9)
  v_mfma_f32_32x32x16_bf16 v[64:79], v[52:55], v[48:51], v[64:79]
  ds_read_b64_tr_b16 v[48:49], v10 offset:10240
  ds_read_b64_tr_b16 v[50:51], v10 offset:10496
  ds_read_b128 v[52:55], v8 offset:10240
  s_waitcnt lgkmcnt(9)
  v_mfma_f32_32x32x16_bf16 v[64:79], v[60:63], v[56:59], v[64:79]
  ds_read_b64_tr_b16 v[56:57], v10 offset:11264
  ds_read_b64_tr_b16 v[58:59], v10 offset:11520
  ds_read_b128 v[60:63], v8 offset:11264
  s_waitcnt lgkmcnt(9)
  v_mfma_f32_32x32x16_bf16 v[64:79], v[36:39], v[32:35], v[64:79]
  ds_read_b64_tr_b16 v[32:33], v10 offset:12288
  ds_read_b64_tr_b16 v[34:35], v10 offset:12544
  ds_read_b128 v[36:39], v8 offset:12288
  s_waitcnt lgkmcnt(9)
  v_mfma_f32_32x32x16_bf16 v[64:79], v[44:47], v[40:43], v[64:79]
  ds_read_b64_tr_b16 v[40:41], v10 offset:13312
  ds_read_b64_tr_b16 v[42:43], v10 offset:13568
  ds_read_b128 v[44:47], v8 offset:13312
  s_waitcnt lgkmcnt(9)
  v_mfma_f32_32x32x16_bf16 v[64:79], v[52:55], v[48:51], v[64:79]
  ds_read_b64_tr_b16 v[48:49], v10 offset:14336
  ds_read_b64_tr_b16 v[50:51], v10 offset:14592
  ds_read_b128 v[52:55], v8 offset:14336
  s_waitcnt lgkmcnt(9)
  v_mfma_f32_32x32x16_bf16 v[64:79], v[60:63], v[56:59], v[64:79]
  ds_read_b64_tr_b16 v[56:57], v10 offset:15360
  ds_read_b64_tr_b16 v[58:59], v10 offset:15616
  ds_read_b128 v[60:63], v8 offset:15360
  s_waitcnt lgkmcnt(9)
  v_mfma_f32_32x32x16_bf16 v[64:79], v[36:39], v[32:35], v[64:79]
  ds_read_b64_tr_b16 v[32:33], v10 offset:16384
  ds_read_b64_tr_b16 v[34:35], v10 offset:16640
  ds_read_b128 v[36:39], v8 offset:16384
  s_waitcnt lgkmcnt(9)
  v_mfma_f32_32x32x16_bf16 v[64:79], v[44:47], v[40:43], v[64:79]
  ds_read_b64_tr_b16 v[40:41], v10 offset:17408
  ds_read_b64_tr_b16 v[42:43], v10 offset:17664
  ds_read_b128 v[44:47], v8 offset:17408
  s_waitcnt lgkmcnt(9)
  v_mfma_f32_32x32x16_bf16 v[64:79], v[52:55], v[48:51], v[64:79]
  ds_read_b64_tr_b16 v[48:49], v10 offset:18432
  ds_read_b64_tr_b16 v[50:51], v10 offset:18688
  ds_read_b128 v[52:55], v8 offset:18432
  s_waitcnt lgkmcnt(9)
  v_mfma_f32_32x32x16_bf16 v[64:79], v[60:63], v[56:59], v[64:79]
  ds_read_b64_tr_b16 v[56:57], v10 offset:19456
  ds_read_b64_tr_b16 v[58:59], v10 offset:19712
  ds_read_b128 v[60:63], v8 offset:19456
  s_waitcnt lgkmcnt(9)
  v_mfma_f32_32x32x16_bf16 v[64:79], v[36:39], v[32:35], v[64:79]
  ds_read_b64_tr_b16 v[32:33], v10 offset:20480
  ds_read_b64_tr_b16 v[34:35], v10 offset:20736
  ds_read_b128 v[36:39], v8 offset:20480
  s_waitcnt lgkmcnt(9)
  v_mfma_f32_32x32x16_bf16 v[64:79], v[44:47], v[40:43], v[64:79]
  ds_read_b64_tr_b16 v[40:41], v10 offset:21504
  ds_read_b64_tr_b16 v[42:43], v10 offset:21760
  ds_read_b128 v[44:47], v8 offset:21504
  s_waitcnt lgkmcnt(9)
  v_mfma_f32_32x32x16_bf16 v[64:79], v[52:55], v[48:51], v[64:79]
  ds_read_b64_tr_b16 v[48:49], v10 offset:22528
  ds_read_b64_tr_b16 v[50:51], v10 offset:22784
  ds_read_b128 v[52:55], v8 offset:22528
  s_waitcnt lgkmcnt(9)
  v_mfma_f32_32x32x16_bf16 v[64:79], v[60:63], v[56:59], v[64:79]
  ds_read_b64_tr_b16 v[56:57], v10 offset:23552
  ds_read_b64_tr_b16 v[58:59], v10 offset:23808
  ds_read_b128 v[60:63], v8 offset:23552
  s_waitcnt lgkmcnt(9)
  v_mfma_f32_32x32x16_bf16 v[64:79], v[36:39], v[32:35], v[64:79]
  ds_read_b64_tr_b16 v[32:33], v10 offset:24576
  ds_read_b64_tr_b16 v[34:35], v10 offset:24832
  ds_read_b128 v[36:39], v8 offset:24576
  s_waitcnt lgkmcnt(9)
  v_mfma_f32_32x32x16_bf16 v[64:79], v[44:47], v[40:43], v[64:79]
  ds_read_b64_tr_b16 v[40:41], v10 offset:25600
  ds_read_b64_tr_b16 v[42:43], v10 offset:25856
  ds_read_b128 v[44:47], v8 offset:25600
  s_waitcnt lgkmcnt(9)
  v_mfma_f32_32x32x16_bf16 v[64:79], v[52:55], v[48:51], v[64:79]
  ds_read_b64_tr_b16 v[48:49], v10 offset:26624
  ds_read_b64_tr_b16 v[50:51], v10 offset:26880
  ds_read_b128 v[52:55], v8 offset:26624
  s_waitcnt lgkmcnt(9)
  v_mfma_f32_32x32x16_bf16 v[64:79], v[60:63], v[56:59], v[64:79]
  ds_read_b64_tr_b16 v[56:57], v10 offset:27648
  ds_read_b64_tr_b16 v[58:59], v10 offset:27904
  ds_read_b128 v[60:63], v8 offset:27648
  s_waitcnt lgkmcnt(9)
  v_mfma_f32_32x32x16_bf16 v[64:79], v[36:39], v[32:35], v[64:79]
  s_waitcnt lgkmcnt(6)
  v_mfma_f32_32x32x16_bf16 v[64:79], v[44:47], v[40:43], v[64:79]
  s_waitcnt lgkmcnt(3)
  v_mfma_f32_32x32x16_bf16 v[64:79], v[52:55], v[48:51], v[64:79]
  s_waitcnt lgkmcnt(0)
  v_mfma_f32_32x32x16_bf16 v[64:79], v[60:63], v[56:59], v[64:79]
  s_lshl_b32 s27, s24, 12
  s_add_u32 s27, s27, 7966720
  v_cmp_eq_u32 vcc, 28, v3
  v_mov_b32 v13, 0x3f803f80
  s_mov_b32 s36, 0
  v_cndmask_b32 v13, 0, v13, vcc
  v_cmp_lt_u32 vcc, 27, v3
  s_nop 7
  v_cvt_pk_bf16_f32 v32, v64, v65
  v_cvt_pk_bf16_f32 v33, v66, v67
  v_cvt_pk_bf16_f32 v34, v68, v69
  v_cvt_pk_bf16_f32 v35, v70, v71
  v_cvt_pk_bf16_f32 v36, v72, v73
  v_cvt_pk_bf16_f32 v37, v74, v75
  v_cvt_pk_bf16_f32 v38, v76, v77
  v_cvt_pk_bf16_f32 v39, v78, v79
  v_cndmask_b32 v32, v32, v13, vcc
  v_cndmask_b32 v33, v33, v13, vcc
  v_cndmask_b32 v34, v34, v13, vcc
  v_cndmask_b32 v35, v35, v13, vcc
  v_cndmask_b32 v36, v36, v13, vcc
  v_cndmask_b32 v37, v37, v13, vcc
  v_cndmask_b32 v38, v38, v13, vcc
  v_cndmask_b32 v39, v39, v13, vcc
  buffer_store_dwordx4 v[32:35], v9, s[16:19], s27 offen offset:2048 sc1
  buffer_store_dwordx4 v[36:39], v9, s[16:19], s27 offen offset:3072 sc1
q0_end:
  v_readfirstlane_b32 s14, v120
  v_mov_b32 v1, 0
  s_mov_b32 s39, 200000
  s_cmp_lg_u32 s14, 0
  s_cbranch_scc1 L_tagdT2
L_tagT2:
  buffer_load_dword v10, v1, s[4:7], 0 offen sc1
  s_waitcnt vmcnt(0)
  v_readfirstlane_b32 s14, v10
  s_sub_u32 s39, s39, 1
  s_cmp_eq_u32 s39, 0
  s_cbranch_scc1 L_tagdT2
  s_cmp_eq_u32 s14, 0
  s_cbranch_scc1 L_tagT2
L_tagdT2:
  s_and_b32 s35, s3, 1
  s_lshl_b32 s37, s24, 4
  s_add_u32 s35, s35, s37
  s_lshl_b32 s35, s35, 3
  s_add_u32 s38, s35, 21618688
  s_add_u32 s38, s38, s15
  v_mov_b32 v10, s14
  v_mov_b32 v11, s36
  v_mov_b32 v1, 0
  s_waitcnt vmcnt(0)
  s_mov_b64 exec, 1
  buffer_store_dwordx2 v[10:11], v1, s[16:19], s38 offen sc1
  s_mov_b64 exec, -1
q0_fin:
  s_lshr_b32 s11, s2, 3
  s_mul_i32 s26, s11, 9363
  s_lshr_b32 s26, s26, 16
  s_mul_i32 s27, s26, 7
  s_sub_u32 s25, s11, s27
  s_min_u32 s26, s26, 3
  s_and_b32 s24, s2, 7
  s_lshl_b32 s24, s24, 2
  s_add_u32 s24, s24, s26
  s_lshr_b32 s26, s3, 1
  s_and_b32 s27, s3, 1
  s_lshl_b32 s24, s24, 1
  s_lshl_b32 s25, s25, 1
  s_add_u32 s24, s24, s26
  s_add_u32 s25, s25, s27
  s_xor_b32 s26, s24, 1
  s_xor_b32 s27, s25, 1
  s_mov_b32 s20, s40
  s_mov_b32 s21, s41
  s_mov_b32 s22, 0x1c0000
  s_mov_b32 s23, 0x20000
  v_mul_u32_u24 v5, 896, v3
  v_lshl_add_u32 v5, v4, 3, v5
  s_mul_i32 s37, s24, 28672
  s_lshl_b32 s38, s25, 6
  s_add_u32 s37, s37, s38
  buffer_load_dwordx2 a[248:249], v5, s[20:23], s37 offen offset:0
  buffer_load_dwordx2 a[250:251], v5, s[20:23], s37 offen offset:16
  buffer_load_dwordx2 a[252:253], v5, s[20:23], s37 offen offset:32
  buffer_load_dwordx2 a[254:255], v5, s[20:23], s37 offen offset:48
  s_and_b32 s24, s2, 7
  s_lshr_b32 s25, s2, 5
  s_lshl_b32 s24, s24, 3
  s_add_u32 s24, s24, s25
  s_bfe_u32 s26, s2, 0x20003
  s_lshl_b32 s26, s26, 2
  s_add_u32 s26, s26, s3
  v_bfe_u32 v10, v2, 2, 2
  v_lshl_add_u32 v10, v4, 2, v10
  v_lshlrev_b32 v10, 6, v10
  v_bfe_u32 v11, v2, 4, 1
  v_lshl_add_u32 v10, v11, 5, v10
  v_and_b32 v11, 3, v2
  v_lshl_add_u32 v10, v11, 3, v10
  s_mul_i32 s27, s3, 28672
  v_add_u32 v10, s27, v10
  s_cmp_gt_u32 s24, 28
  s_cbranch_scc1 L_qp_e
  s_cmp_eq_u32 s24, 28
  s_cbranch_scc1 L_qp_c
  s_lshl_b32 s27, s24, 10
  v_add_u32 v10, s27, v10
  ds_read_b64_tr_b16 v[16:17], v10
  ds_read_b64_tr_b16 v[18:19], v10 offset:512
  s_mul_i32 s27, s26, 28
  s_add_u32 s27, s27, s24
  s_lshl_b32 s27, s27, 10
  s_add_u32 s27, s27, 5394432
  s_waitcnt lgkmcnt(0)
  buffer_store_dwordx4 v[16:19], v9, s[16:19], s27 offen sc1
  s_branch L_qp_e
L_qp_c:
  v_mov_b32 v16, 0x3f803f80
  v_mov_b32 v17, 0x3f803f80
  v_mov_b32 v18, 0x3f803f80
  v_mov_b32 v19, 0x3f803f80
  ds_read_b64_tr_b16 v[32:33], v10 offset:0
  ds_read_b64_tr_b16 v[34:35], v10 offset:512
  ds_read_b64_tr_b16 v[36:37], v10 offset:1024
  ds_read_b64_tr_b16 v[38:39], v10 offset:1536
  s_waitcnt lgkmcnt(2)
  v_mfma_f32_32x32x16_bf16 v[64:79], v[16:19], v[32:35], 0
  ds_read_b64_tr_b16 v[40:41], v10 offset:2048
  ds_read_b64_tr_b16 v[42:43], v10 offset:2560
  s_waitcnt lgkmcnt(2)
  v_mfma_f32_32x32x16_bf16 v[64:79], v[16:19], v[36:39], v[64:79]
  ds_read_b64_tr_b16 v[44:45], v10 offset:3072
  ds_read_b64_tr_b16 v[46:47], v10 offset:3584
  s_waitcnt lgkmcnt(2)
  v_mfma_f32_32x32x16_bf16 v[64:79], v[16:19], v[40:43], v[64:79]
  ds_read_b64_tr_b16 v[32:33], v10 offset:4096
  ds_read_b64_tr_b16 v[34:35], v10 offset:4608
  s_waitcnt lgkmcnt(2)
  v_mfma_f32_32x32x16_bf16 v[64:79], v[16:19], v[44:47], v[64:79]
  ds_read_b64_tr_b16 v[36:37], v10 offset:5120
  ds_read_b64_tr_b16 v[38:39], v10 offset:5632
  s_waitcnt lgkmcnt(2)
  v_mfma_f32_32x32x16_bf16 v[64:79], v[16:19], v[32:35], v[64:79]
  ds_read_b64_tr_b16 v[40:41], v10 offset:6144
  ds_read_b64_tr_b16 v[42:43], v10 offset:6656
  s_waitcnt lgkmcnt(2)
  v_mfma_f32_32x32x16_bf16 v[64:79], v[16:19], v[36:39], v[64:79]
  ds_read_b64_tr_b16 v[44:45], v10 offset:7168
  ds_read_b64_tr_b16 v[46:47], v10 offset:7680
  s_waitcnt lgkmcnt(2)
  v_mfma_f32_32x32x16_bf16 v[64:79], v[16:19], v[40:43], v[64:79]
  ds_read_b64_tr_b16 v[32:33], v10 offset:8192
  ds_read_b64_tr_b16 v[34:35], v10 offset:8704
  s_waitcnt lgkmcnt(2)
  v_mfma_f32_32x32x16_bf16 v[64:79], v[16:19], v[44:47], v[64:79]
  ds_read_b64_tr_b16 v[36:37], v10 offset:9216
  ds_read_b64_tr_b16 v[38:39], v10 offset:9728
  s_waitcnt lgkmcnt(2)
  v_mfma_f32_32x32x16_bf16 v[64:79], v[16:19], v[32:35], v[64:79]
  ds_read_b64_tr_b16 v[40:41], v10 offset:10240
  ds_read_b64_tr_b16 v[42:43], v10 offset:10752
  s_waitcnt lgkmcnt(2)
  v_mfma_f32_32x32x16_bf16 v[64:79], v[16:19], v[36:39], v[64:79]
  ds_read_b64_tr_b16 v[44:45], v10 offset:11264
  ds_read_b64_tr_b16 v[46:47], v10 offset:11776
  s_waitcnt lgkmcnt(2)
  v_mfma_f32_32x32x16_bf16 v[64:79], v[16:19], v[40:43], v[64:79]
  ds_read_b64_tr_b16 v[32:33], v10 offset:12288
  ds_read_b64_tr_b16 v[34:35], v10 offset:12800
  s_waitcnt lgkmcnt(2)
  v_mfma_f32_32x32x16_bf16 v[64:79], v[16:19], v[44:47], v[64:79]
  ds_read_b64_tr_b16 v[36:37], v10 offset:13312
  ds_read_b64_tr_b16 v[38:39], v10 offset:13824
  s_waitcnt lgkmcnt(2)
  v_mfma_f32_32x32x16_bf16 v[64:79], v[16:19], v[32:35], v[64:79]
  ds_read_b64_tr_b16 v[40:41], v10 offset:14336
  ds_read_b64_tr_b16 v[42:43], v10 offset:14848
  s_waitcnt lgkmcnt(2)
  v_mfma_f32_32x32x16_bf16 v[64:79], v[16:19], v[36:39], v[64:79]
  ds_read_b64_tr_b16 v[44:45], v10 offset:15360
  ds_read_b64_tr_b16 v[46:47], v10 offset:15872
  s_waitcnt lgkmcnt(2)
  v_mfma_f32_32x32x16_bf16 v[64:79], v[16:19], v[40:43], v[64:79]
  ds_read_b64_tr_b16 v[32:33], v10 offset:16384
  ds_read_b64_tr_b16 v[34:35], v10 offset:16896
  s_waitcnt lgkmcnt(2)
  v_mfma_f32_32x32x16_bf16 v[64:79], v[16:19], v[44:47], v[64:79]
  ds_read_b64_tr_b16 v[36:37], v10 offset:17408
  ds_read_b64_tr_b16 v[38:39], v10 offset:17920
  s_waitcnt lgkmcnt(2)
  v_mfma_f32_32x32x16_bf16 v[64:79], v[16:19], v[32:35], v[64:79]
  ds_read_b64_tr_b16 v[40:41], v10 offset:18432
  ds_read_b64_tr_b16 v[42:43], v10 offset:18944
  s_waitcnt lgkmcnt(2)
  v_mfma_f32_32x32x16_bf16 v[64:79], v[16:19], v[36:39], v[64:79]
  ds_read_b64_tr_b16 v[44:45], v10 offset:19456
  ds_read_b64_tr_b16 v[46:47], v10 offset:19968
  s_waitcnt lgkmcnt(2)
  v_mfma_f32_32x32x16_bf16 v[64:79], v[16:19], v[40:43], v[64:79]
  ds_read_b64_tr_b16 v[32:33], v10 offset:20480
  ds_read_b64_tr_b16 v[34:35], v10 offset:20992
  s_waitcnt lgkmcnt(2)
  v_mfma_f32_32x32x16_bf16 v[64:79], v[16:19], v[44:47], v[64:79]
  ds_read_b64_tr_b16 v[36:37], v10 offset:21504
  ds_read_b64_tr_b16 v[38:39], v10 offset:22016
  s_waitcnt lgkmcnt(2)
  v_mfma_f32_32x32x16_bf16 v[64:79], v[16:19], v[32:35], v[64:79]
  ds_read_b64_tr_b16 v[40:41], v10 offset:22528
  ds_read_b64_tr_b16 v[42:43], v10 offset:23040
  s_waitcnt lgkmcnt(2)
  v_mfma_f32_32x32x16_bf16 v[64:79], v[16:19], v[36:39], v[64:79]
  ds_read_b64_tr_b16 v[44:45], v10 offset:23552
  ds_read_b64_tr_b16 v[46:47], v10 offset:24064
  s_waitcnt lgkmcnt(2)
  v_mfma_f32_32x32x16_bf16 v[64:79], v[16:19], v[40:43], v[64:79]
  ds_read_b64_tr_b16 v[32:33], v10 offset:24576
  ds_read_b64_tr_b16 v[34:35], v10 offset:25088
  s_waitcnt lgkmcnt(2)
  v_mfma_f32_32x32x16_bf16 v[64:79], v[16:19], v[44:47], v[64:79]
  ds_read_b64_tr_b16 v[36:37], v10 offset:25600
  ds_read_b64_tr_b16 v[38:39], v10 offset:26112
  s_waitcnt lgkmcnt(2)
  v_mfma_f32_32x32x16_bf16 v[64:79], v[16:19], v[32:35], v[64:79]
  ds_read_b64_tr_b16 v[40:41], v10 offset:26624
  ds_read_b64_tr_b16 v[42:43], v10 offset:27136
  s_waitcnt lgkmcnt(2)
  v_mfma_f32_32x32x16_bf16 v[64:79], v[16:19], v[36:39], v[64:79]
  ds_read_b64_tr_b16 v[44:45], v10 offset:27648
  ds_read_b64_tr_b16 v[46:47], v10 offset:28160
  s_waitcnt lgkmcnt(2)
  v_mfma_f32_32x32x16_bf16 v[64:79], v[16:19], v[40:43], v[64:79]
  s_waitcnt lgkmcnt(0)
  v_mfma_f32_32x32x16_bf16 v[64:79], v[16:19], v[44:47], v[64:79]
  s_lshl_b32 s27, s26, 10
  s_add_u32 s27, s27, 5853184
  v_mov_b32 v22, 0
  v_mov_b32 v23, 0
  s_nop 7
  s_nop 3
  v_cvt_pk_bf16_f32 v21, v64, 0
  v_lshlrev_b32 v20, 16, v21
  v_sub_f32 v20, v64, v20
  v_cvt_pk_bf16_f32 v20, v64, v20
  v_cndmask_b32 v21, v21, 0, s[62:63]
  v_cndmask_b32 v20, v20, 0, s[62:63]
  buffer_store_dwordx4 v[20:23], v9, s[16:19], s27 offen sc1
L_qp_e:
  s_mul_i32 s28, s3, 28672
  v_add_u32 v10, s28, v9
  v_bfe_u32 v5, v2, 4, 1
  v_bfe_u32 v7, v2, 2, 2
  v_and_b32 v8, 3, v2
  v_lshl_add_u32 v6, v4, 2, v7
  v_lshlrev_b32 v6, 7, v6
  v_lshl_add_u32 v6, v8, 3, v6
  ds_write_b128 v10, a[0:3] offset:0
  ds_write_b128 v10, a[4:7] offset:1024
  ds_write_b128 v10, a[8:11] offset:2048
  ds_write_b128 v10, a[12:15] offset:3072
  ds_write_b128 v10, a[16:19] offset:4096
  ds_write_b128 v10, a[20:23] offset:5120
  ds_write_b128 v10, a[24:27] offset:6144
  s_waitcnt lgkmcnt(0)
  s_barrier
  s_cmp_ge_u32 s101, 238
  s_cbranch_scc1 L_pf_e
  s_cmp_ge_u32 s101, 112
  s_cbranch_scc1 L_pf_b
  v_mul_u32_u24 v11, 57344, v5
  v_add_u32 v11, v11, v6
  s_lshl_b32 s28, s3, 5
  v_add_u32 v11, s28, v11
  s_and_b32 s25, s101, 3
  s_and_b32 s26, s101, 0xfc
  s_add_u32 s26, s26, s3
  s_mul_i32 s27, s26, 28
  s_mul_i32 s28, s25, 7
  s_add_u32 s27, s27, s28
  s_lshl_b32 s27, s27, 10
  s_add_u32 s27, s27, 0
  v_mov_b32 v12, 0
  ds_read_b64_tr_b16 v[16:17], v11 offset:0
  ds_read_b64_tr_b16 v[18:19], v11 offset:1024
  ds_read_b64_tr_b16 v[20:21], v11 offset:2048
  ds_read_b64_tr_b16 v[22:23], v11 offset:3072
  ds_read_b64_tr_b16 v[24:25], v11 offset:4096
  ds_read_b64_tr_b16 v[26:27], v11 offset:5120
  ds_read_b64_tr_b16 v[28:29], v11 offset:6144
  ds_read_b64_tr_b16 v[30:31], v11 offset:28672
  ds_read_b64_tr_b16 v[32:33], v11 offset:29696
  ds_read_b64_tr_b16 v[34:35], v11 offset:30720
  ds_read_b64_tr_b16 v[36:37], v11 offset:31744
  ds_read_b64_tr_b16 v[38:39], v11 offset:32768
  ds_read_b64_tr_b16 v[40:41], v11 offset:33792
  ds_read_b64_tr_b16 v[42:43], v11 offset:34816
  s_waitcnt lgkmcnt(12)
  buffer_store_dwordx4 v[16:19], v9, s[16:19], s27 offen sc1
  s_add_u32 s27, s27, 1024
  v_lshlrev_b32 v13, 16, v16
  v_and_b32 v14, 0xffff0000, v16
  v_add_f32 v12, v12, v13
  v_add_f32 v12, v12, v14
  v_lshlrev_b32 v13, 16, v17
  v_and_b32 v14, 0xffff0000, v17
  v_add_f32 v12, v12, v13
  v_add_f32 v12, v12, v14
  v_lshlrev_b32 v13, 16, v18
  v_and_b32 v14, 0xffff0000, v18
  v_add_f32 v12, v12, v13
  v_add_f32 v12, v12, v14
  v_lshlrev_b32 v13, 16, v19
  v_and_b32 v14, 0xffff0000, v19
  v_add_f32 v12, v12, v13
  v_add_f32 v12, v12, v14
  s_waitcnt lgkmcnt(10)
  buffer_store_dwordx4 v[20:23], v9, s[16:19], s27 offen sc1
  s_add_u32 s27, s27, 1024
  v_lshlrev_b32 v13, 16, v20
  v_and_b32 v14, 0xffff0000, v20
  v_add_f32 v12, v12, v13
  v_add_f32 v12, v12, v14
  v_lshlrev_b32 v13, 16, v21
  v_and_b32 v14, 0xffff0000, v21
  v_add_f32 v12, v12, v13
  v_add_f32 v12, v12, v14
  v_lshlrev_b32 v13, 16, v22
  v_and_b32 v14, 0xffff0000, v22
  v_add_f32 v12, v12, v13
  v_add_f32 v12, v12, v14
  v_lshlrev_b32 v13, 16, v23
  v_and_b32 v14, 0xffff0000, v23
  v_add_f32 v12, v12, v13
  v_add_f32 v12, v12, v14
  s_waitcnt lgkmcnt(8)
  buffer_store_dwordx4 v[24:27], v9, s[16:19], s27 offen sc1
  s_add_u32 s27, s27, 1024
  v_lshlrev_b32 v13, 16, v24
  v_and_b32 v14, 0xffff0000, v24
  v_add_f32 v12, v12, v13
  v_add_f32 v12, v12, v14
  v_lshlrev_b32 v13, 16, v25
  v_and_b32 v14, 0xffff0000, v25
  v_add_f32 v12, v12, v13
  v_add_f32 v12, v12, v14
  v_lshlrev_b32 v13, 16, v26
  v_and_b32 v14, 0xffff0000, v26
  v_add_f32 v12, v12, v13
  v_add_f32 v12, v12, v14
  v_lshlrev_b32 v13, 16, v27
  v_and_b32 v14, 0xffff0000, v27
  v_add_f32 v12, v12, v13
  v_add_f32 v12, v12, v14
  s_waitcnt lgkmcnt(6)
  buffer_store_dwordx4 v[28:31], v9, s[16:19], s27 offen sc1
  s_add_u32 s27, s27, 1024
  v_lshlrev_b32 v13, 16, v28
  v_and_b32 v14, 0xffff0000, v28
  v_add_f32 v12, v12, v13
  v_add_f32 v12, v12, v14
  v_lshlrev_b32 v13, 16, v29
  v_and_b32 v14, 0xffff0000, v29
  v_add_f32 v12, v12, v13
  v_add_f32 v12, v12, v14
  v_lshlrev_b32 v13, 16, v30
  v_and_b32 v14, 0xffff0000, v30
  v_add_f32 v12, v12, v13
  v_add_f32 v12, v12, v14
  v_lshlrev_b32 v13, 16, v31
  v_and_b32 v14, 0xffff0000, v31
  v_add_f32 v12, v12, v13
  v_add_f32 v12, v12, v14
  s_waitcnt lgkmcnt(4)
  buffer_store_dwordx4 v[32:35], v9, s[16:19], s27 offen sc1
  s_add_u32 s27, s27, 1024
  v_lshlrev_b32 v13, 16, v32
  v_and_b32 v14, 0xffff0000, v32
  v_add_f32 v12, v12, v13
  v_add_f32 v12, v12, v14
  v_lshlrev_b32 v13, 16, v33
  v_and_b32 v14, 0xffff0000, v33
  v_add_f32 v12, v12, v13
  v_add_f32 v12, v12, v14
  v_lshlrev_b32 v13, 16, v34
  v_and_b32 v14, 0xffff0000, v34
  v_add_f32 v12, v12, v13
  v_add_f32 v12, v12, v14
  v_lshlrev_b32 v13, 16, v35
  v_and_b32 v14, 0xffff0000, v35
  v_add_f32 v12, v12, v13
  v_add_f32 v12, v12, v14
  s_waitcnt lgkmcnt(2)
  buffer_store_dwordx4 v[36:39], v9, s[16:19], s27 offen sc1
  s_add_u32 s27, s27, 1024
  v_lshlrev_b32 v13, 16, v36
  v_and_b32 v14, 0xffff0000, v36
  v_add_f32 v12, v12, v13
  v_add_f32 v12, v12, v14
  v_lshlrev_b32 v13, 16, v37
  v_and_b32 v14, 0xffff0000, v37
  v_add_f32 v12, v12, v13
  v_add_f32 v12, v12, v14
  v_lshlrev_b32 v13, 16, v38
  v_and_b32 v14, 0xffff0000, v38
  v_add_f32 v12, v12, v13
  v_add_f32 v12, v12, v14
  v_lshlrev_b32 v13, 16, v39
  v_and_b32 v14, 0xffff0000, v39
  v_add_f32 v12, v12, v13
  v_add_f32 v12, v12, v14
  s_waitcnt lgkmcnt(0)
  buffer_store_dwordx4 v[40:43], v9, s[16:19], s27 offen sc1
  s_add_u32 s27, s27, 1024
  v_lshlrev_b32 v13, 16, v40
  v_and_b32 v14, 0xffff0000, v40
  v_add_f32 v12, v12, v13
  v_add_f32 v12, v12, v14
  v_lshlrev_b32 v13, 16, v41
  v_and_b32 v14, 0xffff0000, v41
  v_add_f32 v12, v12, v13
  v_add_f32 v12, v12, v14
  v_lshlrev_b32 v13, 16, v42
  v_and_b32 v14, 0xffff0000, v42
  v_add_f32 v12, v12, v13
  v_add_f32 v12, v12, v14
  v_lshlrev_b32 v13, 16, v43
  v_and_b32 v14, 0xffff0000, v43
  v_add_f32 v12, v12, v13
  v_add_f32 v12, v12, v14
  v_mov_b32 v13, v12
  s_nop 1
  v_permlane32_swap_b32 v12, v13
  s_nop 1
  v_add_f32 v12, v12, v13
  v_cvt_pk_bf16_f32 v13, v12, 0
  v_lshlrev_b32 v14, 16, v13
  v_sub_f32 v14, v12, v14
  v_cvt_pk_bf16_f32 v12, v12, v14
  v_lshlrev_b32 v15, 4, v3
  s_lshl_b32 s26, s26, 10
  s_lshr_b32 s27, s25, 1
  s_lshl_b32 s27, s27, 9
  s_and_b32 s28, s25, 1
  s_lshl_b32 s28, s28, 3
  s_add_u32 s26, s26, s27
  s_add_u32 s26, s26, s28
  s_add_u32 s26, s26, 3211264
  buffer_store_dwordx2 v[12:13], v15, s[16:19], s26 offen sc1
  s_branch L_pf_e
L_pf_b:
  s_sub_u32 s24, s101, 112
  s_cmp_ge_u32 s24, 98
  s_cselect_b32 s31, 32, 112
  s_mov_b32 s32, 3325952
  s_cselect_b32 s32, 4931584, s32
  s_cselect_b32 s33, 98, 0
  s_sub_u32 s24, s24, s33
  s_mul_i32 s25, s24, 9363
  s_lshr_b32 s25, s25, 16
  s_mul_i32 s26, s25, 7
  s_sub_u32 s24, s24, s26
  s_lshl_b32 s26, s25, 2
  s_add_u32 s26, s26, s3
  v_lshl_add_u32 v11, v5, 5, v6
  v_add_u32 v11, s28, v11
  s_lshl_b32 s24, s24, 1
  s_mul_i32 s27, s24, s31
  s_lshl_b32 s26, s26, 1
  s_add_u32 s27, s27, s26
  s_lshl_b32 s27, s27, 10
  s_add_u32 s27, s27, s32
  s_lshl_b32 s31, s31, 10
  s_add_u32 s28, s27, s31
  ds_read_b64_tr_b16 v[16:17], v11 offset:0
  ds_read_b64_tr_b16 v[18:19], v11 offset:1024
  ds_read_b64_tr_b16 v[20:21], v11 offset:2048
  ds_read_b64_tr_b16 v[22:23], v11 offset:3072
  ds_read_b64_tr_b16 v[24:25], v11 offset:64
  ds_read_b64_tr_b16 v[26:27], v11 offset:1088
  ds_read_b64_tr_b16 v[28:29], v11 offset:2112
  ds_read_b64_tr_b16 v[30:31], v11 offset:3136
  s_waitcnt lgkmcnt(0)
  buffer_store_dwordx4 v[16:19], v9, s[16:19], s27 offen offset:0 sc1
  buffer_store_dwordx4 v[20:23], v9, s[16:19], s27 offen offset:1024 sc1
  buffer_store_dwordx4 v[24:27], v9, s[16:19], s28 offen offset:0 sc1
  buffer_store_dwordx4 v[28:31], v9, s[16:19], s28 offen offset:1024 sc1
L_pf_e:
  s_lshr_b32 s11, s2, 3
  s_mul_i32 s26, s11, 9363
  s_lshr_b32 s26, s26, 16
  s_mul_i32 s27, s26, 7
  s_sub_u32 s25, s11, s27
  s_min_u32 s26, s26, 3
  s_and_b32 s24, s2, 7
  s_lshl_b32 s24, s24, 2
  s_add_u32 s24, s24, s26
  s_lshr_b32 s26, s3, 1
  s_and_b32 s27, s3, 1
  s_lshl_b32 s24, s24, 1
  s_lshl_b32 s25, s25, 1
  s_add_u32 s24, s24, s26
  s_add_u32 s25, s25, s27
  s_xor_b32 s26, s24, 1
  s_xor_b32 s27, s25, 1
  s_lshl_b32 s36, s3, 3
  s_lshl_b32 s96, s25, 5
  s_lshl_b32 s97, s27, 5
  s_add_u32 s96, s96, s36
  s_add_u32 s97, s97, s36
  s_lshl_b32 s96, s96, 10
  s_lshl_b32 s97, s97, 10
  s_add_u32 s96, s96, 4931584
  s_add_u32 s97, s97, 4931584
  s_mul_i32 s36, s3, 28
  s_mul_i32 s98, s25, 112
  s_mul_i32 s99, s27, 112
  s_add_u32 s98, s98, s36
  s_add_u32 s99, s99, s36
  s_lshl_b32 s98, s98, 10
  s_lshl_b32 s99, s99, 10
  s_add_u32 s98, s98, 3325952
  s_add_u32 s99, s99, 3325952
  s_and_b32 s100, s11, 15
  s_mul_i32 s100, s100, 200704
  s_mul_i32 s101, s3, 7168
  s_add_u32 s100, s100, s101
  s_add_u32 s100, s100, 0
  s_mul_i32 s4, s24, 28
  s_lshl_b32 s36, s25, 1
  s_add_u32 s4, s4, s36
  s_lshl_b32 s4, s4, 10
  s_add_u32 s4, s4, 0
  s_add_u32 s4, s4, 10330112
  s_mul_i32 s6, s24, 14
  s_add_u32 s6, s6, s25
  s_lshl_b32 s6, s6, 8
  s_add_u32 s6, s6, 0
  s_add_u32 s6, s6, 14000128
  s_and_b32 s7, s2, 7
  s_lshl_b32 s7, s7, 1
  s_lshr_b32 s36, s11, 4
  s_add_u32 s7, s7, s36
  s_lshl_b32 s7, s7, 2
  s_add_u32 s7, s7, s3
  s_mul_i32 s7, s7, 112
  s_and_b32 s36, s11, 15
  s_mul_i32 s36, s36, 7
  s_add_u32 s7, s7, s36
  s_lshl_b32 s7, s7, 10
  s_add_u32 s7, s7, 0
  s_add_u32 s7, s7, 14229504
  v_lshrrev_b32 v6, 2, v2
  v_lshlrev_b32 v6, 7, v6
  v_lshrrev_b32 v7, 3, v2
  v_lshlrev_b32 v7, 13, v7
  v_add_u32 v7, s9, v7
  s_and_b32 s5, s11, 15
  s_mul_i32 s5, s5, 7168
  s_add_u32 s5, s5, 3211264
  s_and_b32 s24, s2, 7
  s_lshr_b32 s25, s2, 5
  s_lshl_b32 s24, s24, 3
  s_add_u32 s24, s24, s25
  s_bfe_u32 s26, s2, 0x20003
  s_lshl_b32 s8, s24, 2
  s_add_u32 s8, s8, s26
  s_lshl_b32 s8, s8, 2
  s_add_u32 s8, s8, s3
  s_lshl_b32 s8, s8, 11
  s_add_u32 s8, s8, 0
  s_add_u32 s8, s8, 5869568
  s_lshl_b32 s27, s3, 16
  s_add_u32 s27, s27, s15
  s_add_u32 s27, s27, 7966720
  s_add_u32 s20, s12, s27
  s_addc_u32 s21, s13, 0
  s_mov_b32 s22, 65536
  s_mov_b32 s23, 0x20000
  v_and_b32 v10, 15, v2
  s_lshl_b32 s36, s3, 4
  v_add_u32 v10, s36, v10
  v_lshlrev_b32 v10, 7, v10
  v_bfe_u32 v12, v2, 4, 1
  v_lshl_add_u32 v10, v12, 3, v10
  v_add_u32 v10, 49152, v10
  s_mul_i32 s36, s26, 7
  s_lshr_b32 s36, s36, 1
  v_and_b32 v11, 3, v2
  v_add_u32 v11, s36, v11
  s_lshl_b32 s36, s24, 7
  v_lshl_add_u32 v11, v11, 3, s36
  v_lshlrev_b32 v8, 2, v2
  s_lshl_b32 s27, s24, 15
  v_cndmask_b32 v13, v10, v11, s[62:63]
  s_lshl_b32 s36, s3, 2
  s_add_u32 s36, s36, 122880
  v_mov_b32 v12, s36
  v_mov_b32 v5, 122880
  s_add_u32 s27, s27, 0
  s_add_u32 s27, s27, 5869568
  v_mov_b32 v168, 0
  v_mov_b32 v169, 0
  v_mov_b32 v170, 0
  v_mov_b32 v171, 0
  v_mov_b32 v172, 0
  v_mov_b32 v173, 0
  v_mov_b32 v174, 0
  v_mov_b32 v175, 0
  v_mov_b32 v176, 0
  v_mov_b32 v177, 0
  v_mov_b32 v178, 0
  v_mov_b32 v179, 0
  v_mov_b32 v180, 0
  v_mov_b32 v181, 0
  v_mov_b32 v182, 0
  v_mov_b32 v183, 0
  v_mov_b32 v184, 0
  v_mov_b32 v185, 0
  v_mov_b32 v186, 0
  v_mov_b32 v187, 0
  v_mov_b32 v188, 0
  v_mov_b32 v189, 0
  v_mov_b32 v190, 0
  v_mov_b32 v191, 0
  v_mov_b32 v192, 0
  v_mov_b32 v193, 0
  v_mov_b32 v194, 0
  v_mov_b32 v195, 0
  v_mov_b32 v196, 0
  v_mov_b32 v197, 0
  v_mov_b32 v198, 0
  v_mov_b32 v199, 0
  v_mov_b32 v200, 0
  v_mov_b32 v201, 0
  v_mov_b32 v202, 0
  v_mov_b32 v203, 0
  v_mov_b32 v204, 0
  v_mov_b32 v205, 0
  v_mov_b32 v206, 0
  v_mov_b32 v207, 0
  v_mov_b32 v208, 0
  v_mov_b32 v209, 0
  v_mov_b32 v210, 0
  v_mov_b32 v211, 0
  v_mov_b32 v212, 0
  v_mov_b32 v213, 0
  v_mov_b32 v214, 0
  v_mov_b32 v215, 0
  v_mov_b32 v216, 0
  v_mov_b32 v217, 0
  v_mov_b32 v218, 0
  v_mov_b32 v219, 0
  v_mov_b32 v220, 0
  v_mov_b32 v221, 0
  v_mov_b32 v222, 0
  v_mov_b32 v223, 0
  v_mov_b32 v224, 0
  v_mov_b32 v225, 0
  v_mov_b32 v226, 0
  v_mov_b32 v227, 0
  v_mov_b32 v228, 0
  v_mov_b32 v229, 0
  v_mov_b32 v230, 0
  v_mov_b32 v231, 0
  v_mov_b32 v108, 0
  v_mov_b32 v156, 0
  v_mov_b32 v109, 0
  v_mov_b32 v157, 0
  v_mov_b32 v110, 0
  v_mov_b32 v158, 0
  v_mov_b32 v111, 0
  v_mov_b32 v159, 0
  v_mov_b32 v164, 0
  v_mov_b32 v165, 0
  s_lshr_b32 s38, s9, 3
  s_add_u32 s38, s38, 5390336
  s_or_b32 s39, s14, s10
  v_mov_b32 v10, s39
  v_mov_b32 v1, 0
  s_waitcnt vmcnt(0)
  s_barrier
  s_cmp_lg_u32 s3, 0
  s_cbranch_scc1 L_pf_x
  s_mov_b64 exec, 1
  buffer_store_dword v10, v1, s[16:19], s38 offen sc1
  s_mov_b64 exec, -1
L_pf_x:
  s_mov_b32 s39, 200000
W3:
  s_add_u32 s38, s15, 21569536
  buffer_load_dwordx2 v[14:15], v13, s[16:19], s38 offen sc1
  s_waitcnt vmcnt(0)
  v_cmp_ne_u32 vcc, s14, v14
  s_nop 1
  s_cmp_eq_u64 vcc, 0
  s_cbranch_scc1 Wd4
  s_sub_u32 s39, s39, 1
  s_cmp_lg_u32 s39, 0
  s_cbranch_scc1 W3
Wd4:
  s_mov_b32 s30, 0
  s_add_u32 s28, s3, 1
  s_and_b32 s28, s28, 3
  s_lshl_b32 s29, s26, 2
  s_add_u32 s28, s28, s29
  s_lshl_b32 s28, s28, 11
  s_add_u32 s28, s28, s27
  buffer_load_dwordx4 v[16:19], v9, s[16:19], s28 offen offset:0 sc1
  buffer_load_dwordx4 v[20:23], v9, s[16:19], s28 offen offset:1024 sc1
  buffer_load_dwordx4 v[48:51], v9, s[20:23], s30 offen offset:0 sc1
  buffer_load_dwordx4 v[52:55], v9, s[20:23], s30 offen offset:1024 sc1
  s_add_u32 s28, s3, 2
  s_and_b32 s28, s28, 3
  s_lshl_b32 s29, s26, 2
  s_add_u32 s28, s28, s29
  s_lshl_b32 s28, s28, 11
  s_add_u32 s28, s28, s27
  buffer_load_dwordx4 v[24:27], v9, s[16:19], s28 offen offset:0 sc1
  buffer_load_dwordx4 v[28:31], v9, s[16:19], s28 offen offset:1024 sc1
  buffer_load_dwordx4 v[56:59], v9, s[20:23], s30 offen offset:2048 sc1
  buffer_load_dwordx4 v[60:63], v9, s[20:23], s30 offen offset:3072 sc1
  s_add_u32 s30, s30, 4096
  s_add_u32 s28, s3, 3
  s_and_b32 s28, s28, 3
  s_lshl_b32 s29, s26, 2
  s_add_u32 s28, s28, s29
  s_lshl_b32 s28, s28, 11
  s_add_u32 s28, s28, s27
  buffer_load_dwordx4 v[32:35], v9, s[16:19], s28 offen offset:0 sc1
  buffer_load_dwordx4 v[36:39], v9, s[16:19], s28 offen offset:1024 sc1
  s_add_u32 s28, s3, 4
  s_and_b32 s28, s28, 3
  s_lshl_b32 s29, s26, 2
  s_add_u32 s28, s28, s29
  s_lshl_b32 s28, s28, 11
  s_add_u32 s28, s28, s27
  buffer_load_dwordx4 v[40:43], v9, s[16:19], s28 offen offset:0 sc1
  buffer_load_dwordx4 v[44:47], v9, s[16:19], s28 offen offset:1024 sc1
  buffer_load_dwordx4 v[64:67], v9, s[20:23], s30 offen offset:0 sc1
  buffer_load_dwordx4 v[68:71], v9, s[20:23], s30 offen offset:1024 sc1
  buffer_load_dwordx4 v[72:75], v9, s[20:23], s30 offen offset:2048 sc1
  buffer_load_dwordx4 v[76:79], v9, s[20:23], s30 offen offset:3072 sc1
  s_add_u32 s30, s30, 4096
  buffer_load_dwordx4 v[80:83], v9, s[20:23], s30 offen offset:0 sc1
  buffer_load_dwordx4 v[84:87], v9, s[20:23], s30 offen offset:1024 sc1
  buffer_load_dwordx4 v[88:91], v9, s[20:23], s30 offen offset:2048 sc1
  buffer_load_dwordx4 v[92:95], v9, s[20:23], s30 offen offset:3072 sc1
  s_add_u32 s30, s30, 4096
  s_nop 1
  v_max_f32_dpp v15, v15, v15 row_shr:1 row_mask:0xf bank_mask:0xf
  s_nop 1
  v_max_f32_dpp v15, v15, v15 row_shr:2 row_mask:0xf bank_mask:0xf
  s_nop 1
  v_max_f32_dpp v15, v15, v15 row_shr:4 row_mask:0xf bank_mask:0xf
  s_nop 1
  v_max_f32_dpp v15, v15, v15 row_shr:8 row_mask:0xf bank_mask:0xf
  s_nop 1
  v_readlane_b32 s34, v15, 15
  v_readlane_b32 s35, v15, 47
  s_nop 1
  v_mov_b32 v10, s34
  ds_write_b32 v12, v10
  s_waitcnt lgkmcnt(0)
  s_barrier
  ds_read_b128 v[112:115], v5
  s_waitcnt lgkmcnt(0)
  v_max3_f32 v10, v112, v113, v114
  v_max_f32 v10, v10, v115
  v_mul_f32 v10, s35, v10
  v_cmp_nge_f32 vcc, 0x44e10000, v10
  s_waitcnt vmcnt(8)
  v_cndmask_b32 v22, v22, 0, s[62:63]
  v_cndmask_b32 v23, v23, 0, s[62:63]
  v_cndmask_b32 v30, v30, 0, s[62:63]
  v_cndmask_b32 v31, v31, 0, s[62:63]
  v_cndmask_b32 v38, v38, 0, s[62:63]
  v_cndmask_b32 v39, v39, 0, s[62:63]
  v_cndmask_b32 v46, v46, 0, s[62:63]
  v_cndmask_b32 v47, v47, 0, s[62:63]
  s_cbranch_vccnz A_fb0
A_go0:
  v_mfma_f32_32x32x16_bf16 v[112:127], v[48:51], v[16:19], 0
  v_mfma_f32_32x32x16_bf16 v[112:127], v[52:55], v[20:23], v[112:127]
  s_mov_b32 s31, 5390336
  s_nop 7
  s_nop 3
  v_mfma_f32_32x32x16_bf16 v[128:143], v[48:51], v[24:27], 0
  v_exp_f32 v144, v112
  v_cvt_pk_bf16_f32 v166, v156, v157
  v_exp_f32 v145, v113
  v_cvt_pk_bf16_f32 v167, v158, v159
  v_exp_f32 v146, v114
  v_exp_f32 v147, v115
  v_mfma_f32_32x32x16_bf16 v[128:143], v[52:55], v[28:31], v[128:143]
  v_exp_f32 v148, v116
  v_cvt_pk_bf16_f32 v160, v144, v145
  v_exp_f32 v149, v117
  v_cvt_pk_bf16_f32 v161, v146, v147
  v_exp_f32 v150, v118
  v_exp_f32 v151, v119
  v_mfma_f32_32x32x16_bf16 v[216:231], v[108:111], v[164:167], v[216:231]
  v_exp_f32 v152, v120
  v_cvt_pk_bf16_f32 v162, v148, v149
  v_exp_f32 v153, v121
  v_cvt_pk_bf16_f32 v163, v150, v151
  v_exp_f32 v154, v122
  v_exp_f32 v155, v123
  v_mfma_f32_32x32x16_bf16 v[168:183], v[56:59], v[160:163], v[168:183]
  v_exp_f32 v156, v124
  v_cvt_pk_bf16_f32 v164, v152, v153
  v_exp_f32 v157, v125
  v_cvt_pk_bf16_f32 v165, v154, v155
  v_exp_f32 v158, v126
  v_exp_f32 v159, v127
  v_mfma_f32_32x32x16_bf16 v[112:127], v[48:51], v[32:35], 0
  v_exp_f32 v144, v128
  v_cvt_pk_bf16_f32 v166, v156, v157
  v_exp_f32 v145, v129
  v_cvt_pk_bf16_f32 v167, v158, v159
  v_exp_f32 v146, v130
  v_exp_f32 v147, v131
  v_mfma_f32_32x32x16_bf16 v[112:127], v[52:55], v[36:39], v[112:127]
  v_exp_f32 v148, v132
  v_cvt_pk_bf16_f32 v160, v144, v145
  v_exp_f32 v149, v133
  v_cvt_pk_bf16_f32 v161, v146, v147
  v_exp_f32 v150, v134
  v_exp_f32 v151, v135
  v_mfma_f32_32x32x16_bf16 v[168:183], v[60:63], v[164:167], v[168:183]
  v_exp_f32 v152, v136
  buffer_load_dwordx4 v[96:99], v9, s[20:23], s30 offen offset:0 sc1
  v_cvt_pk_bf16_f32 v162, v148, v149
  v_exp_f32 v153, v137
  buffer_load_dwordx4 v[100:103], v9, s[20:23], s30 offen offset:1024 sc1
  v_cvt_pk_bf16_f32 v163, v150, v151
  v_exp_f32 v154, v138
  buffer_load_dwordx4 v[104:107], v9, s[20:23], s30 offen offset:2048 sc1
  v_exp_f32 v155, v139
  buffer_load_dwordx4 v[108:111], v9, s[20:23], s30 offen offset:3072 sc1
  s_add_u32 s30, s30, 4096
  v_mfma_f32_32x32x16_bf16 v[184:199], v[56:59], v[160:163], v[184:199]
  v_exp_f32 v156, v140
  v_cvt_pk_bf16_f32 v164, v152, v153
  v_exp_f32 v157, v141
  v_cvt_pk_bf16_f32 v165, v154, v155
  v_exp_f32 v158, v142
  v_exp_f32 v159, v143
  v_mfma_f32_32x32x16_bf16 v[128:143], v[48:51], v[40:43], 0
  v_exp_f32 v144, v112
  v_cvt_pk_bf16_f32 v166, v156, v157
  v_exp_f32 v145, v113
  v_cvt_pk_bf16_f32 v167, v158, v159
  v_exp_f32 v146, v114
  s_add_u32 s35, s15, 21569536
  buffer_load_dword v14, v7, s[16:19], s35 offen offset:0
  v_exp_f32 v147, v115
  v_mfma_f32_32x32x16_bf16 v[128:143], v[52:55], v[44:47], v[128:143]
  v_exp_f32 v148, v116
  v_cvt_pk_bf16_f32 v160, v144, v145
  v_exp_f32 v149, v117
  v_cvt_pk_bf16_f32 v161, v146, v147
  v_exp_f32 v150, v118
  v_exp_f32 v151, v119
  v_mfma_f32_32x32x16_bf16 v[184:199], v[60:63], v[164:167], v[184:199]
  v_exp_f32 v152, v120
  v_cvt_pk_bf16_f32 v162, v148, v149
  v_exp_f32 v153, v121
  v_cvt_pk_bf16_f32 v163, v150, v151
  v_exp_f32 v154, v122
  v_exp_f32 v155, v123
  v_mfma_f32_32x32x16_bf16 v[200:215], v[56:59], v[160:163], v[200:215]
  v_exp_f32 v156, v124
  v_cvt_pk_bf16_f32 v164, v152, v153
  v_exp_f32 v157, v125
  v_cvt_pk_bf16_f32 v165, v154, v155
  v_exp_f32 v158, v126
  v_exp_f32 v159, v127
  s_waitcnt vmcnt(9)
  v_mfma_f32_32x32x16_bf16 v[112:127], v[64:67], v[16:19], 0
  v_exp_f32 v144, v128
  v_cvt_pk_bf16_f32 v166, v156, v157
  v_exp_f32 v145, v129
  v_cvt_pk_bf16_f32 v167, v158, v159
  v_exp_f32 v146, v130
  v_exp_f32 v147, v131
  v_mfma_f32_32x32x16_bf16 v[112:127], v[68:71], v[20:23], v[112:127]
  v_exp_f32 v148, v132
  v_cvt_pk_bf16_f32 v160, v144, v145
  v_exp_f32 v149, v133
  v_cvt_pk_bf16_f32 v161, v146, v147
  v_exp_f32 v150, v134
  v_exp_f32 v151, v135
  v_mfma_f32_32x32x16_bf16 v[200:215], v[60:63], v[164:167], v[200:215]
  v_exp_f32 v152, v136
  v_cvt_pk_bf16_f32 v162, v148, v149
  v_exp_f32 v153, v137
  v_cvt_pk_bf16_f32 v163, v150, v151
  v_exp_f32 v154, v138
  v_exp_f32 v155, v139
  v_mfma_f32_32x32x16_bf16 v[216:231], v[56:59], v[160:163], v[216:231]
  v_exp_f32 v156, v140
  v_cvt_pk_bf16_f32 v164, v152, v153
  v_exp_f32 v157, v141
  v_cvt_pk_bf16_f32 v165, v154, v155
  v_exp_f32 v158, v142
  v_exp_f32 v159, v143
  v_mfma_f32_32x32x16_bf16 v[128:143], v[64:67], v[24:27], 0
  v_exp_f32 v144, v112
  v_cvt_pk_bf16_f32 v166, v156, v157
  v_exp_f32 v145, v113
  v_cvt_pk_bf16_f32 v167, v158, v159
  v_exp_f32 v146, v114
  v_exp_f32 v147, v115
  v_mfma_f32_32x32x16_bf16 v[128:143], v[68:71], v[28:31], v[128:143]
  v_exp_f32 v148, v116
  v_cvt_pk_bf16_f32 v160, v144, v145
  v_exp_f32 v149, v117
  v_cvt_pk_bf16_f32 v161, v146, v147
  v_exp_f32 v150, v118
  v_exp_f32 v151, v119
  v_mfma_f32_32x32x16_bf16 v[216:231], v[60:63], v[164:167], v[216:231]
  v_exp_f32 v152, v120
  v_cvt_pk_bf16_f32 v162, v148, v149
  v_exp_f32 v153, v121
  v_cvt_pk_bf16_f32 v163, v150, v151
  v_exp_f32 v154, v122
  v_exp_f32 v155, v123
  v_mfma_f32_32x32x16_bf16 v[168:183], v[72:75], v[160:163], v[168:183]
  v_exp_f32 v156, v124
  v_cvt_pk_bf16_f32 v164, v152, v153
  v_exp_f32 v157, v125
  v_cvt_pk_bf16_f32 v165, v154, v155
  v_exp_f32 v158, v126
  v_exp_f32 v159, v127
  v_mfma_f32_32x32x16_bf16 v[112:127], v[64:67], v[32:35], 0
  v_exp_f32 v144, v128
  v_cvt_pk_bf16_f32 v166, v156, v157
  v_exp_f32 v145, v129
  v_cvt_pk_bf16_f32 v167, v158, v159
  v_exp_f32 v146, v130
  v_exp_f32 v147, v131
  v_mfma_f32_32x32x16_bf16 v[112:127], v[68:71], v[36:39], v[112:127]
  v_exp_f32 v148, v132
  v_cvt_pk_bf16_f32 v160, v144, v145
  v_exp_f32 v149, v133
  v_cvt_pk_bf16_f32 v161, v146, v147
  v_exp_f32 v150, v134
  v_exp_f32 v151, v135
  v_mfma_f32_32x32x16_bf16 v[168:183], v[76:79], v[164:167], v[168:183]
  v_exp_f32 v152, v136
  buffer_load_dwordx4 v[48:51], v9, s[20:23], s30 offen offset:0 sc1
  v_cvt_pk_bf16_f32 v162, v148, v149
  v_exp_f32 v153, v137
  buffer_load_dwordx4 v[52:55], v9, s[20:23], s30 offen offset:1024 sc1
  v_cvt_pk_bf16_f32 v163, v150, v151
  v_exp_f32 v154, v138
  buffer_load_dwordx4 v[56:59], v9, s[20:23], s30 offen offset:2048 sc1
  v_exp_f32 v155, v139
  buffer_load_dwordx4 v[60:63], v9, s[20:23], s30 offen offset:3072 sc1
  s_add_u32 s30, s30, 4096
  v_mfma_f32_32x32x16_bf16 v[184:199], v[72:75], v[160:163], v[184:199]
  v_exp_f32 v156, v140
  v_cvt_pk_bf16_f32 v164, v152, v153
  v_exp_f32 v157, v141
  v_cvt_pk_bf16_f32 v165, v154, v155
  v_exp_f32 v158, v142
  v_exp_f32 v159, v143
  v_mfma_f32_32x32x16_bf16 v[128:143], v[64:67], v[40:43], 0
  v_exp_f32 v144, v112
  v_cvt_pk_bf16_f32 v166, v156, v157
  v_exp_f32 v145, v113
  v_cvt_pk_bf16_f32 v167, v158, v159
  v_exp_f32 v146, v114
  v_exp_f32 v147, v115
  v_mfma_f32_32x32x16_bf16 v[128:143], v[68:71], v[44:47], v[128:143]
  v_exp_f32 v148, v116
  v_cvt_pk_bf16_f32 v160, v144, v145
  v_exp_f32 v149, v117
  v_cvt_pk_bf16_f32 v161, v146, v147
  v_exp_f32 v150, v118
  v_exp_f32 v151, v119
  v_mfma_f32_32x32x16_bf16 v[184:199], v[76:79], v[164:167], v[184:199]
  v_exp_f32 v152, v120
  v_cvt_pk_bf16_f32 v162, v148, v149
  v_exp_f32 v153, v121
  v_cvt_pk_bf16_f32 v163, v150, v151
  v_exp_f32 v154, v122
  v_exp_f32 v155, v123
  v_mfma_f32_32x32x16_bf16 v[200:215], v[72:75], v[160:163], v[200:215]
  v_exp_f32 v156, v124
  v_cvt_pk_bf16_f32 v164, v152, v153
  v_exp_f32 v157, v125
  v_cvt_pk_bf16_f32 v165, v154, v155
  v_exp_f32 v158, v126
  v_exp_f32 v159, v127
  s_waitcnt vmcnt(9)
  v_mfma_f32_32x32x16_bf16 v[112:127], v[80:83], v[16:19], 0
  v_exp_f32 v144, v128
  v_cvt_pk_bf16_f32 v166, v156, v157
  v_exp_f32 v145, v129
  v_cvt_pk_bf16_f32 v167, v158, v159
  v_exp_f32 v146, v130
  v_exp_f32 v147, v131
  v_mfma_f32_32x32x16_bf16 v[112:127], v[84:87], v[20:23], v[112:127]
  v_exp_f32 v148, v132
  v_cvt_pk_bf16_f32 v160, v144, v145
  v_exp_f32 v149, v133
  v_cvt_pk_bf16_f32 v161, v146, v147
  v_exp_f32 v150, v134
  v_exp_f32 v151, v135
  v_mfma_f32_32x32x16_bf16 v[200:215], v[76:79], v[164:167], v[200:215]
  v_exp_f32 v152, v136
  v_cvt_pk_bf16_f32 v162, v148, v149
  v_exp_f32 v153, v137
  v_cvt_pk_bf16_f32 v163, v150, v151
  v_exp_f32 v154, v138
  v_exp_f32 v155, v139
  v_mfma_f32_32x32x16_bf16 v[216:231], v[72:75], v[160:163], v[216:231]
  v_exp_f32 v156, v140
  v_cvt_pk_bf16_f32 v164, v152, v153
  v_exp_f32 v157, v141
  v_cvt_pk_bf16_f32 v165, v154, v155
  v_exp_f32 v158, v142
  v_exp_f32 v159, v143
  v_mfma_f32_32x32x16_bf16 v[128:143], v[80:83], v[24:27], 0
  v_exp_f32 v144, v112
  v_cvt_pk_bf16_f32 v166, v156, v157
  v_exp_f32 v145, v113
  v_cvt_pk_bf16_f32 v167, v158, v159
  v_exp_f32 v146, v114
  v_exp_f32 v147, v115
  v_mfma_f32_32x32x16_bf16 v[128:143], v[84:87], v[28:31], v[128:143]
  v_exp_f32 v148, v116
  v_cvt_pk_bf16_f32 v160, v144, v145
  v_exp_f32 v149, v117
  v_cvt_pk_bf16_f32 v161, v146, v147
  v_exp_f32 v150, v118
  buffer_load_dwordx4 v[232:235], v9, s[16:19], s31 offen sc1
  v_exp_f32 v151, v119
  v_mfma_f32_32x32x16_bf16 v[216:231], v[76:79], v[164:167], v[216:231]
  v_exp_f32 v152, v120
  v_cvt_pk_bf16_f32 v162, v148, v149
  v_exp_f32 v153, v121
  v_cvt_pk_bf16_f32 v163, v150, v151
  v_exp_f32 v154, v122
  v_exp_f32 v155, v123
  v_mfma_f32_32x32x16_bf16 v[168:183], v[88:91], v[160:163], v[168:183]
  v_exp_f32 v156, v124
  v_cvt_pk_bf16_f32 v164, v152, v153
  v_exp_f32 v157, v125
  v_cvt_pk_bf16_f32 v165, v154, v155
  v_exp_f32 v158, v126
  v_exp_f32 v159, v127
  v_mfma_f32_32x32x16_bf16 v[112:127], v[80:83], v[32:35], 0
  v_exp_f32 v144, v128
  v_cvt_pk_bf16_f32 v166, v156, v157
  v_exp_f32 v145, v129
  v_cvt_pk_bf16_f32 v167, v158, v159
  v_exp_f32 v146, v130
  v_exp_f32 v147, v131
  v_mfma_f32_32x32x16_bf16 v[112:127], v[84:87], v[36:39], v[112:127]
  v_exp_f32 v148, v132
  v_cvt_pk_bf16_f32 v160, v144, v145
  v_exp_f32 v149, v133
  v_cvt_pk_bf16_f32 v161, v146, v147
  v_exp_f32 v150, v134
  v_exp_f32 v151, v135
  v_mfma_f32_32x32x16_bf16 v[168:183], v[92:95], v[164:167], v[168:183]
  v_exp_f32 v152, v136
  buffer_load_dwordx4 v[64:67], v9, s[20:23], s30 offen offset:0 sc1
  v_cvt_pk_bf16_f32 v162, v148, v149
  v_exp_f32 v153, v137
  buffer_load_dwordx4 v[68:71], v9, s[20:23], s30 offen offset:1024 sc1
  v_cvt_pk_bf16_f32 v163, v150, v151
  v_exp_f32 v154, v138
  buffer_load_dwordx4 v[72:75], v9, s[20:23], s30 offen offset:2048 sc1
  v_exp_f32 v155, v139
  buffer_load_dwordx4 v[76:79], v9, s[20:23], s30 offen offset:3072 sc1
  s_add_u32 s30, s30, 4096
  v_mfma_f32_32x32x16_bf16 v[184:199], v[88:91], v[160:163], v[184:199]
  v_exp_f32 v156, v140
  v_cvt_pk_bf16_f32 v164, v152, v153
  v_exp_f32 v157, v141
  v_cvt_pk_bf16_f32 v165, v154, v155
  v_exp_f32 v158, v142
  v_exp_f32 v159, v143
  v_mfma_f32_32x32x16_bf16 v[128:143], v[80:83], v[40:43], 0
  v_exp_f32 v144, v112
  v_cvt_pk_bf16_f32 v166, v156, v157
  v_exp_f32 v145, v113
  v_cvt_pk_bf16_f32 v167, v158, v159
  v_exp_f32 v146, v114
  buffer_load_dword v14, v6, s[16:19], s4 offen offset:0
  v_exp_f32 v147, v115
  v_mfma_f32_32x32x16_bf16 v[128:143], v[84:87], v[44:47], v[128:143]
  v_exp_f32 v148, v116
  v_cvt_pk_bf16_f32 v160, v144, v145
  v_exp_f32 v149, v117
  v_cvt_pk_bf16_f32 v161, v146, v147
  v_exp_f32 v150, v118
  v_exp_f32 v151, v119
  v_mfma_f32_32x32x16_bf16 v[184:199], v[92:95], v[164:167], v[184:199]
  v_exp_f32 v152, v120
  v_cvt_pk_bf16_f32 v162, v148, v149
  v_exp_f32 v153, v121
  v_cvt_pk_bf16_f32 v163, v150, v151
  v_exp_f32 v154, v122
  v_exp_f32 v155, v123
  v_mfma_f32_32x32x16_bf16 v[200:215], v[88:91], v[160:163], v[200:215]
  v_exp_f32 v156, v124
  v_cvt_pk_bf16_f32 v164, v152, v153
  v_exp_f32 v157, v125
  v_cvt_pk_bf16_f32 v165, v154, v155
  v_exp_f32 v158, v126
  v_exp_f32 v159, v127
  s_waitcnt vmcnt(11)
  s_waitcnt vmcnt(5)
  v_and_b32 v236, -16, v232
  v_and_b32 v237, -16, v233
  v_and_b32 v238, -16, v234
  v_and_b32 v239, -16, v235
  v_cmp_ne_u32 vcc, s14, v236
  v_cmp_ne_u32 s[36:37], s14, v237
  v_cmp_ne_u32 s[38:39], s14, v238
  v_cmp_ne_u32 s[32:33], s14, v239
  s_or_b64 vcc, vcc, s[36:37]
  s_nop 0
  s_or_b64 s[38:39], s[38:39], s[32:33]
  s_or_b64 vcc, vcc, s[38:39]
  s_cbranch_scc1 A_pw
A_pb:
  s_or_b32 s34, s14, s10
  v_cmp_ne_u32 vcc, s34, v232
  v_cmp_ne_u32 s[36:37], s34, v233
  v_cmp_ne_u32 s[38:39], s34, v234
  v_cmp_ne_u32 s[32:33], s34, v235
  s_or_b64 vcc, vcc, s[36:37]
  s_and_b32 s34, s2, 7
  s_or_b64 s[38:39], s[38:39], s[32:33]
  s_lshl_b32 s34, s34, 3
  s_or_b64 vcc, vcc, s[38:39]
  s_lshr_b64 vcc, vcc, s34
  s_and_b32 s34, vcc_lo, 0xff
  s_cselect_b32 s61, 0, 1
  v_mfma_f32_32x32x16_bf16 v[112:127], v[96:99], v[16:19], 0
  v_exp_f32 v144, v128
  v_cvt_pk_bf16_f32 v166, v156, v157
  v_exp_f32 v145, v129
  v_cvt_pk_bf16_f32 v167, v158, v159
  v_exp_f32 v146, v130
  v_exp_f32 v147, v131
  v_mfma_f32_32x32x16_bf16 v[112:127], v[100:103], v[20:23], v[112:127]
  v_exp_f32 v148, v132
  v_cvt_pk_bf16_f32 v160, v144, v145
  v_exp_f32 v149, v133
  v_cvt_pk_bf16_f32 v161, v146, v147
  v_exp_f32 v150, v134
  v_exp_f32 v151, v135
  v_mfma_f32_32x32x16_bf16 v[200:215], v[92:95], v[164:167], v[200:215]
  v_exp_f32 v152, v136
  v_cvt_pk_bf16_f32 v162, v148, v149
  v_exp_f32 v153, v137
  v_cvt_pk_bf16_f32 v163, v150, v151
  v_exp_f32 v154, v138
  v_exp_f32 v155, v139
  v_mfma_f32_32x32x16_bf16 v[216:231], v[88:91], v[160:163], v[216:231]
  v_exp_f32 v156, v140
  v_cvt_pk_bf16_f32 v164, v152, v153
  v_exp_f32 v157, v141
  v_cvt_pk_bf16_f32 v165, v154, v155
  v_exp_f32 v158, v142
  v_exp_f32 v159, v143
  v_mfma_f32_32x32x16_bf16 v[128:143], v[96:99], v[24:27], 0
  v_exp_f32 v144, v112
  v_cvt_pk_bf16_f32 v166, v156, v157
  v_exp_f32 v145, v113
  v_cvt_pk_bf16_f32 v167, v158, v159
  v_exp_f32 v146, v114
  buffer_load_dwordx4 a[0:3], v9, s[16:19], s96 offen offset:0 sc1
  v_exp_f32 v147, v115
  v_mfma_f32_32x32x16_bf16 v[128:143], v[100:103], v[28:31], v[128:143]
  v_exp_f32 v148, v116
  v_cvt_pk_bf16_f32 v160, v144, v145
  v_exp_f32 v149, v117
  v_cvt_pk_bf16_f32 v161, v146, v147
  v_exp_f32 v150, v118
  v_exp_f32 v151, v119
  v_mfma_f32_32x32x16_bf16 v[216:231], v[92:95], v[164:167], v[216:231]
  v_exp_f32 v152, v120
  v_cvt_pk_bf16_f32 v162, v148, v149
  v_exp_f32 v153, v121
  v_cvt_pk_bf16_f32 v163, v150, v151
  v_exp_f32 v154, v122
  v_exp_f32 v155, v123
  v_mfma_f32_32x32x16_bf16 v[168:183], v[104:107], v[160:163], v[168:183]
  v_exp_f32 v156, v124
  v_cvt_pk_bf16_f32 v164, v152, v153
  v_exp_f32 v157, v125
  v_cvt_pk_bf16_f32 v165, v154, v155
  v_exp_f32 v158, v126
  buffer_load_dwordx4 a[4:7], v9, s[16:19], s97 offen offset:0 sc1
  v_exp_f32 v159, v127
  v_mfma_f32_32x32x16_bf16 v[112:127], v[96:99], v[32:35], 0
  v_exp_f32 v144, v128
  v_cvt_pk_bf16_f32 v166, v156, v157
  v_exp_f32 v145, v129
  v_cvt_pk_bf16_f32 v167, v158, v159
  v_exp_f32 v146, v130
  buffer_load_dwordx4 a[8:11], v9, s[16:19], s96 offen offset:1024 sc1
  v_exp_f32 v147, v131
  v_mfma_f32_32x32x16_bf16 v[112:127], v[100:103], v[36:39], v[112:127]
  v_exp_f32 v148, v132
  v_cvt_pk_bf16_f32 v160, v144, v145
  v_exp_f32 v149, v133
  v_cvt_pk_bf16_f32 v161, v146, v147
  v_exp_f32 v150, v134
  v_exp_f32 v151, v135
  v_mfma_f32_32x32x16_bf16 v[168:183], v[108:111], v[164:167], v[168:183]
  v_exp_f32 v152, v136
  buffer_load_dwordx4 v[80:83], v9, s[20:23], s30 offen offset:0 sc1
  v_cvt_pk_bf16_f32 v162, v148, v149
  v_exp_f32 v153, v137
  buffer_load_dwordx4 v[84:87], v9, s[20:23], s30 offen offset:1024 sc1
  v_cvt_pk_bf16_f32 v163, v150, v151
  v_exp_f32 v154, v138
  buffer_load_dwordx4 v[88:91], v9, s[20:23], s30 offen offset:2048 sc1
  v_exp_f32 v155, v139
  buffer_load_dwordx4 v[92:95], v9, s[20:23], s30 offen offset:3072 sc1
  s_add_u32 s30, s30, 4096
  v_mfma_f32_32x32x16_bf16 v[184:199], v[104:107], v[160:163], v[184:199]
  v_exp_f32 v156, v140
  v_cvt_pk_bf16_f32 v164, v152, v153
  v_exp_f32 v157, v141
  v_cvt_pk_bf16_f32 v165, v154, v155
  v_exp_f32 v158, v142
  v_exp_f32 v159, v143
  v_mfma_f32_32x32x16_bf16 v[128:143], v[96:99], v[40:43], 0
  v_exp_f32 v144, v112
  v_cvt_pk_bf16_f32 v166, v156, v157
  v_exp_f32 v145, v113
  v_cvt_pk_bf16_f32 v167, v158, v159
  v_exp_f32 v146, v114
  buffer_load_dwordx4 a[12:15], v9, s[16:19], s97 offen offset:1024 sc1
  v_exp_f32 v147, v115
  v_mfma_f32_32x32x16_bf16 v[128:143], v[100:103], v[44:47], v[128:143]
  v_exp_f32 v148, v116
  v_cvt_pk_bf16_f32 v160, v144, v145
  v_exp_f32 v149, v117
  v_cvt_pk_bf16_f32 v161, v146, v147
  v_exp_f32 v150, v118
  v_exp_f32 v151, v119
  v_mfma_f32_32x32x16_bf16 v[184:199], v[108:111], v[164:167], v[184:199]
  v_exp_f32 v152, v120
  v_cvt_pk_bf16_f32 v162, v148, v149
  v_exp_f32 v153, v121
  v_cvt_pk_bf16_f32 v163, v150, v151
  v_exp_f32 v154, v122
  v_exp_f32 v155, v123
  v_mfma_f32_32x32x16_bf16 v[200:215], v[104:107], v[160:163], v[200:215]
  v_exp_f32 v156, v124
  v_cvt_pk_bf16_f32 v164, v152, v153
  v_exp_f32 v157, v125
  v_cvt_pk_bf16_f32 v165, v154, v155
  v_exp_f32 v158, v126
  buffer_load_dwordx4 a[16:19], v9, s[16:19], s96 offen offset:2048 sc1
  v_exp_f32 v159, v127
  v_mfma_f32_32x32x16_bf16 v[112:127], v[48:51], v[16:19], 0
  v_exp_f32 v144, v128
  v_cvt_pk_bf16_f32 v166, v156, v157
  v_exp_f32 v145, v129
  v_cvt_pk_bf16_f32 v167, v158, v159
  v_exp_f32 v146, v130
  buffer_load_dwordx4 a[20:23], v9, s[16:19], s97 offen offset:2048 sc1
  v_exp_f32 v147, v131
  v_mfma_f32_32x32x16_bf16 v[112:127], v[52:55], v[20:23], v[112:127]
  v_exp_f32 v148, v132
  v_cvt_pk_bf16_f32 v160, v144, v145
  v_exp_f32 v149, v133
  v_cvt_pk_bf16_f32 v161, v146, v147
  v_exp_f32 v150, v134
  v_exp_f32 v151, v135
  v_mfma_f32_32x32x16_bf16 v[200:215], v[108:111], v[164:167], v[200:215]
  v_exp_f32 v152, v136
  v_cvt_pk_bf16_f32 v162, v148, v149
  v_exp_f32 v153, v137
  v_cvt_pk_bf16_f32 v163, v150, v151
  v_exp_f32 v154, v138
  v_exp_f32 v155, v139
  v_mfma_f32_32x32x16_bf16 v[216:231], v[104:107], v[160:163], v[216:231]
  v_exp_f32 v156, v140
  v_cvt_pk_bf16_f32 v164, v152, v153
  v_exp_f32 v157, v141
  v_cvt_pk_bf16_f32 v165, v154, v155
  v_exp_f32 v158, v142
  buffer_load_dwordx4 a[24:27], v9, s[16:19], s96 offen offset:3072 sc1
  v_exp_f32 v159, v143
  v_mfma_f32_32x32x16_bf16 v[128:143], v[48:51], v[24:27], 0
  v_exp_f32 v144, v112
  v_cvt_pk_bf16_f32 v166, v156, v157
  v_exp_f32 v145, v113
  v_cvt_pk_bf16_f32 v167, v158, v159
  v_exp_f32 v146, v114
  buffer_load_dwordx4 a[28:31], v9, s[16:19], s97 offen offset:3072 sc1
  v_exp_f32 v147, v115
  v_mfma_f32_32x32x16_bf16 v[128:143], v[52:55], v[28:31], v[128:143]
  v_exp_f32 v148, v116
  v_cvt_pk_bf16_f32 v160, v144, v145
  v_exp_f32 v149, v117
  v_cvt_pk_bf16_f32 v161, v146, v147
  v_exp_f32 v150, v118
  v_exp_f32 v151, v119
  v_mfma_f32_32x32x16_bf16 v[216:231], v[108:111], v[164:167], v[216:231]
  v_exp_f32 v152, v120
  v_cvt_pk_bf16_f32 v162, v148, v149
  v_exp_f32 v153, v121
  v_cvt_pk_bf16_f32 v163, v150, v151
  v_exp_f32 v154, v122
  v_exp_f32 v155, v123
  v_mfma_f32_32x32x16_bf16 v[168:183], v[56:59], v[160:163], v[168:183]
  v_exp_f32 v156, v124
  v_cvt_pk_bf16_f32 v164, v152, v153
  v_exp_f32 v157, v125
  v_cvt_pk_bf16_f32 v165, v154, v155
  v_exp_f32 v158, v126
  s_add_u32 s96, s96, 4096
  buffer_load_dwordx4 a[32:35], v9, s[16:19], s96 offen offset:0 sc1
  v_exp_f32 v159, v127
  v_mfma_f32_32x32x16_bf16 v[112:127], v[48:51], v[32:35], 0
  v_exp_f32 v144, v128
  v_cvt_pk_bf16_f32 v166, v156, v157
  v_exp_f32 v145, v129
  v_cvt_pk_bf16_f32 v167, v158, v159
  v_exp_f32 v146, v130
  s_add_u32 s97, s97, 4096
  buffer_load_dwordx4 a[36:39], v9, s[16:19], s97 offen offset:0 sc1
  v_exp_f32 v147, v131
  v_mfma_f32_32x32x16_bf16 v[112:127], v[52:55], v[36:39], v[112:127]
  v_exp_f32 v148, v132
  v_cvt_pk_bf16_f32 v160, v144, v145
  v_exp_f32 v149, v133
  v_cvt_pk_bf16_f32 v161, v146, v147
  v_exp_f32 v150, v134
  v_exp_f32 v151, v135
  v_mfma_f32_32x32x16_bf16 v[168:183], v[60:63], v[164:167], v[168:183]
  v_exp_f32 v152, v136
  buffer_load_dwordx4 v[96:99], v9, s[20:23], s30 offen offset:0 sc1
  v_cvt_pk_bf16_f32 v162, v148, v149
  v_exp_f32 v153, v137
  buffer_load_dwordx4 v[100:103], v9, s[20:23], s30 offen offset:1024 sc1
  v_cvt_pk_bf16_f32 v163, v150, v151
  v_exp_f32 v154, v138
  buffer_load_dwordx4 v[104:107], v9, s[20:23], s30 offen offset:2048 sc1
  v_exp_f32 v155, v139
  buffer_load_dwordx4 v[108:111], v9, s[20:23], s30 offen offset:3072 sc1
  s_add_u32 s30, s30, 4096
  v_mfma_f32_32x32x16_bf16 v[184:199], v[56:59], v[160:163], v[184:199]
  v_exp_f32 v156, v140
  v_cvt_pk_bf16_f32 v164, v152, v153
  v_exp_f32 v157, v141
  v_cvt_pk_bf16_f32 v165, v154, v155
  v_exp_f32 v158, v142
  v_exp_f32 v159, v143
  v_mfma_f32_32x32x16_bf16 v[128:143], v[48:51], v[40:43], 0
  v_exp_f32 v144, v112
  v_cvt_pk_bf16_f32 v166, v156, v157
  v_exp_f32 v145, v113
  v_cvt_pk_bf16_f32 v167, v158, v159
  v_exp_f32 v146, v114
  buffer_load_dword v14, v6, s[16:19], s6 offen offset:0
  v_exp_f32 v147, v115
  v_mfma_f32_32x32x16_bf16 v[128:143], v[52:55], v[44:47], v[128:143]
  v_exp_f32 v148, v116
  v_cvt_pk_bf16_f32 v160, v144, v145
  v_exp_f32 v149, v117
  v_cvt_pk_bf16_f32 v161, v146, v147
  v_exp_f32 v150, v118
  v_exp_f32 v151, v119
  v_mfma_f32_32x32x16_bf16 v[184:199], v[60:63], v[164:167], v[184:199]
  v_exp_f32 v152, v120
  v_cvt_pk_bf16_f32 v162, v148, v149
  v_exp_f32 v153, v121
  v_cvt_pk_bf16_f32 v163, v150, v151
  v_exp_f32 v154, v122
  v_exp_f32 v155, v123
  v_mfma_f32_32x32x16_bf16 v[200:215], v[56:59], v[160:163], v[200:215]
  v_exp_f32 v156, v124
  v_cvt_pk_bf16_f32 v164, v152, v153
  v_exp_f32 v157, v125
  v_cvt_pk_bf16_f32 v165, v154, v155
  v_exp_f32 v158, v126
  buffer_load_dwordx4 a[40:43], v9, s[16:19], s96 offen offset:1024 sc1
  v_exp_f32 v159, v127
  s_waitcnt vmcnt(21)
  v_mfma_f32_32x32x16_bf16 v[112:127], v[64:67], v[16:19], 0
  v_exp_f32 v144, v128
  v_cvt_pk_bf16_f32 v166, v156, v157
  v_exp_f32 v145, v129
  v_cvt_pk_bf16_f32 v167, v158, v159
  v_exp_f32 v146, v130
  buffer_load_dwordx4 a[44:47], v9, s[16:19], s97 offen offset:1024 sc1
  v_exp_f32 v147, v131
  v_mfma_f32_32x32x16_bf16 v[112:127], v[68:71], v[20:23], v[112:127]
  v_exp_f32 v148, v132
  v_cvt_pk_bf16_f32 v160, v144, v145
  v_exp_f32 v149, v133
  v_cvt_pk_bf16_f32 v161, v146, v147
  v_exp_f32 v150, v134
  v_exp_f32 v151, v135
  v_mfma_f32_32x32x16_bf16 v[200:215], v[60:63], v[164:167], v[200:215]
  v_exp_f32 v152, v136
  v_cvt_pk_bf16_f32 v162, v148, v149
  v_exp_f32 v153, v137
  v_cvt_pk_bf16_f32 v163, v150, v151
  v_exp_f32 v154, v138
  v_exp_f32 v155, v139
  v_mfma_f32_32x32x16_bf16 v[216:231], v[56:59], v[160:163], v[216:231]
  v_exp_f32 v156, v140
  v_cvt_pk_bf16_f32 v164, v152, v153
  v_exp_f32 v157, v141
  v_cvt_pk_bf16_f32 v165, v154, v155
  v_exp_f32 v158, v142
  buffer_load_dwordx4 a[48:51], v9, s[16:19], s96 offen offset:2048 sc1
  v_exp_f32 v159, v143
  v_mfma_f32_32x32x16_bf16 v[128:143], v[64:67], v[24:27], 0
  v_exp_f32 v144, v112
  v_cvt_pk_bf16_f32 v166, v156, v157
  v_exp_f32 v145, v113
  v_cvt_pk_bf16_f32 v167, v158, v159
  v_exp_f32 v146, v114
  buffer_load_dwordx4 a[52:55], v9, s[16:19], s97 offen offset:2048 sc1
  v_exp_f32 v147, v115
  v_mfma_f32_32x32x16_bf16 v[128:143], v[68:71], v[28:31], v[128:143]
  v_exp_f32 v148, v116
  v_cvt_pk_bf16_f32 v160, v144, v145
  v_exp_f32 v149, v117
  v_cvt_pk_bf16_f32 v161, v146, v147
  v_exp_f32 v150, v118
  v_exp_f32 v151, v119
  v_mfma_f32_32x32x16_bf16 v[216:231], v[60:63], v[164:167], v[216:231]
  v_exp_f32 v152, v120
  v_cvt_pk_bf16_f32 v162, v148, v149
  v_exp_f32 v153, v121
  v_cvt_pk_bf16_f32 v163, v150, v151
  v_exp_f32 v154, v122
  v_exp_f32 v155, v123
  v_mfma_f32_32x32x16_bf16 v[168:183], v[72:75], v[160:163], v[168:183]
  v_exp_f32 v156, v124
  v_cvt_pk_bf16_f32 v164, v152, v153
  v_exp_f32 v157, v125
  v_cvt_pk_bf16_f32 v165, v154, v155
  v_exp_f32 v158, v126
  buffer_load_dwordx4 a[56:59], v9, s[16:19], s96 offen offset:3072 sc1
  v_exp_f32 v159, v127
  v_mfma_f32_32x32x16_bf16 v[112:127], v[64:67], v[32:35], 0
  v_exp_f32 v144, v128
  v_cvt_pk_bf16_f32 v166, v156, v157
  v_exp_f32 v145, v129
  v_cvt_pk_bf16_f32 v167, v158, v159
  v_exp_f32 v146, v130
  buffer_load_dwordx4 a[60:63], v9, s[16:19], s97 offen offset:3072 sc1
  v_exp_f32 v147, v131
  v_mfma_f32_32x32x16_bf16 v[112:127], v[68:71], v[36:39], v[112:127]
  v_exp_f32 v148, v132
  v_cvt_pk_bf16_f32 v160, v144, v145
  v_exp_f32 v149, v133
  v_cvt_pk_bf16_f32 v161, v146, v147
  v_exp_f32 v150, v134
  v_exp_f32 v151, v135
  v_mfma_f32_32x32x16_bf16 v[168:183], v[76:79], v[164:167], v[168:183]
  v_exp_f32 v152, v136
  buffer_load_dwordx4 v[48:51], v9, s[20:23], s30 offen offset:0 sc1
  v_cvt_pk_bf16_f32 v162, v148, v149
  v_exp_f32 v153, v137
  buffer_load_dwordx4 v[52:55], v9, s[20:23], s30 offen offset:1024 sc1
  v_cvt_pk_bf16_f32 v163, v150, v151
  v_exp_f32 v154, v138
  buffer_load_dwordx4 v[56:59], v9, s[20:23], s30 offen offset:2048 sc1
  v_exp_f32 v155, v139
  buffer_load_dwordx4 v[60:63], v9, s[20:23], s30 offen offset:3072 sc1
  s_add_u32 s30, s30, 4096
  v_mfma_f32_32x32x16_bf16 v[184:199], v[72:75], v[160:163], v[184:199]
  v_exp_f32 v156, v140
  v_cvt_pk_bf16_f32 v164, v152, v153
  v_exp_f32 v157, v141
  v_cvt_pk_bf16_f32 v165, v154, v155
  v_exp_f32 v158, v142
  v_exp_f32 v159, v143
  v_mfma_f32_32x32x16_bf16 v[128:143], v[64:67], v[40:43], 0
  v_exp_f32 v144, v112
  v_cvt_pk_bf16_f32 v166, v156, v157
  v_exp_f32 v145, v113
  v_cvt_pk_bf16_f32 v167, v158, v159
  v_exp_f32 v146, v114
  s_add_u32 m0, s101, 0
  buffer_load_dwordx4 v9, s[16:19], s100 offen offset:0 sc1 lds
  v_exp_f32 v147, v115
  v_mfma_f32_32x32x16_bf16 v[128:143], v[68:71], v[44:47], v[128:143]
  v_exp_f32 v148, v116
  v_cvt_pk_bf16_f32 v160, v144, v145
  v_exp_f32 v149, v117
  v_cvt_pk_bf16_f32 v161, v146, v147
  v_exp_f32 v150, v118
  v_exp_f32 v151, v119
  v_mfma_f32_32x32x16_bf16 v[184:199], v[76:79], v[164:167], v[184:199]
  v_exp_f32 v152, v120
  v_cvt_pk_bf16_f32 v162, v148, v149
  v_exp_f32 v153, v121
  v_cvt_pk_bf16_f32 v163, v150, v151
  v_exp_f32 v154, v122
  v_exp_f32 v155, v123
  v_mfma_f32_32x32x16_bf16 v[200:215], v[72:75], v[160:163], v[200:215]
  v_exp_f32 v156, v124
  v_cvt_pk_bf16_f32 v164, v152, v153
  v_exp_f32 v157, v125
  v_cvt_pk_bf16_f32 v165, v154, v155
  v_exp_f32 v158, v126
  buffer_load_dwordx4 v9, s[16:19], s100 offen offset:1024 sc1 lds
  v_exp_f32 v159, v127
  s_waitcnt vmcnt(24)
  v_mfma_f32_32x32x16_bf16 v[112:127], v[80:83], v[16:19], 0
  v_exp_f32 v144, v128
  v_cvt_pk_bf16_f32 v166, v156, v157
  v_exp_f32 v145, v129
  v_cvt_pk_bf16_f32 v167, v158, v159
  v_exp_f32 v146, v130
  buffer_load_dwordx4 v9, s[16:19], s100 offen offset:2048 sc1 lds
  v_exp_f32 v147, v131
  v_mfma_f32_32x32x16_bf16 v[112:127], v[84:87], v[20:23], v[112:127]
  v_exp_f32 v148, v132
  v_cvt_pk_bf16_f32 v160, v144, v145
  v_exp_f32 v149, v133
  v_cvt_pk_bf16_f32 v161, v146, v147
  v_exp_f32 v150, v134
  v_exp_f32 v151, v135
  v_mfma_f32_32x32x16_bf16 v[200:215], v[76:79], v[164:167], v[200:215]
  v_exp_f32 v152, v136
  v_cvt_pk_bf16_f32 v162, v148, v149
  v_exp_f32 v153, v137
  v_cvt_pk_bf16_f32 v163, v150, v151
  v_exp_f32 v154, v138
  v_exp_f32 v155, v139
  v_mfma_f32_32x32x16_bf16 v[216:231], v[72:75], v[160:163], v[216:231]
  v_exp_f32 v156, v140
  v_cvt_pk_bf16_f32 v164, v152, v153
  v_exp_f32 v157, v141
  v_cvt_pk_bf16_f32 v165, v154, v155
  v_exp_f32 v158, v142
  buffer_load_dwordx4 v9, s[16:19], s100 offen offset:3072 sc1 lds
  v_exp_f32 v159, v143
  v_mfma_f32_32x32x16_bf16 v[128:143], v[80:83], v[24:27], 0
  v_exp_f32 v144, v112
  v_cvt_pk_bf16_f32 v166, v156, v157
  v_exp_f32 v145, v113
  v_cvt_pk_bf16_f32 v167, v158, v159
  v_exp_f32 v146, v114
  s_add_u32 m0, m0, 4096
  s_add_u32 s100, s100, 4096
  buffer_load_dwordx4 v9, s[16:19], s100 offen offset:0 sc1 lds
  v_exp_f32 v147, v115
  v_mfma_f32_32x32x16_bf16 v[128:143], v[84:87], v[28:31], v[128:143]
  v_exp_f32 v148, v116
  v_cvt_pk_bf16_f32 v160, v144, v145
  v_exp_f32 v149, v117
  v_cvt_pk_bf16_f32 v161, v146, v147
  v_exp_f32 v150, v118
  v_exp_f32 v151, v119
  v_mfma_f32_32x32x16_bf16 v[216:231], v[76:79], v[164:167], v[216:231]
  v_exp_f32 v152, v120
  v_cvt_pk_bf16_f32 v162, v148, v149
  v_exp_f32 v153, v121
  v_cvt_pk_bf16_f32 v163, v150, v151
  v_exp_f32 v154, v122
  v_exp_f32 v155, v123
  v_mfma_f32_32x32x16_bf16 v[168:183], v[88:91], v[160:163], v[168:183]
  v_exp_f32 v156, v124
  v_cvt_pk_bf16_f32 v164, v152, v153
  v_exp_f32 v157, v125
  v_cvt_pk_bf16_f32 v165, v154, v155
  v_exp_f32 v158, v126
  buffer_load_dwordx4 v9, s[16:19], s100 offen offset:1024 sc1 lds
  v_exp_f32 v159, v127
  v_mfma_f32_32x32x16_bf16 v[112:127], v[80:83], v[32:35], 0
  v_exp_f32 v144, v128
  v_cvt_pk_bf16_f32 v166, v156, v157
  v_exp_f32 v145, v129
  v_cvt_pk_bf16_f32 v167, v158, v159
  v_exp_f32 v146, v130
  buffer_load_dwordx4 v9, s[16:19], s100 offen offset:2048 sc1 lds
  v_exp_f32 v147, v131
  v_mfma_f32_32x32x16_bf16 v[112:127], v[84:87], v[36:39], v[112:127]
  v_exp_f32 v148, v132
  v_cvt_pk_bf16_f32 v160, v144, v145
  v_exp_f32 v149, v133
  v_cvt_pk_bf16_f32 v161, v146, v147
  v_exp_f32 v150, v134
  v_exp_f32 v151, v135
  v_mfma_f32_32x32x16_bf16 v[168:183], v[92:95], v[164:167], v[168:183]
  v_exp_f32 v152, v136
  buffer_load_dwordx4 v[64:67], v9, s[20:23], s30 offen offset:0 sc1
  v_cvt_pk_bf16_f32 v162, v148, v149
  v_exp_f32 v153, v137
  buffer_load_dwordx4 v[68:71], v9, s[20:23], s30 offen offset:1024 sc1
  v_cvt_pk_bf16_f32 v163, v150, v151
  v_exp_f32 v154, v138
  buffer_load_dwordx4 v[72:75], v9, s[20:23], s30 offen offset:2048 sc1
  v_exp_f32 v155, v139
  buffer_load_dwordx4 v[76:79], v9, s[20:23], s30 offen offset:3072 sc1
  s_add_u32 s30, s30, 4096
  v_mfma_f32_32x32x16_bf16 v[184:199], v[88:91], v[160:163], v[184:199]
  v_exp_f32 v156, v140
  v_cvt_pk_bf16_f32 v164, v152, v153
  v_exp_f32 v157, v141
  v_cvt_pk_bf16_f32 v165, v154, v155
  v_exp_f32 v158, v142
  v_exp_f32 v159, v143
  v_mfma_f32_32x32x16_bf16 v[128:143], v[80:83], v[40:43], 0
  v_exp_f32 v144, v112
  v_cvt_pk_bf16_f32 v166, v156, v157
  v_exp_f32 v145, v113
  v_cvt_pk_bf16_f32 v167, v158, v159
  v_exp_f32 v146, v114
  buffer_load_dword v14, v6, s[16:19], s7 offen offset:0
  v_exp_f32 v147, v115
  v_mfma_f32_32x32x16_bf16 v[128:143], v[84:87], v[44:47], v[128:143]
  v_exp_f32 v148, v116
  v_cvt_pk_bf16_f32 v160, v144, v145
  v_exp_f32 v149, v117
  v_cvt_pk_bf16_f32 v161, v146, v147
  v_exp_f32 v150, v118
  v_exp_f32 v151, v119
  v_mfma_f32_32x32x16_bf16 v[184:199], v[92:95], v[164:167], v[184:199]
  v_exp_f32 v152, v120
  v_cvt_pk_bf16_f32 v162, v148, v149
  v_exp_f32 v153, v121
  v_cvt_pk_bf16_f32 v163, v150, v151
  v_exp_f32 v154, v122
  v_exp_f32 v155, v123
  v_mfma_f32_32x32x16_bf16 v[200:215], v[88:91], v[160:163], v[200:215]
  v_exp_f32 v156, v124
  v_cvt_pk_bf16_f32 v164, v152, v153
  v_exp_f32 v157, v125
  v_cvt_pk_bf16_f32 v165, v154, v155
  v_exp_f32 v158, v126
  s_add_u32 m0, s101, 28672
  s_add_u32 s100, s100, 24576
  buffer_load_dwordx4 v9, s[16:19], s100 offen offset:0 sc1 lds
  v_exp_f32 v159, v127
  s_waitcnt vmcnt(24)
  v_mfma_f32_32x32x16_bf16 v[112:127], v[96:99], v[16:19], 0
  v_exp_f32 v144, v128
  v_cvt_pk_bf16_f32 v166, v156, v157
  v_exp_f32 v145, v129
  v_cvt_pk_bf16_f32 v167, v158, v159
  v_exp_f32 v146, v130
  buffer_load_dwordx4 v9, s[16:19], s100 offen offset:1024 sc1 lds
  v_exp_f32 v147, v131
  v_mfma_f32_32x32x16_bf16 v[112:127], v[100:103], v[20:23], v[112:127]
  v_exp_f32 v148, v132
  v_cvt_pk_bf16_f32 v160, v144, v145
  v_exp_f32 v149, v133
  v_cvt_pk_bf16_f32 v161, v146, v147
  v_exp_f32 v150, v134
  v_exp_f32 v151, v135
  v_mfma_f32_32x32x16_bf16 v[200:215], v[92:95], v[164:167], v[200:215]
  v_exp_f32 v152, v136
  v_cvt_pk_bf16_f32 v162, v148, v149
  v_exp_f32 v153, v137
  v_cvt_pk_bf16_f32 v163, v150, v151
  v_exp_f32 v154, v138
  v_exp_f32 v155, v139
  v_mfma_f32_32x32x16_bf16 v[216:231], v[88:91], v[160:163], v[216:231]
  v_exp_f32 v156, v140
  v_cvt_pk_bf16_f32 v164, v152, v153
  v_exp_f32 v157, v141
  v_cvt_pk_bf16_f32 v165, v154, v155
  v_exp_f32 v158, v142
  buffer_load_dwordx4 v9, s[16:19], s100 offen offset:2048 sc1 lds
  v_exp_f32 v159, v143
  v_mfma_f32_32x32x16_bf16 v[128:143], v[96:99], v[24:27], 0
  v_exp_f32 v144, v112
  v_cvt_pk_bf16_f32 v166, v156, v157
  v_exp_f32 v145, v113
  v_cvt_pk_bf16_f32 v167, v158, v159
  v_exp_f32 v146, v114
  buffer_load_dwordx4 v9, s[16:19], s100 offen offset:3072 sc1 lds
  v_exp_f32 v147, v115
  v_mfma_f32_32x32x16_bf16 v[128:143], v[100:103], v[28:31], v[128:143]
  v_exp_f32 v148, v116
  v_cvt_pk_bf16_f32 v160, v144, v145
  v_exp_f32 v149, v117
  v_cvt_pk_bf16_f32 v161, v146, v147
  v_exp_f32 v150, v118
  v_exp_f32 v151, v119
  v_mfma_f32_32x32x16_bf16 v[216:231], v[92:95], v[164:167], v[216:231]
  v_exp_f32 v152, v120
  v_cvt_pk_bf16_f32 v162, v148, v149
  v_exp_f32 v153, v121
  v_cvt_pk_bf16_f32 v163, v150, v151
  v_exp_f32 v154, v122
  v_exp_f32 v155, v123
  v_mfma_f32_32x32x16_bf16 v[168:183], v[104:107], v[160:163], v[168:183]
  v_exp_f32 v156, v124
  v_cvt_pk_bf16_f32 v164, v152, v153
  v_exp_f32 v157, v125
  v_cvt_pk_bf16_f32 v165, v154, v155
  v_exp_f32 v158, v126
  s_add_u32 m0, m0, 4096
  s_add_u32 s100, s100, 4096
  buffer_load_dwordx4 v9, s[16:19], s100 offen offset:0 sc1 lds
  v_exp_f32 v159, v127
  v_mfma_f32_32x32x16_bf16 v[112:127], v[96:99], v[32:35], 0
  v_exp_f32 v144, v128
  v_cvt_pk_bf16_f32 v166, v156, v157
  v_exp_f32 v145, v129
  v_cvt_pk_bf16_f32 v167, v158, v159
  v_exp_f32 v146, v130
  buffer_load_dwordx4 v9, s[16:19], s100 offen offset:1024 sc1 lds
  v_exp_f32 v147, v131
  v_mfma_f32_32x32x16_bf16 v[112:127], v[100:103], v[36:39], v[112:127]
  v_exp_f32 v148, v132
  v_cvt_pk_bf16_f32 v160, v144, v145
  v_exp_f32 v149, v133
  v_cvt_pk_bf16_f32 v161, v146, v147
  v_exp_f32 v150, v134
  v_exp_f32 v151, v135
  v_mfma_f32_32x32x16_bf16 v[168:183], v[108:111], v[164:167], v[168:183]
  v_exp_f32 v152, v136
  buffer_load_dwordx4 v[80:83], v9, s[20:23], s30 offen offset:0 sc1
  v_cvt_pk_bf16_f32 v162, v148, v149
  v_exp_f32 v153, v137
  buffer_load_dwordx4 v[84:87], v9, s[20:23], s30 offen offset:1024 sc1
  v_cvt_pk_bf16_f32 v163, v150, v151
  v_exp_f32 v154, v138
  buffer_load_dwordx4 v[88:91], v9, s[20:23], s30 offen offset:2048 sc1
  v_exp_f32 v155, v139
  buffer_load_dwordx4 v[92:95], v9, s[20:23], s30 offen offset:3072 sc1
  s_add_u32 s30, s30, 4096
  v_mfma_f32_32x32x16_bf16 v[184:199], v[104:107], v[160:163], v[184:199]
  v_exp_f32 v156, v140
  v_cvt_pk_bf16_f32 v164, v152, v153
  v_exp_f32 v157, v141
  v_cvt_pk_bf16_f32 v165, v154, v155
  v_exp_f32 v158, v142
  v_exp_f32 v159, v143
  v_mfma_f32_32x32x16_bf16 v[128:143], v[96:99], v[40:43], 0
  v_exp_f32 v144, v112
  v_cvt_pk_bf16_f32 v166, v156, v157
  v_exp_f32 v145, v113
  v_cvt_pk_bf16_f32 v167, v158, v159
  v_exp_f32 v146, v114
  buffer_load_dwordx4 v9, s[16:19], s100 offen offset:2048 sc1 lds
  v_exp_f32 v147, v115
  v_mfma_f32_32x32x16_bf16 v[128:143], v[100:103], v[44:47], v[128:143]
  v_exp_f32 v148, v116
  v_cvt_pk_bf16_f32 v160, v144, v145
  v_exp_f32 v149, v117
  v_cvt_pk_bf16_f32 v161, v146, v147
  v_exp_f32 v150, v118
  v_exp_f32 v151, v119
  v_mfma_f32_32x32x16_bf16 v[184:199], v[108:111], v[164:167], v[184:199]
  v_exp_f32 v152, v120
  v_cvt_pk_bf16_f32 v162, v148, v149
  v_exp_f32 v153, v121
  v_cvt_pk_bf16_f32 v163, v150, v151
  v_exp_f32 v154, v122
  v_exp_f32 v155, v123
  v_mfma_f32_32x32x16_bf16 v[200:215], v[104:107], v[160:163], v[200:215]
  v_exp_f32 v156, v124
  v_cvt_pk_bf16_f32 v164, v152, v153
  v_exp_f32 v157, v125
  v_cvt_pk_bf16_f32 v165, v154, v155
  v_exp_f32 v158, v126
  s_add_u32 m0, s101, 57344
  s_add_u32 s100, s100, 24576
  buffer_load_dwordx4 v9, s[16:19], s100 offen offset:0 sc1 lds
  v_exp_f32 v159, v127
  s_waitcnt vmcnt(24)
  v_mfma_f32_32x32x16_bf16 v[112:127], v[48:51], v[16:19], 0
  v_exp_f32 v144, v128
  v_cvt_pk_bf16_f32 v166, v156, v157
  v_exp_f32 v145, v129
  v_cvt_pk_bf16_f32 v167, v158, v159
  v_exp_f32 v146, v130
  buffer_load_dwordx4 v9, s[16:19], s100 offen offset:1024 sc1 lds
  v_exp_f32 v147, v131
  v_mfma_f32_32x32x16_bf16 v[112:127], v[52:55], v[20:23], v[112:127]
  v_exp_f32 v148, v132
  v_cvt_pk_bf16_f32 v160, v144, v145
  v_exp_f32 v149, v133
  v_cvt_pk_bf16_f32 v161, v146, v147
  v_exp_f32 v150, v134
  v_exp_f32 v151, v135
  v_mfma_f32_32x32x16_bf16 v[200:215], v[108:111], v[164:167], v[200:215]
  v_exp_f32 v152, v136
  v_cvt_pk_bf16_f32 v162, v148, v149
  v_exp_f32 v153, v137
  v_cvt_pk_bf16_f32 v163, v150, v151
  v_exp_f32 v154, v138
  v_exp_f32 v155, v139
  v_mfma_f32_32x32x16_bf16 v[216:231], v[104:107], v[160:163], v[216:231]
  v_exp_f32 v156, v140
  v_cvt_pk_bf16_f32 v164, v152, v153
  v_exp_f32 v157, v141
  v_cvt_pk_bf16_f32 v165, v154, v155
  v_exp_f32 v158, v142
  buffer_load_dwordx4 v9, s[16:19], s100 offen offset:2048 sc1 lds
  v_exp_f32 v159, v143
  v_mfma_f32_32x32x16_bf16 v[128:143], v[48:51], v[24:27], 0
  v_exp_f32 v144, v112
  v_cvt_pk_bf16_f32 v166, v156, v157
  v_exp_f32 v145, v113
  v_cvt_pk_bf16_f32 v167, v158, v159
  v_exp_f32 v146, v114
  buffer_load_dwordx4 v9, s[16:19], s100 offen offset:3072 sc1 lds
  v_exp_f32 v147, v115
  v_mfma_f32_32x32x16_bf16 v[128:143], v[52:55], v[28:31], v[128:143]
  v_exp_f32 v148, v116
  v_cvt_pk_bf16_f32 v160, v144, v145
  v_exp_f32 v149, v117
  v_cvt_pk_bf16_f32 v161, v146, v147
  v_exp_f32 v150, v118
  v_exp_f32 v151, v119
  v_mfma_f32_32x32x16_bf16 v[216:231], v[108:111], v[164:167], v[216:231]
  v_exp_f32 v152, v120
  v_cvt_pk_bf16_f32 v162, v148, v149
  v_exp_f32 v153, v121
  v_cvt_pk_bf16_f32 v163, v150, v151
  v_exp_f32 v154, v122
  v_exp_f32 v155, v123
  v_mfma_f32_32x32x16_bf16 v[168:183], v[56:59], v[160:163], v[168:183]
  v_exp_f32 v156, v124
  v_cvt_pk_bf16_f32 v164, v152, v153
  v_exp_f32 v157, v125
  v_cvt_pk_bf16_f32 v165, v154, v155
  v_exp_f32 v158, v126
  s_add_u32 m0, m0, 4096
  s_add_u32 s100, s100, 4096
  buffer_load_dwordx4 v9, s[16:19], s100 offen offset:0 sc1 lds
  v_exp_f32 v159, v127
  v_mfma_f32_32x32x16_bf16 v[112:127], v[48:51], v[32:35], 0
  v_exp_f32 v144, v128
  v_cvt_pk_bf16_f32 v166, v156, v157
  v_exp_f32 v145, v129
  v_cvt_pk_bf16_f32 v167, v158, v159
  v_exp_f32 v146, v130
  buffer_load_dwordx4 v9, s[16:19], s100 offen offset:1024 sc1 lds
  v_exp_f32 v147, v131
  v_mfma_f32_32x32x16_bf16 v[112:127], v[52:55], v[36:39], v[112:127]
  v_exp_f32 v148, v132
  v_cvt_pk_bf16_f32 v160, v144, v145
  v_exp_f32 v149, v133
  v_cvt_pk_bf16_f32 v161, v146, v147
  v_exp_f32 v150, v134
  v_exp_f32 v151, v135
  v_mfma_f32_32x32x16_bf16 v[168:183], v[60:63], v[164:167], v[168:183]
  v_exp_f32 v152, v136
  buffer_load_dwordx4 v[96:99], v9, s[20:23], s30 offen offset:0 sc1
  v_cvt_pk_bf16_f32 v162, v148, v149
  v_exp_f32 v153, v137
  buffer_load_dwordx4 v[100:103], v9, s[20:23], s30 offen offset:1024 sc1
  v_cvt_pk_bf16_f32 v163, v150, v151
  v_exp_f32 v154, v138
  buffer_load_dwordx4 v[104:107], v9, s[20:23], s30 offen offset:2048 sc1
  v_exp_f32 v155, v139
  buffer_load_dwordx4 v[108:111], v9, s[20:23], s30 offen offset:3072 sc1
  s_add_u32 s30, s30, 4096
  v_mfma_f32_32x32x16_bf16 v[184:199], v[56:59], v[160:163], v[184:199]
  v_exp_f32 v156, v140
  v_cvt_pk_bf16_f32 v164, v152, v153
  v_exp_f32 v157, v141
  v_cvt_pk_bf16_f32 v165, v154, v155
  v_exp_f32 v158, v142
  v_exp_f32 v159, v143
  v_mfma_f32_32x32x16_bf16 v[128:143], v[48:51], v[40:43], 0
  v_exp_f32 v144, v112
  v_cvt_pk_bf16_f32 v166, v156, v157
  v_exp_f32 v145, v113
  v_cvt_pk_bf16_f32 v167, v158, v159
  v_exp_f32 v146, v114
  buffer_load_dword v14, v6, s[16:19], s7 offen offset:2048
  v_exp_f32 v147, v115
  v_mfma_f32_32x32x16_bf16 v[128:143], v[52:55], v[44:47], v[128:143]
  v_exp_f32 v148, v116
  v_cvt_pk_bf16_f32 v160, v144, v145
  v_exp_f32 v149, v117
  v_cvt_pk_bf16_f32 v161, v146, v147
  v_exp_f32 v150, v118
  v_exp_f32 v151, v119
  v_mfma_f32_32x32x16_bf16 v[184:199], v[60:63], v[164:167], v[184:199]
  v_exp_f32 v152, v120
  v_cvt_pk_bf16_f32 v162, v148, v149
  v_exp_f32 v153, v121
  v_cvt_pk_bf16_f32 v163, v150, v151
  v_exp_f32 v154, v122
  v_exp_f32 v155, v123
  v_mfma_f32_32x32x16_bf16 v[200:215], v[56:59], v[160:163], v[200:215]
  v_exp_f32 v156, v124
  v_cvt_pk_bf16_f32 v164, v152, v153
  v_exp_f32 v157, v125
  v_cvt_pk_bf16_f32 v165, v154, v155
  v_exp_f32 v158, v126
  buffer_load_dwordx4 v9, s[16:19], s100 offen offset:2048 sc1 lds
  v_exp_f32 v159, v127
  s_waitcnt vmcnt(24)
  v_mfma_f32_32x32x16_bf16 v[112:127], v[64:67], v[16:19], 0
  v_exp_f32 v144, v128
  v_cvt_pk_bf16_f32 v166, v156, v157
  v_exp_f32 v145, v129
  v_cvt_pk_bf16_f32 v167, v158, v159
  v_exp_f32 v146, v130
  s_add_u32 m0, s101, 86016
  s_add_u32 s100, s100, 24576
  buffer_load_dwordx4 v9, s[16:19], s100 offen offset:0 sc1 lds
  v_exp_f32 v147, v131
  v_mfma_f32_32x32x16_bf16 v[112:127], v[68:71], v[20:23], v[112:127]
  v_exp_f32 v148, v132
  v_cvt_pk_bf16_f32 v160, v144, v145
  v_exp_f32 v149, v133
  v_cvt_pk_bf16_f32 v161, v146, v147
  v_exp_f32 v150, v134
  v_exp_f32 v151, v135
  v_mfma_f32_32x32x16_bf16 v[200:215], v[60:63], v[164:167], v[200:215]
  v_exp_f32 v152, v136
  v_cvt_pk_bf16_f32 v162, v148, v149
  v_exp_f32 v153, v137
  v_cvt_pk_bf16_f32 v163, v150, v151
  v_exp_f32 v154, v138
  v_exp_f32 v155, v139
  v_mfma_f32_32x32x16_bf16 v[216:231], v[56:59], v[160:163], v[216:231]
  v_exp_f32 v156, v140
  v_cvt_pk_bf16_f32 v164, v152, v153
  v_exp_f32 v157, v141
  v_cvt_pk_bf16_f32 v165, v154, v155
  v_exp_f32 v158, v142
  buffer_load_dwordx4 v9, s[16:19], s100 offen offset:1024 sc1 lds
  v_exp_f32 v159, v143
  v_mfma_f32_32x32x16_bf16 v[128:143], v[64:67], v[24:27], 0
  v_exp_f32 v144, v112
  v_cvt_pk_bf16_f32 v166, v156, v157
  v_exp_f32 v145, v113
  v_cvt_pk_bf16_f32 v167, v158, v159
  v_exp_f32 v146, v114
  buffer_load_dwordx4 v9, s[16:19], s100 offen offset:2048 sc1 lds
  v_exp_f32 v147, v115
  v_mfma_f32_32x32x16_bf16 v[128:143], v[68:71], v[28:31], v[128:143]
  v_exp_f32 v148, v116
  v_cvt_pk_bf16_f32 v160, v144, v145
  v_exp_f32 v149, v117
  v_cvt_pk_bf16_f32 v161, v146, v147
  v_exp_f32 v150, v118
  v_exp_f32 v151, v119
  v_mfma_f32_32x32x16_bf16 v[216:231], v[60:63], v[164:167], v[216:231]
  v_exp_f32 v152, v120
  v_cvt_pk_bf16_f32 v162, v148, v149
  v_exp_f32 v153, v121
  v_cvt_pk_bf16_f32 v163, v150, v151
  v_exp_f32 v154, v122
  v_exp_f32 v155, v123
  v_mfma_f32_32x32x16_bf16 v[168:183], v[72:75], v[160:163], v[168:183]
  v_exp_f32 v156, v124
  v_cvt_pk_bf16_f32 v164, v152, v153
  v_exp_f32 v157, v125
  v_cvt_pk_bf16_f32 v165, v154, v155
  v_exp_f32 v158, v126
  buffer_load_dwordx4 v9, s[16:19], s100 offen offset:3072 sc1 lds
  v_exp_f32 v159, v127
  v_mfma_f32_32x32x16_bf16 v[112:127], v[64:67], v[32:35], 0
  v_exp_f32 v144, v128
  v_cvt_pk_bf16_f32 v166, v156, v157
  v_exp_f32 v145, v129
  v_cvt_pk_bf16_f32 v167, v158, v159
  v_exp_f32 v146, v130
  s_add_u32 m0, m0, 4096
  s_add_u32 s100, s100, 4096
  buffer_load_dwordx4 v9, s[16:19], s100 offen offset:0 sc1 lds
  v_exp_f32 v147, v131
  v_mfma_f32_32x32x16_bf16 v[112:127], v[68:71], v[36:39], v[112:127]
  v_exp_f32 v148, v132
  v_cvt_pk_bf16_f32 v160, v144, v145
  v_exp_f32 v149, v133
  v_cvt_pk_bf16_f32 v161, v146, v147
  v_exp_f32 v150, v134
  v_exp_f32 v151, v135
  v_mfma_f32_32x32x16_bf16 v[168:183], v[76:79], v[164:167], v[168:183]
  v_exp_f32 v152, v136
  buffer_load_dwordx4 v[48:51], v9, s[20:23], s30 offen offset:0 sc1
  v_cvt_pk_bf16_f32 v162, v148, v149
  v_exp_f32 v153, v137
  buffer_load_dwordx4 v[52:55], v9, s[20:23], s30 offen offset:1024 sc1
  v_cvt_pk_bf16_f32 v163, v150, v151
  v_exp_f32 v154, v138
  buffer_load_dwordx4 v[56:59], v9, s[20:23], s30 offen offset:2048 sc1
  v_exp_f32 v155, v139
  buffer_load_dwordx4 v[60:63], v9, s[20:23], s30 offen offset:3072 sc1
  s_add_u32 s30, s30, 4096
  v_mfma_f32_32x32x16_bf16 v[184:199], v[72:75], v[160:163], v[184:199]
  v_exp_f32 v156, v140
  v_cvt_pk_bf16_f32 v164, v152, v153
  v_exp_f32 v157, v141
  v_cvt_pk_bf16_f32 v165, v154, v155
  v_exp_f32 v158, v142
  v_exp_f32 v159, v143
  v_mfma_f32_32x32x16_bf16 v[128:143], v[64:67], v[40:43], 0
  v_exp_f32 v144, v112
  v_cvt_pk_bf16_f32 v166, v156, v157
  v_exp_f32 v145, v113
  v_cvt_pk_bf16_f32 v167, v158, v159
  v_exp_f32 v146, v114
  buffer_load_dwordx4 v9, s[16:19], s100 offen offset:1024 sc1 lds
  v_exp_f32 v147, v115
  v_mfma_f32_32x32x16_bf16 v[128:143], v[68:71], v[44:47], v[128:143]
  v_exp_f32 v148, v116
  v_cvt_pk_bf16_f32 v160, v144, v145
  v_exp_f32 v149, v117
  v_cvt_pk_bf16_f32 v161, v146, v147
  v_exp_f32 v150, v118
  v_exp_f32 v151, v119
  v_mfma_f32_32x32x16_bf16 v[184:199], v[76:79], v[164:167], v[184:199]
  v_exp_f32 v152, v120
  v_cvt_pk_bf16_f32 v162, v148, v149
  v_exp_f32 v153, v121
  v_cvt_pk_bf16_f32 v163, v150, v151
  v_exp_f32 v154, v122
  v_exp_f32 v155, v123
  v_mfma_f32_32x32x16_bf16 v[200:215], v[72:75], v[160:163], v[200:215]
  v_exp_f32 v156, v124
  v_cvt_pk_bf16_f32 v164, v152, v153
  v_exp_f32 v157, v125
  v_cvt_pk_bf16_f32 v165, v154, v155
  v_exp_f32 v158, v126
  buffer_load_dwordx4 v9, s[16:19], s100 offen offset:2048 sc1 lds
  v_exp_f32 v159, v127
  s_waitcnt vmcnt(24)
  v_mfma_f32_32x32x16_bf16 v[112:127], v[80:83], v[16:19], 0
  v_exp_f32 v144, v128
  v_cvt_pk_bf16_f32 v166, v156, v157
  v_exp_f32 v145, v129
  v_cvt_pk_bf16_f32 v167, v158, v159
  v_exp_f32 v146, v130
  buffer_load_dwordx4 a[64:67], v9, s[16:19], s5 offen offset:0 sc1
  v_exp_f32 v147, v131
  v_mfma_f32_32x32x16_bf16 v[112:127], v[84:87], v[20:23], v[112:127]
  v_exp_f32 v148, v132
  v_cvt_pk_bf16_f32 v160, v144, v145
  v_exp_f32 v149, v133
  v_cvt_pk_bf16_f32 v161, v146, v147
  v_exp_f32 v150, v134
  v_exp_f32 v151, v135
  v_mfma_f32_32x32x16_bf16 v[200:215], v[76:79], v[164:167], v[200:215]
  v_exp_f32 v152, v136
  v_cvt_pk_bf16_f32 v162, v148, v149
  v_exp_f32 v153, v137
  v_cvt_pk_bf16_f32 v163, v150, v151
  v_exp_f32 v154, v138
  v_exp_f32 v155, v139
  v_mfma_f32_32x32x16_bf16 v[216:231], v[72:75], v[160:163], v[216:231]
  v_exp_f32 v156, v140
  v_cvt_pk_bf16_f32 v164, v152, v153
  v_exp_f32 v157, v141
  v_cvt_pk_bf16_f32 v165, v154, v155
  v_exp_f32 v158, v142
  buffer_load_dwordx4 a[68:71], v9, s[16:19], s5 offen offset:1024 sc1
  v_exp_f32 v159, v143
  v_mfma_f32_32x32x16_bf16 v[128:143], v[80:83], v[24:27], 0
  v_exp_f32 v144, v112
  v_cvt_pk_bf16_f32 v166, v156, v157
  v_exp_f32 v145, v113
  v_cvt_pk_bf16_f32 v167, v158, v159
  v_exp_f32 v146, v114
  buffer_load_dwordx4 a[72:75], v9, s[16:19], s5 offen offset:2048 sc1
  v_exp_f32 v147, v115
  v_mfma_f32_32x32x16_bf16 v[128:143], v[84:87], v[28:31], v[128:143]
  v_exp_f32 v148, v116
  v_cvt_pk_bf16_f32 v160, v144, v145
  v_exp_f32 v149, v117
  v_cvt_pk_bf16_f32 v161, v146, v147
  v_exp_f32 v150, v118
  v_exp_f32 v151, v119
  v_mfma_f32_32x32x16_bf16 v[216:231], v[76:79], v[164:167], v[216:231]
  v_exp_f32 v152, v120
  v_cvt_pk_bf16_f32 v162, v148, v149
  v_exp_f32 v153, v121
  v_cvt_pk_bf16_f32 v163, v150, v151
  v_exp_f32 v154, v122
  v_exp_f32 v155, v123
  v_mfma_f32_32x32x16_bf16 v[168:183], v[88:91], v[160:163], v[168:183]
  v_exp_f32 v156, v124
  v_cvt_pk_bf16_f32 v164, v152, v153
  v_exp_f32 v157, v125
  v_cvt_pk_bf16_f32 v165, v154, v155
  v_exp_f32 v158, v126
  buffer_load_dwordx4 a[76:79], v9, s[16:19], s5 offen offset:3072 sc1
  v_exp_f32 v159, v127
  v_mfma_f32_32x32x16_bf16 v[112:127], v[80:83], v[32:35], 0
  v_exp_f32 v144, v128
  v_cvt_pk_bf16_f32 v166, v156, v157
  v_exp_f32 v145, v129
  v_cvt_pk_bf16_f32 v167, v158, v159
  v_exp_f32 v146, v130
  s_add_u32 s5, s5, 4096
  buffer_load_dwordx4 a[80:83], v9, s[16:19], s5 offen offset:0 sc1
  v_exp_f32 v147, v131
  v_mfma_f32_32x32x16_bf16 v[112:127], v[84:87], v[36:39], v[112:127]
  v_exp_f32 v148, v132
  v_cvt_pk_bf16_f32 v160, v144, v145
  v_exp_f32 v149, v133
  v_cvt_pk_bf16_f32 v161, v146, v147
  v_exp_f32 v150, v134
  v_exp_f32 v151, v135
  v_mfma_f32_32x32x16_bf16 v[168:183], v[92:95], v[164:167], v[168:183]
  v_exp_f32 v152, v136
  buffer_load_dwordx4 v[64:67], v9, s[20:23], s30 offen offset:0 sc1
  v_cvt_pk_bf16_f32 v162, v148, v149
  v_exp_f32 v153, v137
  buffer_load_dwordx4 v[68:71], v9, s[20:23], s30 offen offset:1024 sc1
  v_cvt_pk_bf16_f32 v163, v150, v151
  v_exp_f32 v154, v138
  buffer_load_dwordx4 v[72:75], v9, s[20:23], s30 offen offset:2048 sc1
  v_exp_f32 v155, v139
  buffer_load_dwordx4 v[76:79], v9, s[20:23], s30 offen offset:3072 sc1
  s_add_u32 s30, s30, 4096
  v_mfma_f32_32x32x16_bf16 v[184:199], v[88:91], v[160:163], v[184:199]
  v_exp_f32 v156, v140
  v_cvt_pk_bf16_f32 v164, v152, v153
  v_exp_f32 v157, v141
  v_cvt_pk_bf16_f32 v165, v154, v155
  v_exp_f32 v158, v142
  v_exp_f32 v159, v143
  v_mfma_f32_32x32x16_bf16 v[128:143], v[80:83], v[40:43], 0
  v_exp_f32 v144, v112
  v_cvt_pk_bf16_f32 v166, v156, v157
  v_exp_f32 v145, v113
  v_cvt_pk_bf16_f32 v167, v158, v159
  v_exp_f32 v146, v114
  s_add_u32 s7, s7, 4096
  buffer_load_dword v14, v6, s[16:19], s7 offen offset:0
  v_exp_f32 v147, v115
  v_mfma_f32_32x32x16_bf16 v[128:143], v[84:87], v[44:47], v[128:143]
  v_exp_f32 v148, v116
  v_cvt_pk_bf16_f32 v160, v144, v145
  v_exp_f32 v149, v117
  v_cvt_pk_bf16_f32 v161, v146, v147
  v_exp_f32 v150, v118
  v_exp_f32 v151, v119
  v_mfma_f32_32x32x16_bf16 v[184:199], v[92:95], v[164:167], v[184:199]
  v_exp_f32 v152, v120
  v_cvt_pk_bf16_f32 v162, v148, v149
  v_exp_f32 v153, v121
  v_cvt_pk_bf16_f32 v163, v150, v151
  v_exp_f32 v154, v122
  v_exp_f32 v155, v123
  v_mfma_f32_32x32x16_bf16 v[200:215], v[88:91], v[160:163], v[200:215]
  v_exp_f32 v156, v124
  v_cvt_pk_bf16_f32 v164, v152, v153
  v_exp_f32 v157, v125
  v_cvt_pk_bf16_f32 v165, v154, v155
  v_exp_f32 v158, v126
  buffer_load_dwordx4 a[84:87], v9, s[16:19], s5 offen offset:1024 sc1
  v_exp_f32 v159, v127
  s_waitcnt vmcnt(24)
  v_mfma_f32_32x32x16_bf16 v[112:127], v[96:99], v[16:19], 0
  v_exp_f32 v144, v128
  v_cvt_pk_bf16_f32 v166, v156, v157
  v_exp_f32 v145, v129
  v_cvt_pk_bf16_f32 v167, v158, v159
  v_exp_f32 v146, v130
  buffer_load_dwordx4 a[88:91], v9, s[16:19], s5 offen offset:2048 sc1
  v_exp_f32 v147, v131
  v_mfma_f32_32x32x16_bf16 v[112:127], v[100:103], v[20:23], v[112:127]
  v_exp_f32 v148, v132
  v_cvt_pk_bf16_f32 v160, v144, v145
  v_exp_f32 v149, v133
  v_cvt_pk_bf16_f32 v161, v146, v147
  v_exp_f32 v150, v134
  v_exp_f32 v151, v135
  v_mfma_f32_32x32x16_bf16 v[200:215], v[92:95], v[164:167], v[200:215]
  v_exp_f32 v152, v136
  v_cvt_pk_bf16_f32 v162, v148, v149
  v_exp_f32 v153, v137
  v_cvt_pk_bf16_f32 v163, v150, v151
  v_exp_f32 v154, v138
  v_exp_f32 v155, v139
  v_mfma_f32_32x32x16_bf16 v[216:231], v[88:91], v[160:163], v[216:231]
  v_exp_f32 v156, v140
  v_cvt_pk_bf16_f32 v164, v152, v153
  v_exp_f32 v157, v141
  v_cvt_pk_bf16_f32 v165, v154, v155
  v_exp_f32 v158, v142
  buffer_load_dwordx4 a[112:115], v9, s[16:19], s98 offen offset:0 sc1
  v_exp_f32 v159, v143
  v_mfma_f32_32x32x16_bf16 v[128:143], v[96:99], v[24:27], 0
  v_exp_f32 v144, v112
  v_cvt_pk_bf16_f32 v166, v156, v157
  v_exp_f32 v145, v113
  v_cvt_pk_bf16_f32 v167, v158, v159
  v_exp_f32 v146, v114
  buffer_load_dwordx4 a[116:119], v9, s[16:19], s99 offen offset:0 sc1
  v_exp_f32 v147, v115
  v_mfma_f32_32x32x16_bf16 v[128:143], v[100:103], v[28:31], v[128:143]
  v_exp_f32 v148, v116
  v_cvt_pk_bf16_f32 v160, v144, v145
  v_exp_f32 v149, v117
  v_cvt_pk_bf16_f32 v161, v146, v147
  v_exp_f32 v150, v118
  v_exp_f32 v151, v119
  v_mfma_f32_32x32x16_bf16 v[216:231], v[92:95], v[164:167], v[216:231]
  v_exp_f32 v152, v120
  v_cvt_pk_bf16_f32 v162, v148, v149
  v_exp_f32 v153, v121
  v_cvt_pk_bf16_f32 v163, v150, v151
  v_exp_f32 v154, v122
  v_exp_f32 v155, v123
  v_mfma_f32_32x32x16_bf16 v[168:183], v[104:107], v[160:163], v[168:183]
  v_exp_f32 v156, v124
  v_cvt_pk_bf16_f32 v164, v152, v153
  v_exp_f32 v157, v125
  v_cvt_pk_bf16_f32 v165, v154, v155
  v_exp_f32 v158, v126
  buffer_load_dwordx4 a[120:123], v9, s[16:19], s98 offen offset:1024 sc1
  v_exp_f32 v159, v127
  v_mfma_f32_32x32x16_bf16 v[112:127], v[96:99], v[32:35], 0
  v_exp_f32 v144, v128
  v_cvt_pk_bf16_f32 v166, v156, v157
  v_exp_f32 v145, v129
  v_cvt_pk_bf16_f32 v167, v158, v159
  v_exp_f32 v146, v130
  buffer_load_dwordx4 a[124:127], v9, s[16:19], s99 offen offset:1024 sc1
  v_exp_f32 v147, v131
  v_mfma_f32_32x32x16_bf16 v[112:127], v[100:103], v[36:39], v[112:127]
  v_exp_f32 v148, v132
  v_cvt_pk_bf16_f32 v160, v144, v145
  v_exp_f32 v149, v133
  v_cvt_pk_bf16_f32 v161, v146, v147
  v_exp_f32 v150, v134
  v_exp_f32 v151, v135
  v_mfma_f32_32x32x16_bf16 v[168:183], v[108:111], v[164:167], v[168:183]
  v_exp_f32 v152, v136
  buffer_load_dwordx4 v[80:83], v9, s[20:23], s30 offen offset:0 sc1
  v_cvt_pk_bf16_f32 v162, v148, v149
  v_exp_f32 v153, v137
  buffer_load_dwordx4 v[84:87], v9, s[20:23], s30 offen offset:1024 sc1
  v_cvt_pk_bf16_f32 v163, v150, v151
  v_exp_f32 v154, v138
  buffer_load_dwordx4 v[88:91], v9, s[20:23], s30 offen offset:2048 sc1
  v_exp_f32 v155, v139
  buffer_load_dwordx4 v[92:95], v9, s[20:23], s30 offen offset:3072 sc1
  s_add_u32 s30, s30, 4096
  v_mfma_f32_32x32x16_bf16 v[184:199], v[104:107], v[160:163], v[184:199]
  v_exp_f32 v156, v140
  v_cvt_pk_bf16_f32 v164, v152, v153
  v_exp_f32 v157, v141
  v_cvt_pk_bf16_f32 v165, v154, v155
  v_exp_f32 v158, v142
  v_exp_f32 v159, v143
  v_mfma_f32_32x32x16_bf16 v[128:143], v[96:99], v[40:43], 0
  v_exp_f32 v144, v112
  v_cvt_pk_bf16_f32 v166, v156, v157
  v_exp_f32 v145, v113
  v_cvt_pk_bf16_f32 v167, v158, v159
  v_exp_f32 v146, v114
  buffer_load_dwordx4 a[128:131], v9, s[16:19], s98 offen offset:2048 sc1
  v_exp_f32 v147, v115
  v_mfma_f32_32x32x16_bf16 v[128:143], v[100:103], v[44:47], v[128:143]
  v_exp_f32 v148, v116
  v_cvt_pk_bf16_f32 v160, v144, v145
  v_exp_f32 v149, v117
  v_cvt_pk_bf16_f32 v161, v146, v147
  v_exp_f32 v150, v118
  v_exp_f32 v151, v119
  v_mfma_f32_32x32x16_bf16 v[184:199], v[108:111], v[164:167], v[184:199]
  v_exp_f32 v152, v120
  v_cvt_pk_bf16_f32 v162, v148, v149
  v_exp_f32 v153, v121
  v_cvt_pk_bf16_f32 v163, v150, v151
  v_exp_f32 v154, v122
  v_exp_f32 v155, v123
  v_mfma_f32_32x32x16_bf16 v[200:215], v[104:107], v[160:163], v[200:215]
  v_exp_f32 v156, v124
  v_cvt_pk_bf16_f32 v164, v152, v153
  v_exp_f32 v157, v125
  v_cvt_pk_bf16_f32 v165, v154, v155
  v_exp_f32 v158, v126
  buffer_load_dwordx4 a[132:135], v9, s[16:19], s99 offen offset:2048 sc1
  v_exp_f32 v159, v127
  s_waitcnt vmcnt(24)
  v_mfma_f32_32x32x16_bf16 v[112:127], v[48:51], v[16:19], 0
  v_exp_f32 v144, v128
  v_cvt_pk_bf16_f32 v166, v156, v157
  v_exp_f32 v145, v129
  v_cvt_pk_bf16_f32 v167, v158, v159
  v_exp_f32 v146, v130
  buffer_load_dwordx4 a[136:139], v9, s[16:19], s98 offen offset:3072 sc1
  v_exp_f32 v147, v131
  v_mfma_f32_32x32x16_bf16 v[112:127], v[52:55], v[20:23], v[112:127]
  v_exp_f32 v148, v132
  v_cvt_pk_bf16_f32 v160, v144, v145
  v_exp_f32 v149, v133
  v_cvt_pk_bf16_f32 v161, v146, v147
  v_exp_f32 v150, v134
  v_exp_f32 v151, v135
  v_mfma_f32_32x32x16_bf16 v[200:215], v[108:111], v[164:167], v[200:215]
  v_exp_f32 v152, v136
  v_cvt_pk_bf16_f32 v162, v148, v149
  v_exp_f32 v153, v137
  v_cvt_pk_bf16_f32 v163, v150, v151
  v_exp_f32 v154, v138
  v_exp_f32 v155, v139
  v_mfma_f32_32x32x16_bf16 v[216:231], v[104:107], v[160:163], v[216:231]
  v_exp_f32 v156, v140
  v_cvt_pk_bf16_f32 v164, v152, v153
  v_exp_f32 v157, v141
  v_cvt_pk_bf16_f32 v165, v154, v155
  v_exp_f32 v158, v142
  buffer_load_dwordx4 a[140:143], v9, s[16:19], s99 offen offset:3072 sc1
  v_exp_f32 v159, v143
  v_mfma_f32_32x32x16_bf16 v[128:143], v[48:51], v[24:27], 0
  v_exp_f32 v144, v112
  v_cvt_pk_bf16_f32 v166, v156, v157
  v_exp_f32 v145, v113
  v_cvt_pk_bf16_f32 v167, v158, v159
  v_exp_f32 v146, v114
  s_add_u32 s98, s98, 7168
  buffer_load_dwordx4 a[144:147], v9, s[16:19], s98 offen offset:0 sc1
  v_exp_f32 v147, v115
  v_mfma_f32_32x32x16_bf16 v[128:143], v[52:55], v[28:31], v[128:143]
  v_exp_f32 v148, v116
  v_cvt_pk_bf16_f32 v160, v144, v145
  v_exp_f32 v149, v117
  v_cvt_pk_bf16_f32 v161, v146, v147
  v_exp_f32 v150, v118
  v_exp_f32 v151, v119
  v_mfma_f32_32x32x16_bf16 v[216:231], v[108:111], v[164:167], v[216:231]
  v_exp_f32 v152, v120
  v_cvt_pk_bf16_f32 v162, v148, v149
  v_exp_f32 v153, v121
  v_cvt_pk_bf16_f32 v163, v150, v151
  v_exp_f32 v154, v122
  v_exp_f32 v155, v123
  v_mfma_f32_32x32x16_bf16 v[168:183], v[56:59], v[160:163], v[168:183]
  v_exp_f32 v156, v124
  v_cvt_pk_bf16_f32 v164, v152, v153
  v_exp_f32 v157, v125
  v_cvt_pk_bf16_f32 v165, v154, v155
  v_exp_f32 v158, v126
  s_add_u32 s99, s99, 7168
  buffer_load_dwordx4 a[148:151], v9, s[16:19], s99 offen offset:0 sc1
  v_exp_f32 v159, v127
  v_mfma_f32_32x32x16_bf16 v[112:127], v[48:51], v[32:35], 0
  v_exp_f32 v144, v128
  v_cvt_pk_bf16_f32 v166, v156, v157
  v_exp_f32 v145, v129
  v_cvt_pk_bf16_f32 v167, v158, v159
  v_exp_f32 v146, v130
  buffer_load_dwordx4 a[152:155], v9, s[16:19], s98 offen offset:1024 sc1
  v_exp_f32 v147, v131
  v_mfma_f32_32x32x16_bf16 v[112:127], v[52:55], v[36:39], v[112:127]
  v_exp_f32 v148, v132
  v_cvt_pk_bf16_f32 v160, v144, v145
  v_exp_f32 v149, v133
  v_cvt_pk_bf16_f32 v161, v146, v147
  v_exp_f32 v150, v134
  v_exp_f32 v151, v135
  v_mfma_f32_32x32x16_bf16 v[168:183], v[60:63], v[164:167], v[168:183]
  v_exp_f32 v152, v136
  buffer_load_dwordx4 v[96:99], v9, s[20:23], s30 offen offset:0 sc1
  v_cvt_pk_bf16_f32 v162, v148, v149
  v_exp_f32 v153, v137
  buffer_load_dwordx4 v[100:103], v9, s[20:23], s30 offen offset:1024 sc1
  v_cvt_pk_bf16_f32 v163, v150, v151
  v_exp_f32 v154, v138
  buffer_load_dwordx4 v[104:107], v9, s[20:23], s30 offen offset:2048 sc1
  v_exp_f32 v155, v139
  buffer_load_dwordx4 v[108:111], v9, s[20:23], s30 offen offset:3072 sc1
  s_add_u32 s30, s30, 4096
  v_mfma_f32_32x32x16_bf16 v[184:199], v[56:59], v[160:163], v[184:199]
  v_exp_f32 v156, v140
  v_cvt_pk_bf16_f32 v164, v152, v153
  v_exp_f32 v157, v141
  v_cvt_pk_bf16_f32 v165, v154, v155
  v_exp_f32 v158, v142
  v_exp_f32 v159, v143
  v_mfma_f32_32x32x16_bf16 v[128:143], v[48:51], v[40:43], 0
  v_exp_f32 v144, v112
  v_cvt_pk_bf16_f32 v166, v156, v157
  v_exp_f32 v145, v113
  v_cvt_pk_bf16_f32 v167, v158, v159
  v_exp_f32 v146, v114
  buffer_load_dword v14, v6, s[16:19], s7 offen offset:2048
  v_exp_f32 v147, v115
  v_mfma_f32_32x32x16_bf16 v[128:143], v[52:55], v[44:47], v[128:143]
  v_exp_f32 v148, v116
  v_cvt_pk_bf16_f32 v160, v144, v145
  v_exp_f32 v149, v117
  v_cvt_pk_bf16_f32 v161, v146, v147
  v_exp_f32 v150, v118
  v_exp_f32 v151, v119
  v_mfma_f32_32x32x16_bf16 v[184:199], v[60:63], v[164:167], v[184:199]
  v_exp_f32 v152, v120
  v_cvt_pk_bf16_f32 v162, v148, v149
  v_exp_f32 v153, v121
  v_cvt_pk_bf16_f32 v163, v150, v151
  v_exp_f32 v154, v122
  v_exp_f32 v155, v123
  v_mfma_f32_32x32x16_bf16 v[200:215], v[56:59], v[160:163], v[200:215]
  v_exp_f32 v156, v124
  v_cvt_pk_bf16_f32 v164, v152, v153
  v_exp_f32 v157, v125
  v_cvt_pk_bf16_f32 v165, v154, v155
  v_exp_f32 v158, v126
  buffer_load_dwordx4 a[156:159], v9, s[16:19], s99 offen offset:1024 sc1
  v_exp_f32 v159, v127
  s_waitcnt vmcnt(24)
  v_mfma_f32_32x32x16_bf16 v[112:127], v[64:67], v[16:19], 0
  v_exp_f32 v144, v128
  v_cvt_pk_bf16_f32 v166, v156, v157
  v_exp_f32 v145, v129
  v_cvt_pk_bf16_f32 v167, v158, v159
  v_exp_f32 v146, v130
  buffer_load_dwordx4 a[160:163], v9, s[16:19], s98 offen offset:2048 sc1
  v_exp_f32 v147, v131
  v_mfma_f32_32x32x16_bf16 v[112:127], v[68:71], v[20:23], v[112:127]
  v_exp_f32 v148, v132
  v_cvt_pk_bf16_f32 v160, v144, v145
  v_exp_f32 v149, v133
  v_cvt_pk_bf16_f32 v161, v146, v147
  v_exp_f32 v150, v134
  v_exp_f32 v151, v135
  v_mfma_f32_32x32x16_bf16 v[200:215], v[60:63], v[164:167], v[200:215]
  v_exp_f32 v152, v136
  v_cvt_pk_bf16_f32 v162, v148, v149
  v_exp_f32 v153, v137
  v_cvt_pk_bf16_f32 v163, v150, v151
  v_exp_f32 v154, v138
  v_exp_f32 v155, v139
  v_mfma_f32_32x32x16_bf16 v[216:231], v[56:59], v[160:163], v[216:231]
  v_exp_f32 v156, v140
  v_cvt_pk_bf16_f32 v164, v152, v153
  v_exp_f32 v157, v141
  v_cvt_pk_bf16_f32 v165, v154, v155
  v_exp_f32 v158, v142
  buffer_load_dwordx4 a[164:167], v9, s[16:19], s99 offen offset:2048 sc1
  v_exp_f32 v159, v143
  v_mfma_f32_32x32x16_bf16 v[128:143], v[64:67], v[24:27], 0
  v_exp_f32 v144, v112
  v_cvt_pk_bf16_f32 v166, v156, v157
  v_exp_f32 v145, v113
  v_cvt_pk_bf16_f32 v167, v158, v159
  v_exp_f32 v146, v114
  buffer_load_dwordx4 a[168:171], v9, s[16:19], s98 offen offset:3072 sc1
  v_exp_f32 v147, v115
  v_mfma_f32_32x32x16_bf16 v[128:143], v[68:71], v[28:31], v[128:143]
  v_exp_f32 v148, v116
  v_cvt_pk_bf16_f32 v160, v144, v145
  v_exp_f32 v149, v117
  v_cvt_pk_bf16_f32 v161, v146, v147
  v_exp_f32 v150, v118
  v_exp_f32 v151, v119
  v_mfma_f32_32x32x16_bf16 v[216:231], v[60:63], v[164:167], v[216:231]
  v_exp_f32 v152, v120
  v_cvt_pk_bf16_f32 v162, v148, v149
  v_exp_f32 v153, v121
  v_cvt_pk_bf16_f32 v163, v150, v151
  v_exp_f32 v154, v122
  v_exp_f32 v155, v123
  v_mfma_f32_32x32x16_bf16 v[168:183], v[72:75], v[160:163], v[168:183]
  v_exp_f32 v156, v124
  v_cvt_pk_bf16_f32 v164, v152, v153
  v_exp_f32 v157, v125
  v_cvt_pk_bf16_f32 v165, v154, v155
  v_exp_f32 v158, v126
  buffer_load_dwordx4 a[172:175], v9, s[16:19], s99 offen offset:3072 sc1
  v_exp_f32 v159, v127
  v_mfma_f32_32x32x16_bf16 v[112:127], v[64:67], v[32:35], 0
  v_exp_f32 v144, v128
  v_cvt_pk_bf16_f32 v166, v156, v157
  v_exp_f32 v145, v129
  v_cvt_pk_bf16_f32 v167, v158, v159
  v_exp_f32 v146, v130
  s_add_u32 s98, s98, 7168
  buffer_load_dwordx4 a[176:179], v9, s[16:19], s98 offen offset:0 sc1
  v_exp_f32 v147, v131
  v_mfma_f32_32x32x16_bf16 v[112:127], v[68:71], v[36:39], v[112:127]
  v_exp_f32 v148, v132
  v_cvt_pk_bf16_f32 v160, v144, v145
  v_exp_f32 v149, v133
  v_cvt_pk_bf16_f32 v161, v146, v147
  v_exp_f32 v150, v134
  v_exp_f32 v151, v135
  v_mfma_f32_32x32x16_bf16 v[168:183], v[76:79], v[164:167], v[168:183]
  v_exp_f32 v152, v136
  v_cvt_pk_bf16_f32 v162, v148, v149
  v_exp_f32 v153, v137
  v_cvt_pk_bf16_f32 v163, v150, v151
  v_exp_f32 v154, v138
  v_exp_f32 v155, v139
  v_mfma_f32_32x32x16_bf16 v[184:199], v[72:75], v[160:163], v[184:199]
  v_exp_f32 v156, v140
  v_cvt_pk_bf16_f32 v164, v152, v153
  v_exp_f32 v157, v141
  v_cvt_pk_bf16_f32 v165, v154, v155
  v_exp_f32 v158, v142
  v_exp_f32 v159, v143
  v_mfma_f32_32x32x16_bf16 v[128:143], v[64:67], v[40:43], 0
  v_exp_f32 v144, v112
  v_cvt_pk_bf16_f32 v166, v156, v157
  v_exp_f32 v145, v113
  v_cvt_pk_bf16_f32 v167, v158, v159
  v_exp_f32 v146, v114
  s_add_u32 s99, s99, 7168
  buffer_load_dwordx4 a[180:183], v9, s[16:19], s99 offen offset:0 sc1
  v_exp_f32 v147, v115
  v_mfma_f32_32x32x16_bf16 v[128:143], v[68:71], v[44:47], v[128:143]
  v_exp_f32 v148, v116
  v_cvt_pk_bf16_f32 v160, v144, v145
  v_exp_f32 v149, v117
  v_cvt_pk_bf16_f32 v161, v146, v147
  v_exp_f32 v150, v118
  v_exp_f32 v151, v119
  v_mfma_f32_32x32x16_bf16 v[184:199], v[76:79], v[164:167], v[184:199]
  v_exp_f32 v152, v120
  v_cvt_pk_bf16_f32 v162, v148, v149
  v_exp_f32 v153, v121
  v_cvt_pk_bf16_f32 v163, v150, v151
  v_exp_f32 v154, v122
  v_exp_f32 v155, v123
  v_mfma_f32_32x32x16_bf16 v[200:215], v[72:75], v[160:163], v[200:215]
  v_exp_f32 v156, v124
  v_cvt_pk_bf16_f32 v164, v152, v153
  v_exp_f32 v157, v125
  v_cvt_pk_bf16_f32 v165, v154, v155
  v_exp_f32 v158, v126
  buffer_load_dwordx4 a[184:187], v9, s[16:19], s98 offen offset:1024 sc1
  v_exp_f32 v159, v127
  s_waitcnt vmcnt(20)
  v_mfma_f32_32x32x16_bf16 v[112:127], v[80:83], v[16:19], 0
  v_exp_f32 v144, v128
  v_cvt_pk_bf16_f32 v166, v156, v157
  v_exp_f32 v145, v129
  v_cvt_pk_bf16_f32 v167, v158, v159
  v_exp_f32 v146, v130
  buffer_load_dwordx4 a[188:191], v9, s[16:19], s99 offen offset:1024 sc1
  v_exp_f32 v147, v131
  v_mfma_f32_32x32x16_bf16 v[112:127], v[84:87], v[20:23], v[112:127]
  v_exp_f32 v148, v132
  v_cvt_pk_bf16_f32 v160, v144, v145
  v_exp_f32 v149, v133
  v_cvt_pk_bf16_f32 v161, v146, v147
  v_exp_f32 v150, v134
  v_exp_f32 v151, v135
  v_mfma_f32_32x32x16_bf16 v[200:215], v[76:79], v[164:167], v[200:215]
  v_exp_f32 v152, v136
  v_cvt_pk_bf16_f32 v162, v148, v149
  v_exp_f32 v153, v137
  v_cvt_pk_bf16_f32 v163, v150, v151
  v_exp_f32 v154, v138
  v_exp_f32 v155, v139
  v_mfma_f32_32x32x16_bf16 v[216:231], v[72:75], v[160:163], v[216:231]
  v_exp_f32 v156, v140
  v_cvt_pk_bf16_f32 v164, v152, v153
  v_exp_f32 v157, v141
  v_cvt_pk_bf16_f32 v165, v154, v155
  v_exp_f32 v158, v142
  buffer_load_dwordx4 a[192:195], v9, s[16:19], s98 offen offset:2048 sc1
  v_exp_f32 v159, v143
  v_mfma_f32_32x32x16_bf16 v[128:143], v[80:83], v[24:27], 0
  s_add_u32 s28, s3, 1
  s_and_b32 s28, s28, 3
  s_mul_i32 s28, s28, 12288
  s_add_u32 s28, s28, 114688
  v_add_u32 v10, s28, v9
  s_add_u32 s28, s3, 2
  s_and_b32 s28, s28, 3
  s_mul_i32 s28, s28, 12288
  s_add_u32 s28, s28, 114688
  v_add_u32 v11, s28, v9
  s_add_u32 s28, s3, 3
  s_and_b32 s28, s28, 3
  s_mul_i32 s28, s28, 12288
  s_add_u32 s28, s28, 114688
  v_add_u32 v12, s28, v9
  s_add_u32 s28, s3, 4
  s_and_b32 s28, s28, 3
  s_mul_i32 s28, s28, 12288
  s_add_u32 s28, s28, 114688
  v_add_u32 v13, s28, v9
  v_exp_f32 v144, v112
  v_cvt_pk_bf16_f32 v166, v156, v157
  v_exp_f32 v145, v113
  v_cvt_pk_bf16_f32 v167, v158, v159
  v_exp_f32 v146, v114
  buffer_load_dwordx4 a[196:199], v9, s[16:19], s99 offen offset:2048 sc1
  v_exp_f32 v147, v115
  v_mfma_f32_32x32x16_bf16 v[128:143], v[84:87], v[28:31], v[128:143]
  v_exp_f32 v148, v116
  v_cvt_pk_bf16_f32 v160, v144, v145
  v_exp_f32 v149, v117
  v_cvt_pk_bf16_f32 v161, v146, v147
  v_exp_f32 v150, v118
  v_exp_f32 v151, v119
  v_mfma_f32_32x32x16_bf16 v[216:231], v[76:79], v[164:167], v[216:231]
  v_exp_f32 v152, v120
  v_cvt_pk_bf16_f32 v162, v148, v149
  v_exp_f32 v153, v121
  v_cvt_pk_bf16_f32 v163, v150, v151
  v_exp_f32 v154, v122
  v_exp_f32 v155, v123
  v_mfma_f32_32x32x16_bf16 v[168:183], v[88:91], v[160:163], v[168:183]
  v_exp_f32 v156, v124
  v_cvt_pk_bf16_f32 v164, v152, v153
  v_exp_f32 v157, v125
  v_cvt_pk_bf16_f32 v165, v154, v155
  v_exp_f32 v158, v126
  buffer_load_dwordx4 a[200:203], v9, s[16:19], s98 offen offset:3072 sc1
  v_exp_f32 v159, v127
  v_mfma_f32_32x32x16_bf16 v[112:127], v[80:83], v[32:35], 0
  v_exp_f32 v144, v128
  v_cvt_pk_bf16_f32 v166, v156, v157
  v_exp_f32 v145, v129
  v_cvt_pk_bf16_f32 v167, v158, v159
  v_exp_f32 v146, v130
  buffer_load_dwordx4 a[204:207], v9, s[16:19], s99 offen offset:3072 sc1
  v_exp_f32 v147, v131
  v_mfma_f32_32x32x16_bf16 v[112:127], v[84:87], v[36:39], v[112:127]
  v_exp_f32 v148, v132
  v_cvt_pk_bf16_f32 v160, v144, v145
  v_exp_f32 v149, v133
  v_cvt_pk_bf16_f32 v161, v146, v147
  v_exp_f32 v150, v134
  v_exp_f32 v151, v135
  v_mfma_f32_32x32x16_bf16 v[168:183], v[92:95], v[164:167], v[168:183]
  v_exp_f32 v152, v136
  v_cvt_pk_bf16_f32 v162, v148, v149
  v_exp_f32 v153, v137
  v_cvt_pk_bf16_f32 v163, v150, v151
  v_exp_f32 v154, v138
  v_exp_f32 v155, v139
  v_mfma_f32_32x32x16_bf16 v[184:199], v[88:91], v[160:163], v[184:199]
  v_exp_f32 v156, v140
  v_cvt_pk_bf16_f32 v164, v152, v153
  v_exp_f32 v157, v141
  v_cvt_pk_bf16_f32 v165, v154, v155
  v_exp_f32 v158, v142
  v_exp_f32 v159, v143
  v_mfma_f32_32x32x16_bf16 v[128:143], v[80:83], v[40:43], 0
  v_exp_f32 v144, v112
  v_cvt_pk_bf16_f32 v166, v156, v157
  v_exp_f32 v145, v113
  v_cvt_pk_bf16_f32 v167, v158, v159
  v_exp_f32 v146, v114
  s_add_u32 s98, s98, 7168
  buffer_load_dwordx4 a[208:211], v9, s[16:19], s98 offen offset:0 sc1
  v_exp_f32 v147, v115
  v_mfma_f32_32x32x16_bf16 v[128:143], v[84:87], v[44:47], v[128:143]
  v_exp_f32 v148, v116
  v_cvt_pk_bf16_f32 v160, v144, v145
  v_exp_f32 v149, v117
  v_cvt_pk_bf16_f32 v161, v146, v147
  v_exp_f32 v150, v118
  v_exp_f32 v151, v119
  v_mfma_f32_32x32x16_bf16 v[184:199], v[92:95], v[164:167], v[184:199]
  v_exp_f32 v152, v120
  v_cvt_pk_bf16_f32 v162, v148, v149
  v_exp_f32 v153, v121
  v_cvt_pk_bf16_f32 v163, v150, v151
  v_exp_f32 v154, v122
  v_exp_f32 v155, v123
  v_mfma_f32_32x32x16_bf16 v[200:215], v[88:91], v[160:163], v[200:215]
  v_exp_f32 v156, v124
  v_cvt_pk_bf16_f32 v164, v152, v153
  v_exp_f32 v157, v125
  v_cvt_pk_bf16_f32 v165, v154, v155
  v_exp_f32 v158, v126
  s_add_u32 s99, s99, 7168
  buffer_load_dwordx4 a[212:215], v9, s[16:19], s99 offen offset:0 sc1
  v_exp_f32 v159, v127
  s_waitcnt vmcnt(16)
  v_mfma_f32_32x32x16_bf16 v[112:127], v[96:99], v[16:19], 0
  v_exp_f32 v144, v128
  v_cvt_pk_bf16_f32 v166, v156, v157
  v_exp_f32 v145, v129
  v_cvt_pk_bf16_f32 v167, v158, v159
  v_exp_f32 v146, v130
  buffer_load_dwordx4 a[216:219], v9, s[16:19], s98 offen offset:1024 sc1
  v_exp_f32 v147, v131
  v_mfma_f32_32x32x16_bf16 v[112:127], v[100:103], v[20:23], v[112:127]
  v_exp_f32 v148, v132
  v_cvt_pk_bf16_f32 v160, v144, v145
  v_exp_f32 v149, v133
  v_cvt_pk_bf16_f32 v161, v146, v147
  v_exp_f32 v150, v134
  v_exp_f32 v151, v135
  v_mfma_f32_32x32x16_bf16 v[200:215], v[92:95], v[164:167], v[200:215]
  v_exp_f32 v152, v136
  v_cvt_pk_bf16_f32 v162, v148, v149
  v_exp_f32 v153, v137
  v_cvt_pk_bf16_f32 v163, v150, v151
  v_exp_f32 v154, v138
  v_exp_f32 v155, v139
  v_mfma_f32_32x32x16_bf16 v[216:231], v[88:91], v[160:163], v[216:231]
  v_exp_f32 v156, v140
  v_cvt_pk_bf16_f32 v164, v152, v153
  v_exp_f32 v157, v141
  v_cvt_pk_bf16_f32 v165, v154, v155
  v_exp_f32 v158, v142
  buffer_load_dwordx4 a[220:223], v9, s[16:19], s99 offen offset:1024 sc1
  v_exp_f32 v159, v143
  v_mfma_f32_32x32x16_bf16 v[128:143], v[96:99], v[24:27], 0
  v_exp_f32 v144, v112
  v_cvt_pk_bf16_f32 v166, v156, v157
  v_exp_f32 v145, v113
  v_cvt_pk_bf16_f32 v167, v158, v159
  v_exp_f32 v146, v114
  buffer_load_dwordx4 a[224:227], v9, s[16:19], s98 offen offset:2048 sc1
  v_exp_f32 v147, v115
  v_mfma_f32_32x32x16_bf16 v[128:143], v[100:103], v[28:31], v[128:143]
  v_exp_f32 v148, v116
  v_cvt_pk_bf16_f32 v160, v144, v145
  v_exp_f32 v149, v117
  v_cvt_pk_bf16_f32 v161, v146, v147
  v_exp_f32 v150, v118
  v_exp_f32 v151, v119
  v_mfma_f32_32x32x16_bf16 v[216:231], v[92:95], v[164:167], v[216:231]
  v_exp_f32 v152, v120
  v_cvt_pk_bf16_f32 v162, v148, v149
  v_exp_f32 v153, v121
  v_cvt_pk_bf16_f32 v163, v150, v151
  v_exp_f32 v154, v122
  v_exp_f32 v155, v123
  v_mfma_f32_32x32x16_bf16 v[168:183], v[104:107], v[160:163], v[168:183]
  v_exp_f32 v156, v124
  v_cvt_pk_bf16_f32 v164, v152, v153
  v_exp_f32 v157, v125
  v_cvt_pk_bf16_f32 v165, v154, v155
  v_exp_f32 v158, v126
  buffer_load_dwordx4 a[228:231], v9, s[16:19], s99 offen offset:2048 sc1
  v_exp_f32 v159, v127
  v_mfma_f32_32x32x16_bf16 v[112:127], v[96:99], v[32:35], 0
  v_exp_f32 v144, v128
  v_cvt_pk_bf16_f32 v166, v156, v157
  v_exp_f32 v145, v129
  v_cvt_pk_bf16_f32 v167, v158, v159
  v_exp_f32 v146, v130
  buffer_load_dwordx4 a[232:235], v9, s[16:19], s98 offen offset:3072 sc1
  v_exp_f32 v147, v131
  v_mfma_f32_32x32x16_bf16 v[112:127], v[100:103], v[36:39], v[112:127]
  v_exp_f32 v148, v132
  v_cvt_pk_bf16_f32 v160, v144, v145
  v_exp_f32 v149, v133
  v_cvt_pk_bf16_f32 v161, v146, v147
  v_exp_f32 v150, v134
  v_exp_f32 v151, v135
  v_mfma_f32_32x32x16_bf16 v[168:183], v[108:111], v[164:167], v[168:183]
  v_exp_f32 v152, v136
  v_cvt_pk_bf16_f32 v162, v148, v149
  v_exp_f32 v153, v137
  v_cvt_pk_bf16_f32 v163, v150, v151
  v_exp_f32 v154, v138
  v_exp_f32 v155, v139
  v_mfma_f32_32x32x16_bf16 v[184:199], v[104:107], v[160:163], v[184:199]
  v_exp_f32 v156, v140
  v_cvt_pk_bf16_f32 v164, v152, v153
  v_exp_f32 v157, v141
  v_cvt_pk_bf16_f32 v165, v154, v155
  v_exp_f32 v158, v142
  v_exp_f32 v159, v143
  v_mfma_f32_32x32x16_bf16 v[128:143], v[96:99], v[40:43], 0
  v_exp_f32 v144, v112
  v_cvt_pk_bf16_f32 v166, v156, v157
  v_exp_f32 v145, v113
  v_cvt_pk_bf16_f32 v167, v158, v159
  v_exp_f32 v146, v114
  buffer_load_dwordx4 a[236:239], v9, s[16:19], s99 offen offset:3072 sc1
  v_exp_f32 v147, v115
  v_mfma_f32_32x32x16_bf16 v[128:143], v[100:103], v[44:47], v[128:143]
  v_exp_f32 v148, v116
  v_cvt_pk_bf16_f32 v160, v144, v145
  v_exp_f32 v149, v117
  v_cvt_pk_bf16_f32 v161, v146, v147
  v_exp_f32 v150, v118
  v_exp_f32 v151, v119
  v_mfma_f32_32x32x16_bf16 v[184:199], v[108:111], v[164:167], v[184:199]
  v_exp_f32 v152, v120
  v_cvt_pk_bf16_f32 v162, v148, v149
  v_exp_f32 v153, v121
  v_cvt_pk_bf16_f32 v163, v150, v151
  v_exp_f32 v154, v122
  v_exp_f32 v155, v123
  v_mfma_f32_32x32x16_bf16 v[200:215], v[104:107], v[160:163], v[200:215]
  v_exp_f32 v156, v124
  v_cvt_pk_bf16_f32 v164, v152, v153
  v_exp_f32 v157, v125
  ds_write_b128 v10, v[168:171] offset:0
  v_cvt_pk_bf16_f32 v165, v154, v155
  v_exp_f32 v158, v126
  s_add_u32 s98, s98, 4294949888
  buffer_load_dwordx4 a[240:243], v9, s[16:19], s98 offen offset:0 sc1
  ds_write_b128 v10, v[172:175] offset:1024
  v_exp_f32 v159, v127
  v_exp_f32 v144, v128
  v_cvt_pk_bf16_f32 v166, v156, v157
  v_exp_f32 v145, v129
  v_cvt_pk_bf16_f32 v167, v158, v159
  v_exp_f32 v146, v130
  s_add_u32 s99, s99, 4294949888
  buffer_load_dwordx4 a[244:247], v9, s[16:19], s99 offen offset:0 sc1
  ds_write_b128 v10, v[176:179] offset:2048
  ds_write_b128 v10, v[180:183] offset:3072
  v_exp_f32 v147, v131
  v_exp_f32 v148, v132
  v_cvt_pk_bf16_f32 v160, v144, v145
  v_exp_f32 v149, v133
  v_cvt_pk_bf16_f32 v161, v146, v147
  v_exp_f32 v150, v134
  v_exp_f32 v151, v135
  v_mfma_f32_32x32x16_bf16 v[200:215], v[108:111], v[164:167], v[200:215]
  v_exp_f32 v152, v136
  v_cvt_pk_bf16_f32 v162, v148, v149
  v_exp_f32 v153, v137
  v_cvt_pk_bf16_f32 v163, v150, v151
  v_exp_f32 v154, v138
  v_exp_f32 v155, v139
  v_mfma_f32_32x32x16_bf16 v[216:231], v[104:107], v[160:163], v[216:231]
  v_exp_f32 v156, v140
  v_cvt_pk_bf16_f32 v164, v152, v153
  v_exp_f32 v157, v141
  ds_write_b128 v11, v[184:187] offset:4096
  v_cvt_pk_bf16_f32 v165, v154, v155
  v_exp_f32 v158, v142
  ds_write_b128 v11, v[188:191] offset:5120
  v_exp_f32 v159, v143
  v_cvt_pk_bf16_f32 v166, v156, v157
  v_cvt_pk_bf16_f32 v167, v158, v159
  ds_write_b128 v11, v[192:195] offset:6144
  ds_write_b128 v11, v[196:199] offset:7168
  v_mfma_f32_32x32x16_bf16 v[216:231], v[108:111], v[164:167], v[216:231]
  ds_write_b128 v12, v[200:203] offset:8192
  ds_write_b128 v12, v[204:207] offset:9216
  ds_write_b128 v12, v[208:211] offset:10240
  ds_write_b128 v12, v[212:215] offset:11264
  s_mov_b32 s27, s8
  s_waitcnt lgkmcnt(0)
  s_barrier
  ds_read_b128 v[168:171], v13 offset:0
  ds_read_b128 v[172:175], v13 offset:1024
  ds_read_b128 v[176:179], v13 offset:2048
  ds_read_b128 v[180:183], v13 offset:3072
  ds_read_b128 v[184:187], v13 offset:4096
  ds_read_b128 v[188:191], v13 offset:5120
  ds_read_b128 v[192:195], v13 offset:6144
  ds_read_b128 v[196:199], v13 offset:7168
  ds_read_b128 v[200:203], v13 offset:8192
  ds_read_b128 v[204:207], v13 offset:9216
  ds_read_b128 v[208:211], v13 offset:10240
  ds_read_b128 v[212:215], v13 offset:11264
  s_waitcnt lgkmcnt(8)
  v_pk_add_f32 v[216:217], v[216:217], v[168:169]
  v_pk_add_f32 v[218:219], v[218:219], v[170:171]
  v_pk_add_f32 v[220:221], v[220:221], v[172:173]
  v_pk_add_f32 v[222:223], v[222:223], v[174:175]
  v_pk_add_f32 v[224:225], v[224:225], v[176:177]
  v_pk_add_f32 v[226:227], v[226:227], v[178:179]
  v_pk_add_f32 v[228:229], v[228:229], v[180:181]
  v_pk_add_f32 v[230:231], v[230:231], v[182:183]
  s_waitcnt lgkmcnt(4)
  v_pk_add_f32 v[216:217], v[216:217], v[184:185]
  v_pk_add_f32 v[218:219], v[218:219], v[186:187]
  v_pk_add_f32 v[220:221], v[220:221], v[188:189]
  v_pk_add_f32 v[222:223], v[222:223], v[190:191]
  v_pk_add_f32 v[224:225], v[224:225], v[192:193]
  v_pk_add_f32 v[226:227], v[226:227], v[194:195]
  v_pk_add_f32 v[228:229], v[228:229], v[196:197]
  v_pk_add_f32 v[230:231], v[230:231], v[198:199]
  s_waitcnt lgkmcnt(0)
  v_pk_add_f32 v[228:229], v[228:229], v[212:213]
  v_mov_b32 v11, v228
  v_mov_b32 v12, v228
  v_pk_add_f32 v[216:217], v[216:217], v[200:201]
  v_pk_add_f32 v[218:219], v[218:219], v[202:203]
  v_permlane32_swap_b32 v11, v12
  v_pk_add_f32 v[220:221], v[220:221], v[204:205]
  v_pk_add_f32 v[222:223], v[222:223], v[206:207]
  v_rcp_f32 v12, v12
  v_pk_add_f32 v[224:225], v[224:225], v[208:209]
  v_pk_add_f32 v[226:227], v[226:227], v[210:211]
  v_pk_add_f32 v[230:231], v[230:231], v[214:215]
  v_pk_mul_f32 v[216:217], v[216:217], v[12:13] op_sel_hi:[1,0]
  v_cvt_pk_bf16_f32 v160, v216, v217
  v_pk_mul_f32 v[218:219], v[218:219], v[12:13] op_sel_hi:[1,0]
  v_cvt_pk_bf16_f32 v161, v218, v219
  v_pk_mul_f32 v[220:221], v[220:221], v[12:13] op_sel_hi:[1,0]
  v_cvt_pk_bf16_f32 v162, v220, v221
  v_pk_mul_f32 v[222:223], v[222:223], v[12:13] op_sel_hi:[1,0]
  v_cvt_pk_bf16_f32 v163, v222, v223
  v_pk_mul_f32 v[224:225], v[224:225], v[12:13] op_sel_hi:[1,0]
  v_cvt_pk_bf16_f32 v164, v224, v225
  v_pk_mul_f32 v[226:227], v[226:227], v[12:13] op_sel_hi:[1,0]
  v_cvt_pk_bf16_f32 v165, v226, v227
  v_pk_mul_f32 v[228:229], v[228:229], v[12:13] op_sel_hi:[1,0]
  v_cvt_pk_bf16_f32 v166, v228, v229
  v_pk_mul_f32 v[230:231], v[230:231], v[12:13] op_sel_hi:[1,0]
  v_cvt_pk_bf16_f32 v167, v230, v231
  v_cndmask_b32 v166, v166, 0, s[62:63]
  v_cndmask_b32 v167, v167, 0, s[62:63]
  s_cmp_eq_u32 s61, 0
  s_cbranch_scc1 S5
  buffer_store_dwordx4 v[160:163], v9, s[16:19], s27 offen
  buffer_store_dwordx4 v[164:167], v9, s[16:19], s27 offen offset:1024
S5b:
  s_barrier
  s_lshr_b32 s11, s2, 3
  s_mul_i32 s26, s11, 9363
  s_lshr_b32 s26, s26, 16
  s_mul_i32 s27, s26, 7
  s_sub_u32 s25, s11, s27
  s_min_u32 s26, s26, 3
  s_and_b32 s24, s2, 7
  s_lshl_b32 s24, s24, 2
  s_add_u32 s24, s24, s26
  s_lshr_b32 s26, s3, 1
  s_and_b32 s27, s3, 1
  s_lshl_b32 s24, s24, 1
  s_lshl_b32 s25, s25, 1
  s_add_u32 s24, s24, s26
  s_add_u32 s25, s25, s27
  s_xor_b32 s26, s24, 1
  s_xor_b32 s27, s25, 1
  s_and_b32 s36, s24, 6
  v_bfe_u32 v10, v2, 2, 1
  v_add_u32 v10, s36, v10
  v_lshl_add_u32 v11, v10, 2, s3
  v_and_b32 v10, 3, v2
  s_and_b32 s38, s2, 7
  s_lshl_b32 s38, s38, 10
  v_lshl_add_u32 v14, v11, 2, v10
  v_lshl_add_u32 v14, v14, 3, s38
  s_lshl_b32 s36, s3, 3
  s_lshl_b32 s30, s24, 5
  s_lshl_b32 s31, s26, 5
  s_add_u32 s30, s30, s36
  s_add_u32 s31, s31, s36
  s_lshl_b32 s30, s30, 10
  s_lshl_b32 s31, s31, 10
  s_add_u32 s36, 0, 5869568
  s_add_u32 s30, s30, s36
  s_add_u32 s31, s31, s36
  s_xor_b32 s39, s3, 0
  s_mul_i32 s39, s39, 12288
  s_add_u32 s39, s39, 114688
  v_add_u32 v10, s39, v9
  s_xor_b32 s39, s3, 1
  s_mul_i32 s39, s39, 12288
  s_add_u32 s39, s39, 114688
  v_add_u32 v11, s39, v9
  s_xor_b32 s39, s3, 2
  s_mul_i32 s39, s39, 12288
  s_add_u32 s39, s39, 114688
  v_add_u32 v12, s39, v9
  s_xor_b32 s39, s3, 3
  s_mul_i32 s39, s39, 12288
  s_add_u32 s39, s39, 114688
  v_add_u32 v13, s39, v9
  s_add_u32 s38, s9, 21577728
  s_add_u32 s38, s38, s15
  v_mov_b32 v6, s14
  v_mov_b32 v7, 0
  v_mov_b32 v1, 0
  s_waitcnt vmcnt(0)
  s_mov_b64 exec, 1
  s_cmp_eq_u32 s61, 0
  s_cbranch_scc1 S6
  buffer_store_dwordx2 v[6:7], v1, s[16:19], s38 offen
S6b:
  s_mov_b64 exec, -1
  s_cmp_ge_u32 s11, 28
  s_cbranch_scc1 O_skip0
  s_mov_b32 s39, 200000
W7:
  s_add_u32 s38, s15, 21577728
  buffer_load_dwordx2 v[16:17], v14, s[16:19], s38 offen sc1
  s_waitcnt vmcnt(0)
  v_cmp_ne_u32 vcc, s14, v16
  s_nop 1
  s_cmp_eq_u64 vcc, 0
  s_cbranch_scc1 Wd8
  s_sub_u32 s39, s39, 1
  s_cmp_lg_u32 s39, 0
  s_cbranch_scc1 W7
Wd8:
  buffer_load_dwordx4 v[80:83], v9, s[16:19], s30 offen offset:0 sc1
  buffer_load_dwordx4 v[84:87], v9, s[16:19], s31 offen offset:0 sc1
  buffer_load_dwordx4 v[88:91], v9, s[16:19], s30 offen offset:1024 sc1
  buffer_load_dwordx4 v[92:95], v9, s[16:19], s31 offen offset:1024 sc1
  buffer_load_dwordx4 v[96:99], v9, s[16:19], s30 offen offset:2048 sc1
  buffer_load_dwordx4 v[100:103], v9, s[16:19], s31 offen offset:2048 sc1
  buffer_load_dwordx4 v[104:107], v9, s[16:19], s30 offen offset:3072 sc1
  buffer_load_dwordx4 v[108:111], v9, s[16:19], s31 offen offset:3072 sc1
  s_add_u32 s30, s30, 4096
  buffer_load_dwordx4 v[112:115], v9, s[16:19], s30 offen offset:0 sc1
  s_add_u32 s31, s31, 4096
  buffer_load_dwordx4 v[116:119], v9, s[16:19], s31 offen offset:0 sc1
  buffer_load_dwordx4 v[120:123], v9, s[16:19], s30 offen offset:1024 sc1
  buffer_load_dwordx4 v[124:127], v9, s[16:19], s31 offen offset:1024 sc1
  buffer_load_dwordx4 v[128:131], v9, s[16:19], s30 offen offset:2048 sc1
  buffer_load_dwordx4 v[132:135], v9, s[16:19], s31 offen offset:2048 sc1
  buffer_load_dwordx4 v[136:139], v9, s[16:19], s30 offen offset:3072 sc1
  buffer_load_dwordx4 v[140:143], v9, s[16:19], s31 offen offset:3072 sc1
  s_waitcnt vmcnt(15)
  v_mfma_f32_32x32x16_bf16 v[16:31], a[0:3], v[80:83], 0
  v_mfma_f32_32x32x16_bf16 v[32:47], a[4:7], v[80:83], 0
  s_waitcnt vmcnt(14)
  v_mfma_f32_32x32x16_bf16 v[48:63], a[0:3], v[84:87], 0
  v_mfma_f32_32x32x16_bf16 v[64:79], a[4:7], v[84:87], 0
  s_waitcnt vmcnt(13)
  v_mfma_f32_32x32x16_bf16 v[16:31], a[8:11], v[88:91], v[16:31]
  v_mfma_f32_32x32x16_bf16 v[32:47], a[12:15], v[88:91], v[32:47]
  s_waitcnt vmcnt(12)
  v_mfma_f32_32x32x16_bf16 v[48:63], a[8:11], v[92:95], v[48:63]
  v_mfma_f32_32x32x16_bf16 v[64:79], a[12:15], v[92:95], v[64:79]
  s_waitcnt vmcnt(11)
  v_mfma_f32_32x32x16_bf16 v[16:31], a[16:19], v[96:99], v[16:31]
  v_mfma_f32_32x32x16_bf16 v[32:47], a[20:23], v[96:99], v[32:47]
  s_waitcnt vmcnt(10)
  v_mfma_f32_32x32x16_bf16 v[48:63], a[16:19], v[100:103], v[48:63]
  v_mfma_f32_32x32x16_bf16 v[64:79], a[20:23], v[100:103], v[64:79]
  s_waitcnt vmcnt(9)
  v_mfma_f32_32x32x16_bf16 v[16:31], a[24:27], v[104:107], v[16:31]
  v_mfma_f32_32x32x16_bf16 v[32:47], a[28:31], v[104:107], v[32:47]
  s_waitcnt vmcnt(8)
  v_mfma_f32_32x32x16_bf16 v[48:63], a[24:27], v[108:111], v[48:63]
  v_mfma_f32_32x32x16_bf16 v[64:79], a[28:31], v[108:111], v[64:79]
  s_waitcnt vmcnt(7)
  v_mfma_f32_32x32x16_bf16 v[16:31], a[32:35], v[112:115], v[16:31]
  v_mfma_f32_32x32x16_bf16 v[32:47], a[36:39], v[112:115], v[32:47]
  s_waitcnt vmcnt(6)
  v_mfma_f32_32x32x16_bf16 v[48:63], a[32:35], v[116:119], v[48:63]
  v_mfma_f32_32x32x16_bf16 v[64:79], a[36:39], v[116:119], v[64:79]
  s_waitcnt vmcnt(5)
  v_mfma_f32_32x32x16_bf16 v[16:31], a[40:43], v[120:123], v[16:31]
  v_mfma_f32_32x32x16_bf16 v[32:47], a[44:47], v[120:123], v[32:47]
  s_waitcnt vmcnt(4)
  v_mfma_f32_32x32x16_bf16 v[48:63], a[40:43], v[124:127], v[48:63]
  v_mfma_f32_32x32x16_bf16 v[64:79], a[44:47], v[124:127], v[64:79]
  s_waitcnt vmcnt(3)
  v_mfma_f32_32x32x16_bf16 v[16:31], a[48:51], v[128:131], v[16:31]
  v_mfma_f32_32x32x16_bf16 v[32:47], a[52:55], v[128:131], v[32:47]
  s_waitcnt vmcnt(2)
  v_mfma_f32_32x32x16_bf16 v[48:63], a[48:51], v[132:135], v[48:63]
  v_mfma_f32_32x32x16_bf16 v[64:79], a[52:55], v[132:135], v[64:79]
  s_waitcnt vmcnt(1)
  v_mfma_f32_32x32x16_bf16 v[16:31], a[56:59], v[136:139], v[16:31]
  v_mfma_f32_32x32x16_bf16 v[32:47], a[60:63], v[136:139], v[32:47]
  s_waitcnt vmcnt(0)
  v_mfma_f32_32x32x16_bf16 v[48:63], a[56:59], v[140:143], v[48:63]
  v_mfma_f32_32x32x16_bf16 v[64:79], a[60:63], v[140:143], v[64:79]
  s_nop 3
  ds_write_b128 v11, v[32:35] offset:0
  ds_write_b128 v11, v[36:39] offset:1024
  ds_write_b128 v11, v[40:43] offset:2048
  ds_write_b128 v11, v[44:47] offset:3072
  ds_write_b128 v12, v[48:51] offset:4096
  ds_write_b128 v12, v[52:55] offset:5120
  ds_write_b128 v12, v[56:59] offset:6144
  ds_write_b128 v12, v[60:63] offset:7168
  s_nop 7
  ds_write_b128 v13, v[64:67] offset:8192
  ds_write_b128 v13, v[68:71] offset:9216
  ds_write_b128 v13, v[72:75] offset:10240
  ds_write_b128 v13, v[76:79] offset:11264
  v_accvgpr_read_b32 v14, a248
  v_lshlrev_b32 v15, 16, v14
  v_and_b32 v14, 0xffff0000, v14
  v_pk_add_f32 v[80:81], v[16:17], v[14:15] op_sel:[0,1] op_sel_hi:[1,0]
  v_accvgpr_read_b32 v14, a249
  v_lshlrev_b32 v15, 16, v14
  v_and_b32 v14, 0xffff0000, v14
  v_pk_add_f32 v[82:83], v[18:19], v[14:15] op_sel:[0,1] op_sel_hi:[1,0]
  v_accvgpr_read_b32 v14, a250
  v_lshlrev_b32 v15, 16, v14
  v_and_b32 v14, 0xffff0000, v14
  v_pk_add_f32 v[84:85], v[20:21], v[14:15] op_sel:[0,1] op_sel_hi:[1,0]
  v_accvgpr_read_b32 v14, a251
  v_lshlrev_b32 v15, 16, v14
  v_and_b32 v14, 0xffff0000, v14
  v_pk_add_f32 v[86:87], v[22:23], v[14:15] op_sel:[0,1] op_sel_hi:[1,0]
  v_accvgpr_read_b32 v14, a252
  v_lshlrev_b32 v15, 16, v14
  v_and_b32 v14, 0xffff0000, v14
  v_pk_add_f32 v[88:89], v[24:25], v[14:15] op_sel:[0,1] op_sel_hi:[1,0]
  v_accvgpr_read_b32 v14, a253
  v_lshlrev_b32 v15, 16, v14
  v_and_b32 v14, 0xffff0000, v14
  v_pk_add_f32 v[90:91], v[26:27], v[14:15] op_sel:[0,1] op_sel_hi:[1,0]
  v_accvgpr_read_b32 v14, a254
  v_lshlrev_b32 v15, 16, v14
  v_and_b32 v14, 0xffff0000, v14
  v_pk_add_f32 v[92:93], v[28:29], v[14:15] op_sel:[0,1] op_sel_hi:[1,0]
  v_accvgpr_read_b32 v14, a255
  v_lshlrev_b32 v15, 16, v14
  v_and_b32 v14, 0xffff0000, v14
  v_pk_add_f32 v[94:95], v[30:31], v[14:15] op_sel:[0,1] op_sel_hi:[1,0]
  s_waitcnt lgkmcnt(0)
  s_barrier
  ds_read_b128 v[96:99], v10 offset:0
  ds_read_b128 v[100:103], v10 offset:1024
  ds_read_b128 v[104:107], v10 offset:2048
  ds_read_b128 v[108:111], v10 offset:3072
  ds_read_b128 v[112:115], v10 offset:4096
  ds_read_b128 v[116:119], v10 offset:5120
  ds_read_b128 v[120:123], v10 offset:6144
  ds_read_b128 v[124:127], v10 offset:7168
  ds_read_b128 v[128:131], v10 offset:8192
  ds_read_b128 v[132:135], v10 offset:9216
  ds_read_b128 v[136:139], v10 offset:10240
  ds_read_b128 v[140:143], v10 offset:11264
  s_waitcnt lgkmcnt(8)
  v_pk_add_f32 v[80:81], v[80:81], v[96:97]
  v_pk_add_f32 v[82:83], v[82:83], v[98:99]
  v_pk_add_f32 v[84:85], v[84:85], v[100:101]
  v_pk_add_f32 v[86:87], v[86:87], v[102:103]
  v_pk_add_f32 v[88:89], v[88:89], v[104:105]
  v_pk_add_f32 v[90:91], v[90:91], v[106:107]
  v_pk_add_f32 v[92:93], v[92:93], v[108:109]
  v_pk_add_f32 v[94:95], v[94:95], v[110:111]
  s_waitcnt lgkmcnt(4)
  v_pk_add_f32 v[80:81], v[80:81], v[112:113]
  v_pk_add_f32 v[82:83], v[82:83], v[114:115]
  v_pk_add_f32 v[84:85], v[84:85], v[116:117]
  v_pk_add_f32 v[86:87], v[86:87], v[118:119]
  v_pk_add_f32 v[88:89], v[88:89], v[120:121]
  v_pk_add_f32 v[90:91], v[90:91], v[122:123]
  v_pk_add_f32 v[92:93], v[92:93], v[124:125]
  v_pk_add_f32 v[94:95], v[94:95], v[126:127]
  s_waitcnt lgkmcnt(0)
  v_pk_add_f32 v[80:81], v[80:81], v[128:129]
  v_pk_add_f32 v[82:83], v[82:83], v[130:131]
  v_pk_add_f32 v[84:85], v[84:85], v[132:133]
  v_pk_add_f32 v[86:87], v[86:87], v[134:135]
  v_pk_add_f32 v[88:89], v[88:89], v[136:137]
  v_pk_add_f32 v[90:91], v[90:91], v[138:139]
  v_pk_add_f32 v[92:93], v[92:93], v[140:141]
  v_pk_add_f32 v[94:95], v[94:95], v[142:143]
  v_cvt_pk_bf16_f32 v96, v80, v81
  v_cvt_pk_bf16_f32 v97, v82, v83
  v_cvt_pk_bf16_f32 v98, v84, v85
  v_cvt_pk_bf16_f32 v99, v86, v87
  v_cvt_pk_bf16_f32 v100, v88, v89
  v_cvt_pk_bf16_f32 v101, v90, v91
  v_cvt_pk_bf16_f32 v102, v92, v93
  v_cvt_pk_bf16_f32 v103, v94, v95
  s_mul_i32 s38, s24, 28
  s_lshl_b32 s39, s25, 1
  s_add_u32 s38, s38, s39
  s_lshl_b32 s38, s38, 10
  s_add_u32 s38, s38, 0
  s_add_u32 s38, s38, 10330112
  s_cmp_eq_u32 s61, 0
  s_cbranch_scc1 S9
  buffer_store_dwordx4 v[96:99], v9, s[16:19], s38 offen offset:0
  buffer_store_dwordx4 v[100:103], v9, s[16:19], s38 offen offset:1024
S9b:
  v_pk_add_f32 v[24:25], v[80:81], v[82:83]
  v_pk_mul_f32 v[26:27], v[80:81], v[80:81]
  v_pk_fma_f32 v[26:27], v[82:83], v[82:83], v[26:27]
  v_pk_add_f32 v[24:25], v[24:25], v[84:85]
  v_pk_fma_f32 v[26:27], v[84:85], v[84:85], v[26:27]
  v_pk_add_f32 v[24:25], v[24:25], v[86:87]
  v_pk_fma_f32 v[26:27], v[86:87], v[86:87], v[26:27]
  v_pk_add_f32 v[24:25], v[24:25], v[88:89]
  v_pk_fma_f32 v[26:27], v[88:89], v[88:89], v[26:27]
  v_pk_add_f32 v[24:25], v[24:25], v[90:91]
  v_pk_fma_f32 v[26:27], v[90:91], v[90:91], v[26:27]
  v_pk_add_f32 v[24:25], v[24:25], v[92:93]
  v_pk_fma_f32 v[26:27], v[92:93], v[92:93], v[26:27]
  v_pk_add_f32 v[24:25], v[24:25], v[94:95]
  v_pk_fma_f32 v[26:27], v[94:95], v[94:95], v[26:27]
  v_add_f32 v24, v24, v25
  v_add_f32 v25, v26, v27
  v_mov_b32 v26, v24
  v_mov_b32 v27, v25
  s_mul_i32 s38, s24, 14
  s_add_u32 s38, s38, s25
  v_permlane32_swap_b32 v24, v26
  v_permlane32_swap_b32 v25, v27
  s_lshl_b32 s38, s38, 8
  s_add_u32 s38, s38, 0
  s_add_u32 s38, s38, 14000128
  v_add_f32 v24, v24, v26
  v_add_f32 v25, v25, v27
  v_lshlrev_b32 v6, 3, v3
  s_cmp_eq_u32 s61, 0
  s_cbranch_scc1 S10
  buffer_store_dwordx2 v[24:25], v6, s[16:19], s38 offen
S10b:
  v_accvgpr_write_b32 a248, v96
  v_accvgpr_write_b32 a249, v97
  v_accvgpr_write_b32 a250, v98
  v_accvgpr_write_b32 a251, v99
  v_accvgpr_write_b32 a252, v100
  v_accvgpr_write_b32 a253, v101
  v_accvgpr_write_b32 a254, v102
  v_accvgpr_write_b32 a255, v103
  s_add_u32 s38, s9, 21585920
  s_add_u32 s38, s38, s15
  v_mov_b32 v10, s14
  v_mov_b32 v11, 0
  v_mov_b32 v1, 0
  s_waitcnt vmcnt(0)
  s_mov_b64 exec, 1
  s_cmp_eq_u32 s61, 0
  s_cbranch_scc1 S11
  buffer_store_dwordx2 v[10:11], v1, s[16:19], s38 offen
S11b:
  s_mov_b64 exec, -1
  s_barrier
O_join0:
  s_and_b32 s24, s2, 7
  s_lshr_b32 s26, s2, 7
  s_lshl_b32 s26, s26, 2
  s_add_u32 s26, s26, s3
  s_lshl_b32 s24, s24, 3
  s_add_u32 s24, s24, s26
  s_bfe_u32 s25, s2, 0x40003
  s_lshr_b32 s36, s26, 1
  s_mul_i32 s36, s36, 7
  v_min_u32 v10, 13, v2
  v_lshrrev_b32 v11, 1, v10
  v_add_u32 v11, s36, v11
  v_and_b32 v10, 1, v10
  s_and_b32 s36, s26, 1
  s_lshl_b32 s36, s36, 1
  v_add_u32 v10, s36, v10
  s_and_b32 s38, s2, 7
  s_lshl_b32 s38, s38, 10
  v_lshl_add_u32 v14, v11, 2, v10
  v_lshl_add_u32 v14, v14, 3, s38
  s_mul_i32 s26, s24, 28672
  s_add_u32 s26, s26, 0
  s_add_u32 s26, s26, 10330112
  s_mul_i32 s28, s3, 7168
  s_mul_i32 s27, s25, 200704
  s_add_u32 s27, s27, s28
  s_add_u32 s27, s27, 0
  v_mov_b32 v10, v9
  v_add_u32 v11, 57344, v9
  v_add_u32 v12, 114688, v9
  v_mul_u32_u24 v5, 1792, v4
  v_lshl_add_u32 v5, v3, 3, v5
  s_mul_i32 s30, s24, 3584
  s_add_u32 s30, s30, 0
  s_add_u32 s30, s30, 14000128
  s_mul_i32 s31, s25, 7168
  s_add_u32 s31, s31, 3211264
  s_add_u32 s32, s31, 4096
  s_mul_i32 s33, s24, 112
  s_mul_i32 s34, s25, 7
  s_add_u32 s33, s33, s34
  s_lshl_b32 s33, s33, 10
  s_add_u32 s33, s33, 0
  s_add_u32 s33, s33, 14229504
  s_add_u32 s34, s33, 4096
  s_lshr_b32 s36, s2, 3
  s_mul_i32 s37, s36, 9363
  s_lshr_b32 s37, s37, 16
  s_mul_i32 s37, s37, 7
  s_sub_u32 s36, s36, s37
  s_lshl_b32 s36, s36, 1
  s_and_b32 s37, s3, 1
  s_add_u32 s96, s36, s37
  s_xor_b32 s97, s96, 1
  s_mul_i32 s36, s3, 28
  s_mul_i32 s96, s96, 112
  s_add_u32 s96, s96, s36
  s_lshl_b32 s96, s96, 10
  s_add_u32 s96, s96, 3325952
  s_mul_i32 s97, s97, 112
  s_add_u32 s97, s97, s36
  s_lshl_b32 s97, s97, 10
  s_add_u32 s97, s97, 3325952
  s_add_u32 s38, s15, 21585920
  buffer_load_dwordx2 v[16:17], v14, s[16:19], s38 offen sc1
  v_accvgpr_read_b32 v160, a64
  v_accvgpr_read_b32 v161, a65
  v_accvgpr_read_b32 v162, a66
  v_accvgpr_read_b32 v163, a67
  v_accvgpr_read_b32 v164, a68
  v_accvgpr_read_b32 v165, a69
  v_accvgpr_read_b32 v166, a70
  v_accvgpr_read_b32 v167, a71
  v_accvgpr_read_b32 v168, a72
  v_accvgpr_read_b32 v169, a73
  v_accvgpr_read_b32 v170, a74
  v_accvgpr_read_b32 v171, a75
  v_accvgpr_read_b32 v172, a76
  v_accvgpr_read_b32 v173, a77
  v_accvgpr_read_b32 v174, a78
  v_accvgpr_read_b32 v175, a79
  v_accvgpr_read_b32 v176, a80
  v_accvgpr_read_b32 v177, a81
  v_accvgpr_read_b32 v178, a82
  v_accvgpr_read_b32 v179, a83
  v_accvgpr_read_b32 v180, a84
  v_accvgpr_read_b32 v181, a85
  v_accvgpr_read_b32 v182, a86
  v_accvgpr_read_b32 v183, a87
  v_accvgpr_read_b32 v184, a88
  v_accvgpr_read_b32 v185, a89
  v_accvgpr_read_b32 v186, a90
  v_accvgpr_read_b32 v187, a91
  ds_read_b128 v[128:131], v10 offset:0
  ds_read_b128 v[132:135], v10 offset:28672
  ds_read_b128 v[136:139], v11 offset:0
  s_mov_b32 s39, 200000
W12:
  s_waitcnt vmcnt(0)
  v_cmp_ne_u32 vcc, s14, v16
  s_nop 1
  s_cmp_eq_u64 vcc, 0
  s_cbranch_scc1 Wd13
  s_add_u32 s38, s15, 21585920
  buffer_load_dwordx2 v[16:17], v14, s[16:19], s38 offen sc1
  s_sub_u32 s39, s39, 1
  s_cmp_lg_u32 s39, 0
  s_cbranch_scc1 W12
Wd13:
  buffer_load_dwordx4 a[0:3], v9, s[16:19], s26 offen offset:0 sc1
  buffer_load_dwordx4 a[4:7], v9, s[16:19], s26 offen offset:1024 sc1
  buffer_load_dwordx4 a[8:11], v9, s[16:19], s26 offen offset:2048 sc1
  buffer_load_dwordx4 a[12:15], v9, s[16:19], s26 offen offset:3072 sc1
  s_add_u32 s26, s26, 4096
  buffer_load_dwordx4 a[16:19], v9, s[16:19], s26 offen offset:0 sc1
  buffer_load_dwordx4 a[20:23], v9, s[16:19], s26 offen offset:1024 sc1
  buffer_load_dwordx4 a[24:27], v9, s[16:19], s26 offen offset:2048 sc1
  buffer_load_dwordx4 a[28:31], v9, s[16:19], s26 offen offset:3072 sc1
  s_add_u32 s26, s26, 4096
  s_waitcnt vmcnt(7)
  s_waitcnt lgkmcnt(0)
  v_mfma_f32_32x32x16_bf16 v[16:31], v[128:131], a[0:3], 0
  ds_read_b128 v[144:147], v10 offset:1024
  ds_read_b128 v[148:151], v10 offset:29696
  ds_read_b128 v[152:155], v11 offset:1024
  v_mfma_f32_32x32x16_bf16 v[32:47], v[132:135], a[0:3], 0
  buffer_load_dwordx4 a[32:35], v9, s[16:19], s26 offen offset:0 sc1
  v_mfma_f32_32x32x16_bf16 v[48:63], v[136:139], a[0:3], 0
  buffer_load_dwordx2 v[200:201], v5, s[16:19], s30 offen offset:0 sc1
  s_waitcnt vmcnt(8)
  s_waitcnt lgkmcnt(0)
  v_mfma_f32_32x32x16_bf16 v[16:31], v[144:147], a[4:7], v[16:31]
  ds_read_b128 v[128:131], v10 offset:2048
  ds_read_b128 v[132:135], v10 offset:30720
  ds_read_b128 v[136:139], v11 offset:2048
  v_mfma_f32_32x32x16_bf16 v[32:47], v[148:151], a[4:7], v[32:47]
  buffer_load_dwordx4 a[36:39], v9, s[16:19], s26 offen offset:1024 sc1
  v_mfma_f32_32x32x16_bf16 v[48:63], v[152:155], a[4:7], v[48:63]
  buffer_load_dwordx2 v[202:203], v5, s[16:19], s30 offen offset:256 sc1
  s_waitcnt vmcnt(9)
  s_waitcnt lgkmcnt(0)
  v_mfma_f32_32x32x16_bf16 v[16:31], v[128:131], a[8:11], v[16:31]
  ds_read_b128 v[144:147], v10 offset:3072
  ds_read_b128 v[148:151], v10 offset:31744
  ds_read_b128 v[152:155], v11 offset:3072
  v_mfma_f32_32x32x16_bf16 v[32:47], v[132:135], a[8:11], v[32:47]
  buffer_load_dwordx4 a[40:43], v9, s[16:19], s26 offen offset:2048 sc1
  v_mfma_f32_32x32x16_bf16 v[48:63], v[136:139], a[8:11], v[48:63]
  buffer_load_dwordx2 v[204:205], v5, s[16:19], s30 offen offset:512 sc1
  s_waitcnt vmcnt(10)
  s_waitcnt lgkmcnt(0)
  v_mfma_f32_32x32x16_bf16 v[16:31], v[144:147], a[12:15], v[16:31]
  ds_read_b128 v[128:131], v10 offset:4096
  ds_read_b128 v[132:135], v10 offset:32768
  ds_read_b128 v[136:139], v11 offset:4096
  v_mfma_f32_32x32x16_bf16 v[32:47], v[148:151], a[12:15], v[32:47]
  buffer_load_dwordx4 a[44:47], v9, s[16:19], s26 offen offset:3072 sc1
  s_add_u32 s26, s26, 4096
  v_mfma_f32_32x32x16_bf16 v[48:63], v[152:155], a[12:15], v[48:63]
  buffer_load_dwordx2 v[206:207], v5, s[16:19], s30 offen offset:768 sc1
  s_waitcnt vmcnt(11)
  s_waitcnt lgkmcnt(0)
  v_mfma_f32_32x32x16_bf16 v[16:31], v[128:131], a[16:19], v[16:31]
  ds_read_b128 v[144:147], v10 offset:5120
  ds_read_b128 v[148:151], v10 offset:33792
  ds_read_b128 v[152:155], v11 offset:5120
  v_mfma_f32_32x32x16_bf16 v[32:47], v[132:135], a[16:19], v[32:47]
  buffer_load_dwordx4 a[48:51], v9, s[16:19], s26 offen offset:0 sc1
  v_mfma_f32_32x32x16_bf16 v[48:63], v[136:139], a[16:19], v[48:63]
  buffer_load_dwordx2 v[208:209], v5, s[16:19], s30 offen offset:1024 sc1
  s_waitcnt vmcnt(12)
  s_waitcnt lgkmcnt(0)
  v_mfma_f32_32x32x16_bf16 v[16:31], v[144:147], a[20:23], v[16:31]
  ds_read_b128 v[128:131], v10 offset:6144
  ds_read_b128 v[132:135], v10 offset:34816
  ds_read_b128 v[136:139], v11 offset:6144
  v_mfma_f32_32x32x16_bf16 v[32:47], v[148:151], a[20:23], v[32:47]
  buffer_load_dwordx4 a[52:55], v9, s[16:19], s26 offen offset:1024 sc1
  v_mfma_f32_32x32x16_bf16 v[48:63], v[152:155], a[20:23], v[48:63]
  buffer_load_dwordx2 v[210:211], v5, s[16:19], s30 offen offset:1280 sc1
  s_waitcnt vmcnt(13)
  s_waitcnt lgkmcnt(0)
  v_mfma_f32_32x32x16_bf16 v[16:31], v[128:131], a[24:27], v[16:31]
  ds_read_b128 v[144:147], v10 offset:7168
  ds_read_b128 v[148:151], v10 offset:35840
  ds_read_b128 v[152:155], v11 offset:7168
  v_mfma_f32_32x32x16_bf16 v[32:47], v[132:135], a[24:27], v[32:47]
  buffer_load_dwordx4 a[56:59], v9, s[16:19], s26 offen offset:2048 sc1
  v_mfma_f32_32x32x16_bf16 v[48:63], v[136:139], a[24:27], v[48:63]
  buffer_load_dwordx2 v[212:213], v5, s[16:19], s30 offen offset:1536 sc1
  s_waitcnt vmcnt(14)
  s_waitcnt lgkmcnt(0)
  v_mfma_f32_32x32x16_bf16 v[16:31], v[144:147], a[28:31], v[16:31]
  ds_read_b128 v[128:131], v10 offset:8192
  ds_read_b128 v[132:135], v10 offset:36864
  ds_read_b128 v[136:139], v11 offset:8192
  v_mfma_f32_32x32x16_bf16 v[32:47], v[148:151], a[28:31], v[32:47]
  buffer_load_dwordx4 a[60:63], v9, s[16:19], s26 offen offset:3072 sc1
  s_add_u32 s26, s26, 4096
  v_mfma_f32_32x32x16_bf16 v[48:63], v[152:155], a[28:31], v[48:63]
  s_add_u32 m0, s28, 114688
  s_add_u32 s29, s27, 114688
  buffer_load_dwordx4 v9, s[16:19], s29 offen offset:0 sc1 lds
  s_waitcnt vmcnt(15)
  s_waitcnt lgkmcnt(0)
  v_mfma_f32_32x32x16_bf16 v[16:31], v[128:131], a[32:35], v[16:31]
  ds_read_b128 v[144:147], v10 offset:9216
  ds_read_b128 v[148:151], v10 offset:37888
  ds_read_b128 v[152:155], v11 offset:9216
  v_mfma_f32_32x32x16_bf16 v[32:47], v[132:135], a[32:35], v[32:47]
  buffer_load_dwordx4 a[64:67], v9, s[16:19], s26 offen offset:0 sc1
  v_mfma_f32_32x32x16_bf16 v[48:63], v[136:139], a[32:35], v[48:63]
  buffer_load_dwordx4 v9, s[16:19], s29 offen offset:1024 sc1 lds
  s_waitcnt vmcnt(15)
  s_waitcnt lgkmcnt(0)
  v_mfma_f32_32x32x16_bf16 v[16:31], v[144:147], a[36:39], v[16:31]
  ds_read_b128 v[128:131], v10 offset:10240
  ds_read_b128 v[132:135], v10 offset:38912
  ds_read_b128 v[136:139], v11 offset:10240
  v_mfma_f32_32x32x16_bf16 v[32:47], v[148:151], a[36:39], v[32:47]
  buffer_load_dwordx4 a[68:71], v9, s[16:19], s26 offen offset:1024 sc1
  v_mfma_f32_32x32x16_bf16 v[48:63], v[152:155], a[36:39], v[48:63]
  buffer_load_dwordx4 v9, s[16:19], s29 offen offset:2048 sc1 lds
  s_waitcnt vmcnt(15)
  s_waitcnt lgkmcnt(0)
  v_mfma_f32_32x32x16_bf16 v[16:31], v[128:131], a[40:43], v[16:31]
  ds_read_b128 v[144:147], v10 offset:11264
  ds_read_b128 v[148:151], v10 offset:39936
  ds_read_b128 v[152:155], v11 offset:11264
  v_mfma_f32_32x32x16_bf16 v[32:47], v[132:135], a[40:43], v[32:47]
  buffer_load_dwordx4 a[72:75], v9, s[16:19], s26 offen offset:2048 sc1
  v_mfma_f32_32x32x16_bf16 v[48:63], v[136:139], a[40:43], v[48:63]
  buffer_load_dwordx4 v9, s[16:19], s29 offen offset:3072 sc1 lds
  s_waitcnt vmcnt(15)
  s_waitcnt lgkmcnt(0)
  v_mfma_f32_32x32x16_bf16 v[16:31], v[144:147], a[44:47], v[16:31]
  ds_read_b128 v[128:131], v10 offset:12288
  ds_read_b128 v[132:135], v10 offset:40960
  ds_read_b128 v[136:139], v11 offset:12288
  v_mfma_f32_32x32x16_bf16 v[32:47], v[148:151], a[44:47], v[32:47]
  buffer_load_dwordx4 a[76:79], v9, s[16:19], s26 offen offset:3072 sc1
  s_add_u32 s26, s26, 4096
  v_mfma_f32_32x32x16_bf16 v[48:63], v[152:155], a[44:47], v[48:63]
  s_add_u32 m0, s28, 118784
  s_add_u32 s29, s27, 118784
  buffer_load_dwordx4 v9, s[16:19], s29 offen offset:0 sc1 lds
  s_waitcnt vmcnt(15)
  s_waitcnt lgkmcnt(0)
  v_mfma_f32_32x32x16_bf16 v[16:31], v[128:131], a[48:51], v[16:31]
  ds_read_b128 v[144:147], v10 offset:13312
  ds_read_b128 v[148:151], v10 offset:41984
  ds_read_b128 v[152:155], v11 offset:13312
  v_mfma_f32_32x32x16_bf16 v[32:47], v[132:135], a[48:51], v[32:47]
  buffer_load_dwordx4 a[80:83], v9, s[16:19], s26 offen offset:0 sc1
  v_mfma_f32_32x32x16_bf16 v[48:63], v[136:139], a[48:51], v[48:63]
  buffer_load_dwordx4 v9, s[16:19], s29 offen offset:1024 sc1 lds
  s_waitcnt vmcnt(15)
  s_waitcnt lgkmcnt(0)
  v_mfma_f32_32x32x16_bf16 v[16:31], v[144:147], a[52:55], v[16:31]
  ds_read_b128 v[128:131], v10 offset:14336
  ds_read_b128 v[132:135], v10 offset:43008
  ds_read_b128 v[136:139], v11 offset:14336
  v_mfma_f32_32x32x16_bf16 v[32:47], v[148:151], a[52:55], v[32:47]
  buffer_load_dwordx4 a[84:87], v9, s[16:19], s26 offen offset:1024 sc1
  v_mfma_f32_32x32x16_bf16 v[48:63], v[152:155], a[52:55], v[48:63]
  buffer_load_dwordx4 v9, s[16:19], s29 offen offset:2048 sc1 lds
  s_waitcnt vmcnt(15)
  s_waitcnt lgkmcnt(0)
  v_mfma_f32_32x32x16_bf16 v[16:31], v[128:131], a[56:59], v[16:31]
  ds_read_b128 v[144:147], v10 offset:15360
  ds_read_b128 v[148:151], v10 offset:44032
  ds_read_b128 v[152:155], v11 offset:15360
  v_mfma_f32_32x32x16_bf16 v[32:47], v[132:135], a[56:59], v[32:47]
  buffer_load_dwordx4 a[88:91], v9, s[16:19], s26 offen offset:2048 sc1
  v_mfma_f32_32x32x16_bf16 v[48:63], v[136:139], a[56:59], v[48:63]
  s_add_u32 s96, s96, 4096
  buffer_load_dwordx4 v[232:235], v9, s[16:19], s96 offen offset:1024 sc1
  s_waitcnt vmcnt(15)
  s_waitcnt lgkmcnt(0)
  v_mfma_f32_32x32x16_bf16 v[16:31], v[144:147], a[60:63], v[16:31]
  ds_read_b128 v[128:131], v10 offset:16384
  ds_read_b128 v[132:135], v10 offset:45056
  ds_read_b128 v[136:139], v11 offset:16384
  v_mfma_f32_32x32x16_bf16 v[32:47], v[148:151], a[60:63], v[32:47]
  buffer_load_dwordx4 a[92:95], v9, s[16:19], s26 offen offset:3072 sc1
  s_add_u32 s26, s26, 4096
  v_mfma_f32_32x32x16_bf16 v[48:63], v[152:155], a[60:63], v[48:63]
  s_add_u32 s97, s97, 4096
  buffer_load_dwordx4 v[236:239], v9, s[16:19], s97 offen offset:1024 sc1
  s_waitcnt vmcnt(15)
  s_waitcnt lgkmcnt(0)
  v_mfma_f32_32x32x16_bf16 v[16:31], v[128:131], a[64:67], v[16:31]
  ds_read_b128 v[144:147], v10 offset:17408
  ds_read_b128 v[148:151], v10 offset:46080
  ds_read_b128 v[152:155], v11 offset:17408
  v_mfma_f32_32x32x16_bf16 v[32:47], v[132:135], a[64:67], v[32:47]
  buffer_load_dwordx4 a[96:99], v9, s[16:19], s26 offen offset:0 sc1
  v_mfma_f32_32x32x16_bf16 v[48:63], v[136:139], a[64:67], v[48:63]
  buffer_load_dwordx4 v[240:243], v9, s[16:19], s96 offen offset:2048 sc1
  s_waitcnt vmcnt(15)
  s_waitcnt lgkmcnt(0)
  v_mfma_f32_32x32x16_bf16 v[16:31], v[144:147], a[68:71], v[16:31]
  ds_read_b128 v[128:131], v10 offset:18432
  ds_read_b128 v[132:135], v10 offset:47104
  ds_read_b128 v[136:139], v11 offset:18432
  v_mfma_f32_32x32x16_bf16 v[32:47], v[148:151], a[68:71], v[32:47]
  buffer_load_dwordx4 a[100:103], v9, s[16:19], s26 offen offset:1024 sc1
  v_mfma_f32_32x32x16_bf16 v[48:63], v[152:155], a[68:71], v[48:63]
  buffer_load_dwordx4 v[244:247], v9, s[16:19], s97 offen offset:2048 sc1
  s_waitcnt vmcnt(15)
  s_waitcnt lgkmcnt(0)
  v_mfma_f32_32x32x16_bf16 v[16:31], v[128:131], a[72:75], v[16:31]
  ds_read_b128 v[144:147], v10 offset:19456
  ds_read_b128 v[148:151], v10 offset:48128
  ds_read_b128 v[152:155], v11 offset:19456
  v_mfma_f32_32x32x16_bf16 v[32:47], v[132:135], a[72:75], v[32:47]
  buffer_load_dwordx4 a[104:107], v9, s[16:19], s26 offen offset:2048 sc1
  v_add_f32 v200, v200, v202
  v_add_f32 v201, v201, v203
  v_add_f32 v200, v200, v204
  v_add_f32 v201, v201, v205
  v_add_f32 v200, v200, v206
  v_mfma_f32_32x32x16_bf16 v[48:63], v[136:139], a[72:75], v[48:63]
  s_add_u32 s96, s96, 7168
  buffer_load_dwordx4 v[248:251], v9, s[16:19], s96 offen offset:0 sc1
  s_waitcnt vmcnt(15)
  s_waitcnt lgkmcnt(0)
  v_mfma_f32_32x32x16_bf16 v[16:31], v[144:147], a[76:79], v[16:31]
  ds_read_b128 v[128:131], v10 offset:20480
  ds_read_b128 v[132:135], v10 offset:49152
  ds_read_b128 v[136:139], v11 offset:20480
  v_mfma_f32_32x32x16_bf16 v[32:47], v[148:151], a[76:79], v[32:47]
  buffer_load_dwordx4 a[108:111], v9, s[16:19], s26 offen offset:3072 sc1
  s_add_u32 s26, s26, 4096
  v_add_f32 v201, v201, v207
  v_add_f32 v200, v200, v208
  v_add_f32 v201, v201, v209
  v_add_f32 v200, v200, v210
  v_add_f32 v201, v201, v211
  v_mfma_f32_32x32x16_bf16 v[48:63], v[152:155], a[76:79], v[48:63]
  s_add_u32 s97, s97, 7168
  buffer_load_dwordx4 v[252:255], v9, s[16:19], s97 offen offset:0 sc1
  s_waitcnt vmcnt(15)
  s_waitcnt lgkmcnt(0)
  v_mfma_f32_32x32x16_bf16 v[16:31], v[128:131], a[80:83], v[16:31]
  ds_read_b128 v[144:147], v10 offset:21504
  ds_read_b128 v[148:151], v10 offset:50176
  ds_read_b128 v[152:155], v11 offset:21504
  v_mfma_f32_32x32x16_bf16 v[32:47], v[132:135], a[80:83], v[32:47]
  v_add_f32 v200, v200, v212
  v_add_f32 v201, v201, v213
  v_mov_b32 v202, v200
  v_mov_b32 v203, v201
  s_nop 1
  v_mfma_f32_32x32x16_bf16 v[48:63], v[136:139], a[80:83], v[48:63]
  v_permlane32_swap_b32 v200, v202
  v_permlane32_swap_b32 v201, v203
  s_nop 1
  v_add_f32 v200, v200, v202
  v_add_f32 v201, v201, v203
  s_waitcnt vmcnt(13)
  s_waitcnt lgkmcnt(0)
  v_mfma_f32_32x32x16_bf16 v[16:31], v[144:147], a[84:87], v[16:31]
  ds_read_b128 v[128:131], v10 offset:22528
  ds_read_b128 v[132:135], v10 offset:51200
  ds_read_b128 v[136:139], v11 offset:22528
  v_mfma_f32_32x32x16_bf16 v[32:47], v[148:151], a[84:87], v[32:47]
  v_mul_f32 v200, 0xbb124925, v200
  v_mul_f32 v201, 0x3b124925, v201
  v_fma_f32 v201, -v200, v200, v201
  v_max_f32 v201, 0, v201
  v_add_f32 v201, 0x3727c5ac, v201
  v_mfma_f32_32x32x16_bf16 v[48:63], v[152:155], a[84:87], v[48:63]
  v_cvt_pk_bf16_f32 v192, v200, v200
  v_rsq_f32 v197, v201
  v_and_b32 v202, 0xffff0000, v192
  v_mul_f32 v196, v201, v197
  v_sub_f32 v202, v200, v202
  s_waitcnt vmcnt(11)
  s_waitcnt lgkmcnt(0)
  v_mfma_f32_32x32x16_bf16 v[16:31], v[128:131], a[88:91], v[16:31]
  ds_read_b128 v[144:147], v10 offset:23552
  ds_read_b128 v[148:151], v10 offset:52224
  ds_read_b128 v[152:155], v11 offset:23552
  v_mfma_f32_32x32x16_bf16 v[32:47], v[132:135], a[88:91], v[32:47]
  v_mul_f32 v197, 0xbfb8aa3b, v197
  v_cvt_pk_bf16_f32 v193, v202, 0
  v_mov_b32 v194, v192
  v_mov_b32 v195, v193
  v_mfma_f32_32x32x16_bf16 v[48:63], v[136:139], a[88:91], v[48:63]
  s_waitcnt vmcnt(9)
  s_waitcnt lgkmcnt(0)
  v_mfma_f32_32x32x16_bf16 v[16:31], v[144:147], a[92:95], v[16:31]
  ds_read_b128 v[128:131], v10 offset:24576
  ds_read_b128 v[132:135], v10 offset:53248
  ds_read_b128 v[136:139], v11 offset:24576
  v_mfma_f32_32x32x16_bf16 v[32:47], v[148:151], a[92:95], v[32:47]
  v_mfma_f32_32x32x16_bf16 v[48:63], v[152:155], a[92:95], v[48:63]
  s_waitcnt vmcnt(7)
  s_waitcnt lgkmcnt(0)
  v_mfma_f32_32x32x16_bf16 v[16:31], v[128:131], a[96:99], v[16:31]
  ds_read_b128 v[144:147], v10 offset:25600
  ds_read_b128 v[148:151], v10 offset:54272
  ds_read_b128 v[152:155], v11 offset:25600
  v_mfma_f32_32x32x16_bf16 v[32:47], v[132:135], a[96:99], v[32:47]
  v_mfma_f32_32x32x16_bf16 v[48:63], v[136:139], a[96:99], v[48:63]
  s_waitcnt vmcnt(5)
  s_waitcnt lgkmcnt(0)
  v_mfma_f32_32x32x16_bf16 v[16:31], v[144:147], a[100:103], v[16:31]
  ds_read_b128 v[128:131], v10 offset:26624
  ds_read_b128 v[132:135], v10 offset:55296
  ds_read_b128 v[136:139], v11 offset:26624
  v_mfma_f32_32x32x16_bf16 v[32:47], v[148:151], a[100:103], v[32:47]
  v_mfma_f32_32x32x16_bf16 v[48:63], v[152:155], a[100:103], v[48:63]
  s_waitcnt vmcnt(3)
  s_waitcnt lgkmcnt(0)
  v_mfma_f32_32x32x16_bf16 v[16:31], v[128:131], a[104:107], v[16:31]
  ds_read_b128 v[144:147], v10 offset:27648
  ds_read_b128 v[148:151], v10 offset:56320
  ds_read_b128 v[152:155], v11 offset:27648
  v_mfma_f32_32x32x16_bf16 v[32:47], v[132:135], a[104:107], v[32:47]
  v_mfma_f32_32x32x16_bf16 v[48:63], v[136:139], a[104:107], v[48:63]
  s_waitcnt vmcnt(1)
  s_waitcnt lgkmcnt(0)
  s_barrier
  v_mfma_f32_32x32x16_bf16 v[16:31], v[144:147], a[108:111], v[16:31]
  ds_read_b128 v[128:131], v11 offset:28672
  ds_read_b128 v[132:135], v11 offset:29696
  ds_read_b128 v[136:139], v11 offset:30720
  ds_read_b128 v[140:143], v11 offset:31744
  v_mfma_f32_32x32x16_bf16 v[32:47], v[148:151], a[108:111], v[32:47]
  v_mfma_f32_32x32x16_bf16 v[48:63], v[152:155], a[108:111], v[48:63]
  s_nop 0
  v_mfma_f32_32x32x16_bf16 v[16:31], v[160:163], v[192:195], v[16:31]
  v_mfma_f32_32x32x16_bf16 v[32:47], v[164:167], v[192:195], v[32:47]
  v_mfma_f32_32x32x16_bf16 v[48:63], v[168:171], v[192:195], v[48:63]
  s_waitcnt lgkmcnt(2)
  v_mfma_f32_32x32x16_bf16 v[64:79], v[128:131], a[0:3], 0
  ds_read_b128 v[144:147], v11 offset:32768
  s_add_u32 m0, s28, 0
  s_add_u32 s29, s27, 143360
  buffer_load_dwordx4 v9, s[16:19], s29 offen offset:0 sc1 lds
  v_mfma_f32_32x32x16_bf16 v[64:79], v[132:135], a[4:7], v[64:79]
  ds_read_b128 v[148:151], v11 offset:33792
  s_waitcnt lgkmcnt(2)
  v_mfma_f32_32x32x16_bf16 v[64:79], v[136:139], a[8:11], v[64:79]
  ds_read_b128 v[128:131], v11 offset:34816
  buffer_load_dwordx4 v9, s[16:19], s29 offen offset:1024 sc1 lds
  v_mfma_f32_32x32x16_bf16 v[64:79], v[140:143], a[12:15], v[64:79]
  ds_read_b128 v[132:135], v11 offset:35840
  v_mul_f32 v216, v197, v16
  v_mul_f32 v217, v197, v17
  v_mul_f32 v218, v197, v18
  v_mul_f32 v219, v197, v19
  s_waitcnt lgkmcnt(2)
  v_mfma_f32_32x32x16_bf16 v[64:79], v[144:147], a[16:19], v[64:79]
  ds_read_b128 v[136:139], v11 offset:36864
  buffer_load_dwordx4 v9, s[16:19], s29 offen offset:2048 sc1 lds
  v_mfma_f32_32x32x16_bf16 v[64:79], v[148:151], a[20:23], v[64:79]
  ds_read_b128 v[140:143], v11 offset:37888
  v_exp_f32 v216, v216
  v_exp_f32 v217, v217
  s_waitcnt lgkmcnt(2)
  v_mfma_f32_32x32x16_bf16 v[64:79], v[128:131], a[24:27], v[64:79]
  ds_read_b128 v[144:147], v11 offset:38912
  buffer_load_dwordx4 v9, s[16:19], s29 offen offset:3072 sc1 lds
  v_mfma_f32_32x32x16_bf16 v[64:79], v[132:135], a[28:31], v[64:79]
  ds_read_b128 v[148:151], v11 offset:39936
  v_exp_f32 v218, v218
  v_exp_f32 v219, v219
  v_fma_f32 v216, v216, v196, v196
  s_waitcnt lgkmcnt(2)
  v_mfma_f32_32x32x16_bf16 v[64:79], v[136:139], a[32:35], v[64:79]
  ds_read_b128 v[128:131], v11 offset:40960
  s_add_u32 m0, s28, 4096
  s_add_u32 s29, s27, 147456
  buffer_load_dwordx4 v9, s[16:19], s29 offen offset:0 sc1 lds
  v_mfma_f32_32x32x16_bf16 v[64:79], v[140:143], a[36:39], v[64:79]
  ds_read_b128 v[132:135], v11 offset:41984
  v_fma_f32 v217, v217, v196, v196
  v_fma_f32 v218, v218, v196, v196
  v_fma_f32 v219, v219, v196, v196
  v_rcp_f32 v216, v216
  s_waitcnt lgkmcnt(2)
  v_mfma_f32_32x32x16_bf16 v[64:79], v[144:147], a[40:43], v[64:79]
  ds_read_b128 v[136:139], v11 offset:43008
  buffer_load_dwordx4 v9, s[16:19], s29 offen offset:1024 sc1 lds
  v_mfma_f32_32x32x16_bf16 v[64:79], v[148:151], a[44:47], v[64:79]
  ds_read_b128 v[140:143], v11 offset:44032
  v_rcp_f32 v217, v217
  v_rcp_f32 v218, v218
  s_waitcnt lgkmcnt(2)
  v_mfma_f32_32x32x16_bf16 v[64:79], v[128:131], a[48:51], v[64:79]
  ds_read_b128 v[144:147], v11 offset:45056
  buffer_load_dwordx4 v9, s[16:19], s29 offen offset:2048 sc1 lds
  v_mfma_f32_32x32x16_bf16 v[64:79], v[132:135], a[52:55], v[64:79]
  ds_read_b128 v[148:151], v11 offset:46080
  v_rcp_f32 v219, v219
  v_mul_f32 v216, v216, v24
  v_mul_f32 v217, v217, v25
  v_mul_f32 v218, v218, v26
  s_waitcnt lgkmcnt(2)
  v_mfma_f32_32x32x16_bf16 v[64:79], v[136:139], a[56:59], v[64:79]
  ds_read_b128 v[128:131], v11 offset:47104
  s_add_u32 m0, s28, 28672
  s_add_u32 s29, s27, 172032
  buffer_load_dwordx4 v9, s[16:19], s29 offen offset:0 sc1 lds
  v_mfma_f32_32x32x16_bf16 v[64:79], v[140:143], a[60:63], v[64:79]
  ds_read_b128 v[132:135], v11 offset:48128
  v_mul_f32 v219, v219, v27
  v_cvt_pk_bf16_f32 v224, v216, v217
  v_cvt_pk_bf16_f32 v225, v218, v219
  v_mul_f32 v220, v197, v20
  v_mul_f32 v221, v197, v21
  s_waitcnt lgkmcnt(2)
  v_mfma_f32_32x32x16_bf16 v[64:79], v[144:147], a[64:67], v[64:79]
  ds_read_b128 v[136:139], v11 offset:49152
  buffer_load_dwordx4 v9, s[16:19], s29 offen offset:1024 sc1 lds
  v_mfma_f32_32x32x16_bf16 v[64:79], v[148:151], a[68:71], v[64:79]
  ds_read_b128 v[140:143], v11 offset:50176
  v_mul_f32 v222, v197, v22
  v_mul_f32 v223, v197, v23
  v_exp_f32 v220, v220
  s_waitcnt lgkmcnt(2)
  v_mfma_f32_32x32x16_bf16 v[64:79], v[128:131], a[72:75], v[64:79]
  ds_read_b128 v[144:147], v11 offset:51200
  buffer_load_dwordx4 v9, s[16:19], s29 offen offset:2048 sc1 lds
  v_mfma_f32_32x32x16_bf16 v[64:79], v[132:135], a[76:79], v[64:79]
  ds_read_b128 v[148:151], v11 offset:52224
  v_exp_f32 v221, v221
  v_exp_f32 v222, v222
  s_waitcnt lgkmcnt(2)
  v_mfma_f32_32x32x16_bf16 v[64:79], v[136:139], a[80:83], v[64:79]
  ds_read_b128 v[128:131], v11 offset:53248
  buffer_load_dwordx4 v9, s[16:19], s29 offen offset:3072 sc1 lds
  v_mfma_f32_32x32x16_bf16 v[64:79], v[140:143], a[84:87], v[64:79]
  ds_read_b128 v[132:135], v11 offset:54272
  v_exp_f32 v223, v223
  v_fma_f32 v220, v220, v196, v196
  v_fma_f32 v221, v221, v196, v196
  v_fma_f32 v222, v222, v196, v196
  s_waitcnt lgkmcnt(2)
  v_mfma_f32_32x32x16_bf16 v[64:79], v[144:147], a[88:91], v[64:79]
  ds_read_b128 v[136:139], v11 offset:55296
  s_add_u32 m0, s28, 32768
  s_add_u32 s29, s27, 176128
  buffer_load_dwordx4 v9, s[16:19], s29 offen offset:0 sc1 lds
  v_mfma_f32_32x32x16_bf16 v[64:79], v[148:151], a[92:95], v[64:79]
  ds_read_b128 v[140:143], v11 offset:56320
  v_fma_f32 v223, v223, v196, v196
  v_rcp_f32 v220, v220
  v_rcp_f32 v221, v221
  s_waitcnt lgkmcnt(2)
  v_mfma_f32_32x32x16_bf16 v[64:79], v[128:131], a[96:99], v[64:79]
  s_barrier
  ds_read_b128 v[144:147], v12 offset:0
  buffer_load_dwordx4 v9, s[16:19], s29 offen offset:1024 sc1 lds
  v_mfma_f32_32x32x16_bf16 v[64:79], v[132:135], a[100:103], v[64:79]
  ds_read_b128 v[148:151], v12 offset:1024
  v_rcp_f32 v222, v222
  v_rcp_f32 v223, v223
  v_mul_f32 v220, v220, v28
  s_waitcnt lgkmcnt(2)
  v_mfma_f32_32x32x16_bf16 v[64:79], v[136:139], a[104:107], v[64:79]
  ds_read_b128 v[128:131], v12 offset:2048
  buffer_load_dwordx4 v9, s[16:19], s29 offen offset:2048 sc1 lds
  v_mfma_f32_32x32x16_bf16 v[64:79], v[140:143], a[108:111], v[64:79]
  ds_read_b128 v[132:135], v12 offset:3072
  v_mul_f32 v221, v221, v29
  v_mul_f32 v222, v222, v30
  v_mul_f32 v223, v223, v31
  v_cvt_pk_bf16_f32 v226, v220, v221
  v_cvt_pk_bf16_f32 v227, v222, v223
  v_mfma_f32_32x32x16_bf16 v[64:79], v[172:175], v[192:195], v[64:79]
  s_cmp_eq_u32 s61, 0
  s_cbranch_scc1 S14
  buffer_store_dwordx4 v[224:227], v9, s[16:19], s33 offen offset:0
S14b:
  v_mul_f32 v216, v197, v32
  s_waitcnt lgkmcnt(2)
  v_mfma_f32_32x32x16_bf16 v[80:95], v[144:147], a[0:3], 0
  ds_read_b128 v[136:139], v12 offset:4096
  v_mul_f32 v217, v197, v33
  v_mul_f32 v218, v197, v34
  v_mul_f32 v219, v197, v35
  v_mfma_f32_32x32x16_bf16 v[80:95], v[148:151], a[4:7], v[80:95]
  ds_read_b128 v[140:143], v12 offset:5120
  v_exp_f32 v216, v216
  v_exp_f32 v217, v217
  s_waitcnt lgkmcnt(2)
  v_mfma_f32_32x32x16_bf16 v[80:95], v[128:131], a[8:11], v[80:95]
  ds_read_b128 v[144:147], v12 offset:6144
  v_exp_f32 v218, v218
  v_exp_f32 v219, v219
  v_mfma_f32_32x32x16_bf16 v[80:95], v[132:135], a[12:15], v[80:95]
  ds_read_b128 v[148:151], v12 offset:7168
  v_fma_f32 v216, v216, v196, v196
  v_fma_f32 v217, v217, v196, v196
  v_fma_f32 v218, v218, v196, v196
  v_fma_f32 v219, v219, v196, v196
  s_waitcnt lgkmcnt(2)
  v_mfma_f32_32x32x16_bf16 v[80:95], v[136:139], a[16:19], v[80:95]
  ds_read_b128 v[128:131], v12 offset:8192
  v_rcp_f32 v216, v216
  v_rcp_f32 v217, v217
  v_mfma_f32_32x32x16_bf16 v[80:95], v[140:143], a[20:23], v[80:95]
  ds_read_b128 v[132:135], v12 offset:9216
  v_rcp_f32 v218, v218
  v_rcp_f32 v219, v219
  v_mul_f32 v216, v216, v40
  s_waitcnt lgkmcnt(2)
  v_mfma_f32_32x32x16_bf16 v[80:95], v[144:147], a[24:27], v[80:95]
  ds_read_b128 v[136:139], v12 offset:10240
  v_mul_f32 v217, v217, v41
  v_mul_f32 v218, v218, v42
  v_mul_f32 v219, v219, v43
  v_cvt_pk_bf16_f32 v228, v216, v217
  v_mfma_f32_32x32x16_bf16 v[80:95], v[148:151], a[28:31], v[80:95]
  ds_read_b128 v[140:143], v12 offset:11264
  v_cvt_pk_bf16_f32 v229, v218, v219
  v_mul_f32 v220, v197, v36
  v_mul_f32 v221, v197, v37
  v_mul_f32 v222, v197, v38
  v_mul_f32 v223, v197, v39
  s_waitcnt lgkmcnt(2)
  v_mfma_f32_32x32x16_bf16 v[80:95], v[128:131], a[32:35], v[80:95]
  ds_read_b128 v[144:147], v12 offset:12288
  v_exp_f32 v220, v220
  v_exp_f32 v221, v221
  v_mfma_f32_32x32x16_bf16 v[80:95], v[132:135], a[36:39], v[80:95]
  ds_read_b128 v[148:151], v12 offset:13312
  v_exp_f32 v222, v222
  v_exp_f32 v223, v223
  v_fma_f32 v220, v220, v196, v196
  s_waitcnt lgkmcnt(2)
  v_mfma_f32_32x32x16_bf16 v[80:95], v[136:139], a[40:43], v[80:95]
  ds_read_b128 v[128:131], v12 offset:14336
  v_fma_f32 v221, v221, v196, v196
  v_fma_f32 v222, v222, v196, v196
  v_fma_f32 v223, v223, v196, v196
  v_mfma_f32_32x32x16_bf16 v[80:95], v[140:143], a[44:47], v[80:95]
  ds_read_b128 v[132:135], v12 offset:15360
  v_rcp_f32 v220, v220
  v_rcp_f32 v221, v221
  s_waitcnt lgkmcnt(2)
  v_mfma_f32_32x32x16_bf16 v[80:95], v[144:147], a[48:51], v[80:95]
  ds_read_b128 v[136:139], v12 offset:16384
  v_rcp_f32 v222, v222
  v_rcp_f32 v223, v223
  v_mfma_f32_32x32x16_bf16 v[80:95], v[148:151], a[52:55], v[80:95]
  ds_read_b128 v[140:143], v12 offset:17408
  v_mul_f32 v220, v220, v44
  v_mul_f32 v221, v221, v45
  v_mul_f32 v222, v222, v46
  v_mul_f32 v223, v223, v47
  v_cvt_pk_bf16_f32 v230, v220, v221
  s_waitcnt lgkmcnt(2)
  v_mfma_f32_32x32x16_bf16 v[80:95], v[128:131], a[56:59], v[80:95]
  ds_read_b128 v[144:147], v12 offset:18432
  v_cvt_pk_bf16_f32 v231, v222, v223
  v_mfma_f32_32x32x16_bf16 v[80:95], v[132:135], a[60:63], v[80:95]
  ds_read_b128 v[148:151], v12 offset:19456
  s_cmp_eq_u32 s61, 0
  s_cbranch_scc1 S15
  buffer_store_dwordx4 v[228:231], v9, s[16:19], s33 offen offset:1024
S15b:
  v_mul_f32 v216, v197, v48
  s_waitcnt lgkmcnt(2)
  v_mfma_f32_32x32x16_bf16 v[80:95], v[136:139], a[64:67], v[80:95]
  ds_read_b128 v[128:131], v12 offset:20480
  v_mul_f32 v217, v197, v49
  v_mul_f32 v218, v197, v50
  v_mul_f32 v219, v197, v51
  v_mfma_f32_32x32x16_bf16 v[80:95], v[140:143], a[68:71], v[80:95]
  ds_read_b128 v[132:135], v12 offset:21504
  v_exp_f32 v216, v216
  v_exp_f32 v217, v217
  s_waitcnt lgkmcnt(2)
  v_mfma_f32_32x32x16_bf16 v[80:95], v[144:147], a[72:75], v[80:95]
  ds_read_b128 v[136:139], v12 offset:22528
  v_exp_f32 v218, v218
  v_exp_f32 v219, v219
  v_mfma_f32_32x32x16_bf16 v[80:95], v[148:151], a[76:79], v[80:95]
  ds_read_b128 v[140:143], v12 offset:23552
  v_fma_f32 v216, v216, v196, v196
  v_fma_f32 v217, v217, v196, v196
  v_fma_f32 v218, v218, v196, v196
  v_fma_f32 v219, v219, v196, v196
  s_waitcnt lgkmcnt(2)
  v_mfma_f32_32x32x16_bf16 v[80:95], v[128:131], a[80:83], v[80:95]
  ds_read_b128 v[144:147], v12 offset:24576
  v_rcp_f32 v216, v216
  v_rcp_f32 v217, v217
  v_mfma_f32_32x32x16_bf16 v[80:95], v[132:135], a[84:87], v[80:95]
  ds_read_b128 v[148:151], v12 offset:25600
  v_rcp_f32 v218, v218
  v_rcp_f32 v219, v219
  v_mul_f32 v216, v216, v56
  s_waitcnt lgkmcnt(2)
  v_mfma_f32_32x32x16_bf16 v[80:95], v[136:139], a[88:91], v[80:95]
  ds_read_b128 v[128:131], v12 offset:26624
  v_mul_f32 v217, v217, v57
  v_mul_f32 v218, v218, v58
  v_mul_f32 v219, v219, v59
  v_cvt_pk_bf16_f32 v224, v216, v217
  v_mfma_f32_32x32x16_bf16 v[80:95], v[140:143], a[92:95], v[80:95]
  ds_read_b128 v[132:135], v12 offset:27648
  v_cvt_pk_bf16_f32 v225, v218, v219
  v_mul_f32 v220, v197, v52
  v_mul_f32 v221, v197, v53
  v_mul_f32 v222, v197, v54
  v_mul_f32 v223, v197, v55
  s_waitcnt lgkmcnt(2)
  v_mfma_f32_32x32x16_bf16 v[80:95], v[144:147], a[96:99], v[80:95]
  s_waitcnt vmcnt(9)
  s_barrier
  ds_read_b128 v[136:139], v10 offset:0
  v_exp_f32 v220, v220
  v_mfma_f32_32x32x16_bf16 v[80:95], v[148:151], a[100:103], v[80:95]
  ds_read_b128 v[140:143], v10 offset:1024
  v_exp_f32 v221, v221
  v_exp_f32 v222, v222
  s_waitcnt lgkmcnt(2)
  v_mfma_f32_32x32x16_bf16 v[80:95], v[128:131], a[104:107], v[80:95]
  ds_read_b128 v[144:147], v10 offset:2048
  v_exp_f32 v223, v223
  v_fma_f32 v220, v220, v196, v196
  v_fma_f32 v221, v221, v196, v196
  v_mfma_f32_32x32x16_bf16 v[80:95], v[132:135], a[108:111], v[80:95]
  ds_read_b128 v[148:151], v10 offset:3072
  v_fma_f32 v222, v222, v196, v196
  v_fma_f32 v223, v223, v196, v196
  v_rcp_f32 v220, v220
  v_mfma_f32_32x32x16_bf16 v[80:95], v[176:179], v[192:195], v[80:95]
  v_rcp_f32 v221, v221
  v_rcp_f32 v222, v222
  s_waitcnt lgkmcnt(2)
  v_mfma_f32_32x32x16_bf16 v[96:111], v[136:139], a[0:3], 0
  ds_read_b128 v[128:131], v10 offset:4096
  v_rcp_f32 v223, v223
  v_mul_f32 v220, v220, v60
  v_mul_f32 v221, v221, v61
  v_mfma_f32_32x32x16_bf16 v[96:111], v[140:143], a[4:7], v[96:111]
  ds_read_b128 v[132:135], v10 offset:5120
  v_mul_f32 v222, v222, v62
  v_mul_f32 v223, v223, v63
  v_cvt_pk_bf16_f32 v226, v220, v221
  v_cvt_pk_bf16_f32 v227, v222, v223
  s_waitcnt lgkmcnt(2)
  v_mfma_f32_32x32x16_bf16 v[96:111], v[144:147], a[8:11], v[96:111]
  ds_read_b128 v[136:139], v10 offset:6144
  s_cmp_eq_u32 s61, 0
  s_cbranch_scc1 S16
  buffer_store_dwordx4 v[224:227], v9, s[16:19], s33 offen offset:2048
S16b:
  v_mfma_f32_32x32x16_bf16 v[96:111], v[148:151], a[12:15], v[96:111]
  ds_read_b128 v[140:143], v10 offset:7168
  v_mul_f32 v216, v197, v64
  v_mul_f32 v217, v197, v65
  v_mul_f32 v218, v197, v66
  v_mul_f32 v219, v197, v67
  s_waitcnt lgkmcnt(2)
  v_mfma_f32_32x32x16_bf16 v[96:111], v[128:131], a[16:19], v[96:111]
  ds_read_b128 v[144:147], v10 offset:8192
  v_exp_f32 v216, v216
  v_exp_f32 v217, v217
  v_mfma_f32_32x32x16_bf16 v[96:111], v[132:135], a[20:23], v[96:111]
  ds_read_b128 v[148:151], v10 offset:9216
  v_exp_f32 v218, v218
  v_exp_f32 v219, v219
  v_fma_f32 v216, v216, v196, v196
  s_waitcnt lgkmcnt(2)
  v_mfma_f32_32x32x16_bf16 v[96:111], v[136:139], a[24:27], v[96:111]
  ds_read_b128 v[128:131], v10 offset:10240
  v_fma_f32 v217, v217, v196, v196
  v_fma_f32 v218, v218, v196, v196
  v_fma_f32 v219, v219, v196, v196
  v_mfma_f32_32x32x16_bf16 v[96:111], v[140:143], a[28:31], v[96:111]
  ds_read_b128 v[132:135], v10 offset:11264
  v_rcp_f32 v216, v216
  v_rcp_f32 v217, v217
  s_waitcnt lgkmcnt(2)
  v_mfma_f32_32x32x16_bf16 v[96:111], v[144:147], a[32:35], v[96:111]
  ds_read_b128 v[136:139], v10 offset:12288
  v_rcp_f32 v218, v218
  v_rcp_f32 v219, v219
  v_mfma_f32_32x32x16_bf16 v[96:111], v[148:151], a[36:39], v[96:111]
  ds_read_b128 v[140:143], v10 offset:13312
  v_mul_f32 v216, v216, v72
  v_mul_f32 v217, v217, v73
  v_mul_f32 v218, v218, v74
  v_mul_f32 v219, v219, v75
  v_cvt_pk_bf16_f32 v228, v216, v217
  s_waitcnt lgkmcnt(2)
  v_mfma_f32_32x32x16_bf16 v[96:111], v[128:131], a[40:43], v[96:111]
  ds_read_b128 v[144:147], v10 offset:14336
  v_cvt_pk_bf16_f32 v229, v218, v219
  v_mul_f32 v220, v197, v68
  v_mul_f32 v221, v197, v69
  v_mul_f32 v222, v197, v70
  v_mfma_f32_32x32x16_bf16 v[96:111], v[132:135], a[44:47], v[96:111]
  ds_read_b128 v[148:151], v10 offset:15360
  v_mul_f32 v223, v197, v71
  v_exp_f32 v220, v220
  v_exp_f32 v221, v221
  s_waitcnt lgkmcnt(2)
  v_mfma_f32_32x32x16_bf16 v[96:111], v[136:139], a[48:51], v[96:111]
  ds_read_b128 v[128:131], v10 offset:16384
  v_exp_f32 v222, v222
  v_exp_f32 v223, v223
  v_mfma_f32_32x32x16_bf16 v[96:111], v[140:143], a[52:55], v[96:111]
  ds_read_b128 v[132:135], v10 offset:17408
  v_fma_f32 v220, v220, v196, v196
  v_fma_f32 v221, v221, v196, v196
  v_fma_f32 v222, v222, v196, v196
  v_fma_f32 v223, v223, v196, v196
  s_waitcnt lgkmcnt(2)
  v_mfma_f32_32x32x16_bf16 v[96:111], v[144:147], a[56:59], v[96:111]
  ds_read_b128 v[136:139], v10 offset:18432
  v_rcp_f32 v220, v220
  v_rcp_f32 v221, v221
  v_mfma_f32_32x32x16_bf16 v[96:111], v[148:151], a[60:63], v[96:111]
  ds_read_b128 v[140:143], v10 offset:19456
  v_rcp_f32 v222, v222
  v_rcp_f32 v223, v223
  v_mul_f32 v220, v220, v76
  s_waitcnt lgkmcnt(2)
  v_mfma_f32_32x32x16_bf16 v[96:111], v[128:131], a[64:67], v[96:111]
  ds_read_b128 v[144:147], v10 offset:20480
  v_mul_f32 v221, v221, v77
  v_mul_f32 v222, v222, v78
  v_mul_f32 v223, v223, v79
  v_cvt_pk_bf16_f32 v230, v220, v221
  v_mfma_f32_32x32x16_bf16 v[96:111], v[132:135], a[68:71], v[96:111]
  ds_read_b128 v[148:151], v10 offset:21504
  v_cvt_pk_bf16_f32 v231, v222, v223
  s_cmp_eq_u32 s61, 0
  s_cbranch_scc1 S17
  buffer_store_dwordx4 v[228:231], v9, s[16:19], s33 offen offset:3072
S17b:
  s_waitcnt lgkmcnt(2)
  v_mfma_f32_32x32x16_bf16 v[96:111], v[136:139], a[72:75], v[96:111]
  ds_read_b128 v[128:131], v10 offset:22528
  buffer_load_dwordx4 v[16:19], v9, s[16:19], s96 offen offset:1024 sc1
  v_mfma_f32_32x32x16_bf16 v[96:111], v[140:143], a[76:79], v[96:111]
  ds_read_b128 v[132:135], v10 offset:23552
  buffer_load_dwordx4 v[20:23], v9, s[16:19], s97 offen offset:1024 sc1
  s_waitcnt lgkmcnt(2)
  v_mfma_f32_32x32x16_bf16 v[96:111], v[144:147], a[80:83], v[96:111]
  ds_read_b128 v[136:139], v10 offset:24576
  buffer_load_dwordx4 v[24:27], v9, s[16:19], s96 offen offset:2048 sc1
  v_mfma_f32_32x32x16_bf16 v[96:111], v[148:151], a[84:87], v[96:111]
  ds_read_b128 v[140:143], v10 offset:25600
  buffer_load_dwordx4 v[28:31], v9, s[16:19], s97 offen offset:2048 sc1
  s_waitcnt lgkmcnt(2)
  v_mfma_f32_32x32x16_bf16 v[96:111], v[128:131], a[88:91], v[96:111]
  ds_read_b128 v[144:147], v10 offset:26624
  s_add_u32 s96, s96, 7168
  buffer_load_dwordx4 v[32:35], v9, s[16:19], s96 offen offset:0 sc1
  v_mfma_f32_32x32x16_bf16 v[96:111], v[132:135], a[92:95], v[96:111]
  ds_read_b128 v[148:151], v10 offset:27648
  s_add_u32 s97, s97, 7168
  buffer_load_dwordx4 v[36:39], v9, s[16:19], s97 offen offset:0 sc1
  s_waitcnt lgkmcnt(2)
  v_mfma_f32_32x32x16_bf16 v[96:111], v[136:139], a[96:99], v[96:111]
  s_waitcnt vmcnt(10)
  s_barrier
  ds_read_b128 v[128:131], v10 offset:28672
  v_mfma_f32_32x32x16_bf16 v[96:111], v[140:143], a[100:103], v[96:111]
  ds_read_b128 v[132:135], v10 offset:29696
  buffer_load_dwordx4 v[40:43], v9, s[16:19], s96 offen offset:1024 sc1
  s_waitcnt lgkmcnt(2)
  v_mfma_f32_32x32x16_bf16 v[96:111], v[144:147], a[104:107], v[96:111]
  ds_read_b128 v[136:139], v10 offset:30720
  buffer_load_dwordx4 v[44:47], v9, s[16:19], s97 offen offset:1024 sc1
  v_mfma_f32_32x32x16_bf16 v[96:111], v[148:151], a[108:111], v[96:111]
  ds_read_b128 v[140:143], v10 offset:31744
  buffer_load_dwordx4 v[48:51], v9, s[16:19], s96 offen offset:2048 sc1
  v_mfma_f32_32x32x16_bf16 v[96:111], v[180:183], v[192:195], v[96:111]
  buffer_load_dwordx4 v[52:55], v9, s[16:19], s97 offen offset:2048 sc1
  s_waitcnt lgkmcnt(2)
  v_mfma_f32_32x32x16_bf16 v[112:127], v[128:131], a[0:3], 0
  ds_read_b128 v[144:147], v10 offset:32768
  s_waitcnt vmcnt(10)
  s_add_u32 s38, s9, 21594112
  s_add_u32 s38, s38, s15
  v_mov_b32 v14, s14
  v_mov_b32 v15, 0
  v_mov_b32 v1, 0
  s_mov_b64 exec, 1
  s_cmp_eq_u32 s61, 0
  s_cbranch_scc1 S18
  buffer_store_dwordx2 v[14:15], v1, s[16:19], s38 offen
S18b:
  s_mov_b64 exec, -1
  v_mfma_f32_32x32x16_bf16 v[112:127], v[132:135], a[4:7], v[112:127]
  ds_read_b128 v[148:151], v10 offset:33792
  s_add_u32 s96, s96, 7168
  buffer_load_dwordx4 v[56:59], v9, s[16:19], s96 offen offset:0 sc1
  s_waitcnt lgkmcnt(2)
  v_mfma_f32_32x32x16_bf16 v[112:127], v[136:139], a[8:11], v[112:127]
  ds_read_b128 v[128:131], v10 offset:34816
  s_add_u32 s97, s97, 7168
  buffer_load_dwordx4 v[60:63], v9, s[16:19], s97 offen offset:0 sc1
  v_mfma_f32_32x32x16_bf16 v[112:127], v[140:143], a[12:15], v[112:127]
  ds_read_b128 v[132:135], v10 offset:35840
  buffer_load_dwordx4 v[64:67], v9, s[16:19], s96 offen offset:1024 sc1
  s_waitcnt lgkmcnt(2)
  v_mfma_f32_32x32x16_bf16 v[112:127], v[144:147], a[16:19], v[112:127]
  ds_read_b128 v[136:139], v10 offset:36864
  buffer_load_dwordx4 v[68:71], v9, s[16:19], s97 offen offset:1024 sc1
  v_mfma_f32_32x32x16_bf16 v[112:127], v[148:151], a[20:23], v[112:127]
  ds_read_b128 v[140:143], v10 offset:37888
  buffer_load_dwordx4 v[72:75], v9, s[16:19], s96 offen offset:2048 sc1
  s_waitcnt lgkmcnt(2)
  v_mfma_f32_32x32x16_bf16 v[112:127], v[128:131], a[24:27], v[112:127]
  ds_read_b128 v[144:147], v10 offset:38912
  buffer_load_dwordx4 v[76:79], v9, s[16:19], s97 offen offset:2048 sc1
  v_mfma_f32_32x32x16_bf16 v[112:127], v[132:135], a[28:31], v[112:127]
  ds_read_b128 v[148:151], v10 offset:39936
  v_mul_f32 v216, v197, v80
  v_mul_f32 v217, v197, v81
  v_mul_f32 v218, v197, v82
  v_mul_f32 v219, v197, v83
  s_waitcnt lgkmcnt(2)
  v_mfma_f32_32x32x16_bf16 v[112:127], v[136:139], a[32:35], v[112:127]
  ds_read_b128 v[128:131], v10 offset:40960
  v_exp_f32 v216, v216
  v_exp_f32 v217, v217
  v_mfma_f32_32x32x16_bf16 v[112:127], v[140:143], a[36:39], v[112:127]
  ds_read_b128 v[132:135], v10 offset:41984
  v_exp_f32 v218, v218
  v_exp_f32 v219, v219
  v_fma_f32 v216, v216, v196, v196
  s_waitcnt lgkmcnt(2)
  v_mfma_f32_32x32x16_bf16 v[112:127], v[144:147], a[40:43], v[112:127]
  ds_read_b128 v[136:139], v10 offset:43008
  v_fma_f32 v217, v217, v196, v196
  v_fma_f32 v218, v218, v196, v196
  v_fma_f32 v219, v219, v196, v196
  v_mfma_f32_32x32x16_bf16 v[112:127], v[148:151], a[44:47], v[112:127]
  ds_read_b128 v[140:143], v10 offset:44032
  v_rcp_f32 v216, v216
  v_rcp_f32 v217, v217
  s_waitcnt lgkmcnt(2)
  v_mfma_f32_32x32x16_bf16 v[112:127], v[128:131], a[48:51], v[112:127]
  ds_read_b128 v[144:147], v10 offset:45056
  v_rcp_f32 v218, v218
  v_rcp_f32 v219, v219
  v_mfma_f32_32x32x16_bf16 v[112:127], v[132:135], a[52:55], v[112:127]
  ds_read_b128 v[148:151], v10 offset:46080
  v_mul_f32 v216, v216, v88
  v_mul_f32 v217, v217, v89
  v_mul_f32 v218, v218, v90
  v_mul_f32 v219, v219, v91
  v_cvt_pk_bf16_f32 v224, v216, v217
  s_waitcnt lgkmcnt(2)
  v_mfma_f32_32x32x16_bf16 v[112:127], v[136:139], a[56:59], v[112:127]
  ds_read_b128 v[128:131], v10 offset:47104
  v_cvt_pk_bf16_f32 v225, v218, v219
  v_mul_f32 v220, v197, v84
  v_mul_f32 v221, v197, v85
  v_mul_f32 v222, v197, v86
  v_mfma_f32_32x32x16_bf16 v[112:127], v[140:143], a[60:63], v[112:127]
  ds_read_b128 v[132:135], v10 offset:48128
  v_mul_f32 v223, v197, v87
  v_exp_f32 v220, v220
  v_exp_f32 v221, v221
  s_waitcnt lgkmcnt(2)
  v_mfma_f32_32x32x16_bf16 v[112:127], v[144:147], a[64:67], v[112:127]
  ds_read_b128 v[136:139], v10 offset:49152
  v_exp_f32 v222, v222
  v_exp_f32 v223, v223
  v_mfma_f32_32x32x16_bf16 v[112:127], v[148:151], a[68:71], v[112:127]
  ds_read_b128 v[140:143], v10 offset:50176
  v_fma_f32 v220, v220, v196, v196
  v_fma_f32 v221, v221, v196, v196
  v_fma_f32 v222, v222, v196, v196
  v_fma_f32 v223, v223, v196, v196
  s_waitcnt lgkmcnt(2)
  v_mfma_f32_32x32x16_bf16 v[112:127], v[128:131], a[72:75], v[112:127]
  ds_read_b128 v[144:147], v10 offset:51200
  v_rcp_f32 v220, v220
  v_rcp_f32 v221, v221
  v_mfma_f32_32x32x16_bf16 v[112:127], v[132:135], a[76:79], v[112:127]
  ds_read_b128 v[148:151], v10 offset:52224
  v_rcp_f32 v222, v222
  v_rcp_f32 v223, v223
  v_mul_f32 v220, v220, v92
  s_waitcnt lgkmcnt(2)
  v_mfma_f32_32x32x16_bf16 v[112:127], v[136:139], a[80:83], v[112:127]
  ds_read_b128 v[128:131], v10 offset:53248
  v_mul_f32 v221, v221, v93
  v_mul_f32 v222, v222, v94
  v_mul_f32 v223, v223, v95
  v_cvt_pk_bf16_f32 v226, v220, v221
  v_mfma_f32_32x32x16_bf16 v[112:127], v[140:143], a[84:87], v[112:127]
  ds_read_b128 v[132:135], v10 offset:54272
  v_cvt_pk_bf16_f32 v227, v222, v223
  s_cmp_eq_u32 s61, 0
  s_cbranch_scc1 S19
  buffer_store_dwordx4 v[224:227], v9, s[16:19], s34 offen offset:0
S19b:
  s_waitcnt lgkmcnt(2)
  v_mfma_f32_32x32x16_bf16 v[112:127], v[144:147], a[88:91], v[112:127]
  ds_read_b128 v[136:139], v10 offset:55296
  v_mul_f32 v216, v197, v96
  v_mul_f32 v217, v197, v97
  v_mul_f32 v218, v197, v98
  v_mul_f32 v219, v197, v99
  v_mfma_f32_32x32x16_bf16 v[112:127], v[148:151], a[92:95], v[112:127]
  ds_read_b128 v[140:143], v10 offset:56320
  v_exp_f32 v216, v216
  v_exp_f32 v217, v217
  s_waitcnt lgkmcnt(2)
  v_mfma_f32_32x32x16_bf16 v[112:127], v[128:131], a[96:99], v[112:127]
  v_exp_f32 v218, v218
  v_exp_f32 v219, v219
  v_mfma_f32_32x32x16_bf16 v[112:127], v[132:135], a[100:103], v[112:127]
  v_fma_f32 v216, v216, v196, v196
  v_fma_f32 v217, v217, v196, v196
  v_fma_f32 v218, v218, v196, v196
  v_fma_f32 v219, v219, v196, v196
  s_waitcnt lgkmcnt(0)
  v_mfma_f32_32x32x16_bf16 v[112:127], v[136:139], a[104:107], v[112:127]
  v_rcp_f32 v216, v216
  v_rcp_f32 v217, v217
  v_mfma_f32_32x32x16_bf16 v[112:127], v[140:143], a[108:111], v[112:127]
  v_rcp_f32 v218, v218
  v_rcp_f32 v219, v219
  v_mul_f32 v216, v216, v104
  v_mfma_f32_32x32x16_bf16 v[112:127], v[184:187], v[192:195], v[112:127]
  v_mul_f32 v217, v217, v105
  v_mul_f32 v218, v218, v106
  v_mul_f32 v219, v219, v107
  v_cvt_pk_bf16_f32 v228, v216, v217
  v_cvt_pk_bf16_f32 v229, v218, v219
  s_lshr_b32 s11, s2, 3
  s_mul_i32 s26, s11, 9363
  s_lshr_b32 s26, s26, 16
  s_mul_i32 s27, s26, 7
  s_sub_u32 s25, s11, s27
  s_min_u32 s26, s26, 3
  s_and_b32 s24, s2, 7
  s_lshl_b32 s24, s24, 2
  s_add_u32 s24, s24, s26
  s_lshr_b32 s26, s3, 1
  s_and_b32 s27, s3, 1
  s_lshl_b32 s24, s24, 1
  s_lshl_b32 s25, s25, 1
  s_add_u32 s24, s24, s26
  s_add_u32 s25, s25, s27
  s_xor_b32 s26, s24, 1
  s_xor_b32 s27, s25, 1
  s_bfe_u32 s36, s24, 0x10002
  s_lshl_b32 s36, s36, 2
  s_add_u32 s36, s36, s3
  s_lshl_b32 s36, s36, 2
  v_and_b32 v7, 3, v2
  v_add_u32 v7, s36, v7
  v_bfe_u32 v6, v2, 2, 1
  s_and_b32 s36, s24, 2
  v_add_u32 v6, s36, v6
  s_and_b32 s38, s2, 7
  s_lshl_b32 s38, s38, 10
  v_lshl_add_u32 v8, v7, 2, v6
  v_lshl_add_u32 v8, v8, 3, s38
  s_mul_i32 s30, s24, 112
  s_mul_i32 s36, s3, 28
  s_add_u32 s30, s30, s36
  s_lshl_b32 s30, s30, 10
  s_add_u32 s30, s30, 14229504
  s_mul_i32 s31, s26, 112
  s_mul_i32 s36, s3, 28
  s_add_u32 s31, s31, s36
  s_lshl_b32 s31, s31, 10
  s_add_u32 s31, s31, 14229504
  s_add_u32 s30, s30, 0
  s_add_u32 s31, s31, 0
  s_add_u32 s35, s15, 21594112
  v_mul_f32 v220, v197, v100
  v_mul_f32 v221, v197, v101
  v_mul_f32 v222, v197, v102
  v_mul_f32 v223, v197, v103
  v_exp_f32 v220, v220
  v_exp_f32 v221, v221
  v_exp_f32 v222, v222
  v_exp_f32 v223, v223
  v_fma_f32 v220, v220, v196, v196
  v_fma_f32 v221, v221, v196, v196
  v_fma_f32 v222, v222, v196, v196
  v_fma_f32 v223, v223, v196, v196
  v_rcp_f32 v220, v220
  v_rcp_f32 v221, v221
  v_rcp_f32 v222, v222
  v_rcp_f32 v223, v223
  v_mul_f32 v220, v220, v108
  v_mul_f32 v221, v221, v109
  v_mul_f32 v222, v222, v110
  v_mul_f32 v223, v223, v111
  v_cvt_pk_bf16_f32 v230, v220, v221
  v_cvt_pk_bf16_f32 v231, v222, v223
  s_cmp_eq_u32 s61, 0
  s_cbranch_scc1 S20
  buffer_store_dwordx4 v[228:231], v9, s[16:19], s34 offen offset:1024
S20b:
  v_pk_mul_f32 v[216:217], v[112:113], v[196:197] op_sel:[0,1] op_sel_hi:[1,1]
  v_pk_mul_f32 v[218:219], v[114:115], v[196:197] op_sel:[0,1] op_sel_hi:[1,1]
  v_exp_f32 v216, v216
  buffer_load_dwordx2 v[6:7], v8, s[16:19], s35 offen sc1
  v_exp_f32 v217, v217
  v_exp_f32 v218, v218
  v_exp_f32 v219, v219
  v_pk_fma_f32 v[216:217], v[216:217], v[196:197], v[196:197] op_sel_hi:[1,0,0]
  v_pk_fma_f32 v[218:219], v[218:219], v[196:197], v[196:197] op_sel_hi:[1,0,0]
  v_rcp_f32 v216, v216
  v_rcp_f32 v217, v217
  v_rcp_f32 v218, v218
  v_rcp_f32 v219, v219
  v_pk_mul_f32 v[216:217], v[216:217], v[120:121]
  v_pk_mul_f32 v[218:219], v[218:219], v[122:123]
  v_cvt_pk_bf16_f32 v224, v216, v217
  v_cvt_pk_bf16_f32 v225, v218, v219
  v_pk_mul_f32 v[220:221], v[116:117], v[196:197] op_sel:[0,1] op_sel_hi:[1,1]
  v_pk_mul_f32 v[222:223], v[118:119], v[196:197] op_sel:[0,1] op_sel_hi:[1,1]
  v_exp_f32 v220, v220
  v_exp_f32 v221, v221
  v_exp_f32 v222, v222
  v_exp_f32 v223, v223
  v_pk_fma_f32 v[220:221], v[220:221], v[196:197], v[196:197] op_sel_hi:[1,0,0]
  v_pk_fma_f32 v[222:223], v[222:223], v[196:197], v[196:197] op_sel_hi:[1,0,0]
  v_rcp_f32 v220, v220
  v_rcp_f32 v221, v221
  v_rcp_f32 v222, v222
  v_rcp_f32 v223, v223
  v_pk_mul_f32 v[220:221], v[220:221], v[124:125]
  v_pk_mul_f32 v[222:223], v[222:223], v[126:127]
  v_cvt_pk_bf16_f32 v226, v220, v221
  v_cvt_pk_bf16_f32 v227, v222, v223
  s_cmp_eq_u32 s61, 0
  s_cbranch_scc1 S21
  buffer_store_dwordx4 v[224:227], v9, s[16:19], s34 offen offset:2048
S21b:
  s_waitcnt vmcnt(1)
  v_cmp_ne_u32 vcc, s14, v6
  s_nop 4
  s_cbranch_vccnz Da_pw0
  buffer_load_dwordx4 v[80:83], v9, s[16:19], s30 offen offset:0 sc1
  buffer_load_dwordx4 v[84:87], v9, s[16:19], s31 offen offset:0 sc1
  buffer_load_dwordx4 v[88:91], v9, s[16:19], s30 offen offset:1024 sc1
  buffer_load_dwordx4 v[92:95], v9, s[16:19], s31 offen offset:1024 sc1
  buffer_load_dwordx4 v[96:99], v9, s[16:19], s30 offen offset:2048 sc1
  buffer_load_dwordx4 v[100:103], v9, s[16:19], s31 offen offset:2048 sc1
  buffer_load_dwordx4 v[104:107], v9, s[16:19], s30 offen offset:3072 sc1
  buffer_load_dwordx4 v[108:111], v9, s[16:19], s31 offen offset:3072 sc1
  s_add_u32 s30, s30, 7168
  s_add_u32 s31, s31, 7168
  buffer_load_dwordx4 v[112:115], v9, s[16:19], s30 offen offset:0 sc1
  buffer_load_dwordx4 v[116:119], v9, s[16:19], s31 offen offset:0 sc1
  s_waitcnt vmcnt(10)
  s_add_u32 s38, s9, 21602304
  s_add_u32 s38, s38, s15
  v_mov_b32 v10, s14
  v_mov_b32 v11, 0
  v_mov_b32 v1, 0
  s_mov_b64 exec, 1
  s_cmp_eq_u32 s61, 0
  s_cbranch_scc1 S22
  buffer_store_dwordx2 v[10:11], v1, s[16:19], s38 offen
S22b:
  s_mov_b64 exec, -1
Da_pb0:
  buffer_load_dwordx4 v[120:123], v9, s[16:19], s30 offen offset:1024 sc1
  buffer_load_dwordx4 v[124:127], v9, s[16:19], s31 offen offset:1024 sc1
  buffer_load_dwordx4 v[128:131], v9, s[16:19], s30 offen offset:2048 sc1
  buffer_load_dwordx4 v[132:135], v9, s[16:19], s31 offen offset:2048 sc1
  buffer_load_dwordx4 v[136:139], v9, s[16:19], s30 offen offset:3072 sc1
  buffer_load_dwordx4 v[140:143], v9, s[16:19], s31 offen offset:3072 sc1
  s_cmp_ge_u32 s11, 28
  s_cbranch_scc1 D_skip0
  s_bfe_u32 s33, s2, 0x20003
  s_lshl_b32 s33, s33, 2
  s_add_u32 s33, s33, s3
  s_mul_i32 s32, s33, 28672
  s_add_u32 s32, s32, 5394432
  s_lshl_b32 s33, s33, 10
  s_add_u32 s33, s33, 5853184
  s_xor_b32 s39, s3, 0
  s_mul_i32 s39, s39, 12288
  s_add_u32 s39, s39, 114688
  v_add_u32 v10, s39, v9
  s_xor_b32 s39, s3, 1
  s_mul_i32 s39, s39, 12288
  s_add_u32 s39, s39, 114688
  v_add_u32 v11, s39, v9
  s_xor_b32 s39, s3, 2
  s_mul_i32 s39, s39, 12288
  s_add_u32 s39, s39, 114688
  v_add_u32 v12, s39, v9
  s_xor_b32 s39, s3, 3
  s_mul_i32 s39, s39, 12288
  s_add_u32 s39, s39, 114688
  v_add_u32 v13, s39, v9
  s_waitcnt vmcnt(16)
  v_mfma_f32_32x32x16_bf16 a[0:15], a[112:115], v[80:83], 0
  v_mfma_f32_32x32x16_bf16 a[16:31], a[116:119], v[80:83], 0
  s_add_u32 s30, s30, 7168
  s_add_u32 s31, s31, 7168
  buffer_load_dwordx4 v[144:147], v9, s[16:19], s30 offen offset:0 sc1
  buffer_load_dwordx4 v[148:151], v9, s[16:19], s31 offen offset:0 sc1
  s_waitcnt vmcnt(17)
  v_mfma_f32_32x32x16_bf16 a[32:47], a[112:115], v[84:87], 0
  v_mfma_f32_32x32x16_bf16 a[48:63], a[116:119], v[84:87], 0
  s_waitcnt vmcnt(16)
  v_mfma_f32_32x32x16_bf16 a[0:15], a[120:123], v[88:91], a[0:15]
  v_mfma_f32_32x32x16_bf16 a[16:31], a[124:127], v[88:91], a[16:31]
  buffer_load_dwordx4 v[152:155], v9, s[16:19], s30 offen offset:1024 sc1
  buffer_load_dwordx4 v[156:159], v9, s[16:19], s31 offen offset:1024 sc1
  s_waitcnt vmcnt(17)
  v_mfma_f32_32x32x16_bf16 a[32:47], a[120:123], v[92:95], a[32:47]
  v_mfma_f32_32x32x16_bf16 a[48:63], a[124:127], v[92:95], a[48:63]
  s_waitcnt vmcnt(16)
  v_mfma_f32_32x32x16_bf16 a[0:15], a[128:131], v[96:99], a[0:15]
  v_mfma_f32_32x32x16_bf16 a[16:31], a[132:135], v[96:99], a[16:31]
  buffer_load_dwordx4 v[80:83], v9, s[16:19], s30 offen offset:2048 sc1
  buffer_load_dwordx4 v[84:87], v9, s[16:19], s31 offen offset:2048 sc1
  s_waitcnt vmcnt(17)
  v_mfma_f32_32x32x16_bf16 a[32:47], a[128:131], v[100:103], a[32:47]
  v_mfma_f32_32x32x16_bf16 a[48:63], a[132:135], v[100:103], a[48:63]
  s_waitcnt vmcnt(16)
  v_mfma_f32_32x32x16_bf16 a[0:15], a[136:139], v[104:107], a[0:15]
  v_mfma_f32_32x32x16_bf16 a[16:31], a[140:143], v[104:107], a[16:31]
  buffer_load_dwordx4 v[88:91], v9, s[16:19], s30 offen offset:3072 sc1
  buffer_load_dwordx4 v[92:95], v9, s[16:19], s31 offen offset:3072 sc1
  s_waitcnt vmcnt(17)
  v_mfma_f32_32x32x16_bf16 a[32:47], a[136:139], v[108:111], a[32:47]
  v_mfma_f32_32x32x16_bf16 a[48:63], a[140:143], v[108:111], a[48:63]
  s_waitcnt vmcnt(16)
  v_mfma_f32_32x32x16_bf16 a[0:15], a[144:147], v[112:115], a[0:15]
  v_mfma_f32_32x32x16_bf16 a[16:31], a[148:151], v[112:115], a[16:31]
  s_add_u32 s30, s30, 7168
  s_add_u32 s31, s31, 7168
  buffer_load_dwordx4 v[96:99], v9, s[16:19], s30 offen offset:0 sc1
  buffer_load_dwordx4 v[100:103], v9, s[16:19], s31 offen offset:0 sc1
  s_waitcnt vmcnt(17)
  v_mfma_f32_32x32x16_bf16 a[32:47], a[144:147], v[116:119], a[32:47]
  v_mfma_f32_32x32x16_bf16 a[48:63], a[148:151], v[116:119], a[48:63]
  s_add_u32 s35, s15, 21602304
  buffer_load_dwordx2 v[6:7], v8, s[16:19], s35 offen sc1
  s_waitcnt vmcnt(16)
  v_mfma_f32_32x32x16_bf16 a[0:15], a[152:155], v[120:123], a[0:15]
  v_mfma_f32_32x32x16_bf16 a[16:31], a[156:159], v[120:123], a[16:31]
  buffer_load_dwordx4 v[104:107], v9, s[16:19], s30 offen offset:1024 sc1
  buffer_load_dwordx4 v[108:111], v9, s[16:19], s31 offen offset:1024 sc1
  s_waitcnt vmcnt(17)
  v_mfma_f32_32x32x16_bf16 a[32:47], a[152:155], v[124:127], a[32:47]
  v_mfma_f32_32x32x16_bf16 a[48:63], a[156:159], v[124:127], a[48:63]
  s_waitcnt vmcnt(16)
  v_mfma_f32_32x32x16_bf16 a[0:15], a[160:163], v[128:131], a[0:15]
  v_mfma_f32_32x32x16_bf16 a[16:31], a[164:167], v[128:131], a[16:31]
  buffer_load_dwordx4 v[112:115], v9, s[16:19], s30 offen offset:2048 sc1
  buffer_load_dwordx4 v[116:119], v9, s[16:19], s31 offen offset:2048 sc1
  s_waitcnt vmcnt(17)
  v_mfma_f32_32x32x16_bf16 a[32:47], a[160:163], v[132:135], a[32:47]
  v_mfma_f32_32x32x16_bf16 a[48:63], a[164:167], v[132:135], a[48:63]
  s_waitcnt vmcnt(16)
  v_mfma_f32_32x32x16_bf16 a[0:15], a[168:171], v[136:139], a[0:15]
  v_mfma_f32_32x32x16_bf16 a[16:31], a[172:175], v[136:139], a[16:31]
  buffer_load_dwordx4 v[120:123], v9, s[16:19], s30 offen offset:3072 sc1
  buffer_load_dwordx4 v[124:127], v9, s[16:19], s31 offen offset:3072 sc1
  s_waitcnt vmcnt(17)
  v_mfma_f32_32x32x16_bf16 a[32:47], a[168:171], v[140:143], a[32:47]
  v_mfma_f32_32x32x16_bf16 a[48:63], a[172:175], v[140:143], a[48:63]
  s_waitcnt vmcnt(6)
  v_cmp_ne_u32 vcc, s14, v6
  s_nop 4
  s_cbranch_vccnz D_pw0
D_pb0:
  v_mfma_f32_32x32x16_bf16 a[0:15], a[176:179], v[144:147], a[0:15]
  v_mfma_f32_32x32x16_bf16 a[16:31], a[180:183], v[144:147], a[16:31]
  s_add_u32 s30, s30, 4294949888
  s_add_u32 s31, s31, 4294949888
  buffer_load_dwordx4 v[128:131], v9, s[16:19], s30 offen offset:0 sc1
  buffer_load_dwordx4 v[132:135], v9, s[16:19], s31 offen offset:0 sc1
  v_mfma_f32_32x32x16_bf16 a[32:47], a[176:179], v[148:151], a[32:47]
  v_mfma_f32_32x32x16_bf16 a[48:63], a[180:183], v[148:151], a[48:63]
  v_mfma_f32_32x32x16_bf16 a[0:15], a[184:187], v[152:155], a[0:15]
  v_mfma_f32_32x32x16_bf16 a[16:31], a[188:191], v[152:155], a[16:31]
  buffer_load_dwordx4 v[136:139], v9, s[16:19], s30 offen offset:1024 sc1
  buffer_load_dwordx4 v[140:143], v9, s[16:19], s31 offen offset:1024 sc1
  v_mfma_f32_32x32x16_bf16 a[32:47], a[184:187], v[156:159], a[32:47]
  v_mfma_f32_32x32x16_bf16 a[48:63], a[188:191], v[156:159], a[48:63]
  v_mfma_f32_32x32x16_bf16 a[0:15], a[192:195], v[80:83], a[0:15]
  v_mfma_f32_32x32x16_bf16 a[16:31], a[196:199], v[80:83], a[16:31]
  buffer_load_dwordx4 v[144:147], v9, s[16:19], s30 offen offset:2048 sc1
  buffer_load_dwordx4 v[148:151], v9, s[16:19], s31 offen offset:2048 sc1
  v_mfma_f32_32x32x16_bf16 a[32:47], a[192:195], v[84:87], a[32:47]
  v_mfma_f32_32x32x16_bf16 a[48:63], a[196:199], v[84:87], a[48:63]
  v_mfma_f32_32x32x16_bf16 a[0:15], a[200:203], v[88:91], a[0:15]
  v_mfma_f32_32x32x16_bf16 a[16:31], a[204:207], v[88:91], a[16:31]
  s_add_u32 s30, s30, 7168
  s_add_u32 s31, s31, 7168
  buffer_load_dwordx4 v[152:155], v9, s[16:19], s30 offen offset:0 sc1
  buffer_load_dwordx4 v[156:159], v9, s[16:19], s31 offen offset:0 sc1
  v_mfma_f32_32x32x16_bf16 a[32:47], a[200:203], v[92:95], a[32:47]
  v_mfma_f32_32x32x16_bf16 a[48:63], a[204:207], v[92:95], a[48:63]
  v_mfma_f32_32x32x16_bf16 a[0:15], a[208:211], v[96:99], a[0:15]
  v_mfma_f32_32x32x16_bf16 a[16:31], a[212:215], v[96:99], a[16:31]
  buffer_load_dwordx4 v[80:83], v9, s[16:19], s30 offen offset:1024 sc1
  buffer_load_dwordx4 v[84:87], v9, s[16:19], s31 offen offset:1024 sc1
  v_mfma_f32_32x32x16_bf16 a[32:47], a[208:211], v[100:103], a[32:47]
  v_mfma_f32_32x32x16_bf16 a[48:63], a[212:215], v[100:103], a[48:63]
  s_waitcnt vmcnt(15)
  v_mfma_f32_32x32x16_bf16 a[0:15], a[216:219], v[104:107], a[0:15]
  v_mfma_f32_32x32x16_bf16 a[16:31], a[220:223], v[104:107], a[16:31]
  buffer_load_dwordx4 v[88:91], v9, s[16:19], s30 offen offset:2048 sc1
  buffer_load_dwordx4 v[92:95], v9, s[16:19], s31 offen offset:2048 sc1
  s_waitcnt vmcnt(16)
  v_mfma_f32_32x32x16_bf16 a[32:47], a[216:219], v[108:111], a[32:47]
  v_mfma_f32_32x32x16_bf16 a[48:63], a[220:223], v[108:111], a[48:63]
  s_waitcnt vmcnt(15)
  v_mfma_f32_32x32x16_bf16 a[0:15], a[224:227], v[112:115], a[0:15]
  v_mfma_f32_32x32x16_bf16 a[16:31], a[228:231], v[112:115], a[16:31]
  s_add_u32 s30, s30, 7168
  s_add_u32 s31, s31, 7168
  buffer_load_dwordx4 v[96:99], v9, s[16:19], s30 offen offset:0 sc1
  buffer_load_dwordx4 v[100:103], v9, s[16:19], s31 offen offset:0 sc1
  s_waitcnt vmcnt(16)
  v_mfma_f32_32x32x16_bf16 a[32:47], a[224:227], v[116:119], a[32:47]
  v_mfma_f32_32x32x16_bf16 a[48:63], a[228:231], v[116:119], a[48:63]
  s_waitcnt vmcnt(15)
  v_mfma_f32_32x32x16_bf16 a[0:15], a[232:235], v[120:123], a[0:15]
  v_mfma_f32_32x32x16_bf16 a[16:31], a[236:239], v[120:123], a[16:31]
  buffer_load_dwordx4 v[104:107], v9, s[16:19], s30 offen offset:1024 sc1
  buffer_load_dwordx4 v[108:111], v9, s[16:19], s31 offen offset:1024 sc1
  s_waitcnt vmcnt(16)
  v_mfma_f32_32x32x16_bf16 a[32:47], a[232:235], v[124:127], a[32:47]
  v_mfma_f32_32x32x16_bf16 a[48:63], a[236:239], v[124:127], a[48:63]
  s_waitcnt vmcnt(15)
  v_mfma_f32_32x32x16_bf16 a[0:15], a[240:243], v[128:131], a[0:15]
  v_mfma_f32_32x32x16_bf16 a[16:31], a[244:247], v[128:131], a[16:31]
  buffer_load_dwordx4 v[112:115], v9, s[16:19], s30 offen offset:2048 sc1
  buffer_load_dwordx4 v[116:119], v9, s[16:19], s31 offen offset:2048 sc1
  s_waitcnt vmcnt(16)
  v_mfma_f32_32x32x16_bf16 a[32:47], a[240:243], v[132:135], a[32:47]
  v_mfma_f32_32x32x16_bf16 a[48:63], a[244:247], v[132:135], a[48:63]
  s_waitcnt vmcnt(15)
  v_mfma_f32_32x32x16_bf16 a[0:15], v[232:235], v[136:139], a[0:15]
  v_mfma_f32_32x32x16_bf16 a[16:31], v[236:239], v[136:139], a[16:31]
  s_add_u32 s30, s30, 7168
  s_add_u32 s31, s31, 7168
  buffer_load_dwordx4 v[120:123], v9, s[16:19], s30 offen offset:0 sc1
  buffer_load_dwordx4 v[124:127], v9, s[16:19], s31 offen offset:0 sc1
  s_waitcnt vmcnt(16)
  v_mfma_f32_32x32x16_bf16 a[32:47], v[232:235], v[140:143], a[32:47]
  v_mfma_f32_32x32x16_bf16 a[48:63], v[236:239], v[140:143], a[48:63]
  s_waitcnt vmcnt(15)
  v_mfma_f32_32x32x16_bf16 a[0:15], v[240:243], v[144:147], a[0:15]
  v_mfma_f32_32x32x16_bf16 a[16:31], v[244:247], v[144:147], a[16:31]
  buffer_load_dwordx4 v[128:131], v9, s[16:19], s30 offen offset:1024 sc1
  buffer_load_dwordx4 v[132:135], v9, s[16:19], s31 offen offset:1024 sc1
  s_waitcnt vmcnt(16)
  v_mfma_f32_32x32x16_bf16 a[32:47], v[240:243], v[148:151], a[32:47]
  v_mfma_f32_32x32x16_bf16 a[48:63], v[244:247], v[148:151], a[48:63]
  s_waitcnt vmcnt(15)
  v_mfma_f32_32x32x16_bf16 a[0:15], v[248:251], v[152:155], a[0:15]
  v_mfma_f32_32x32x16_bf16 a[16:31], v[252:255], v[152:155], a[16:31]
  buffer_load_dwordx4 v[136:139], v9, s[16:19], s30 offen offset:2048 sc1
  buffer_load_dwordx4 v[140:143], v9, s[16:19], s31 offen offset:2048 sc1
  s_waitcnt vmcnt(16)
  v_mfma_f32_32x32x16_bf16 a[32:47], v[248:251], v[156:159], a[32:47]
  v_mfma_f32_32x32x16_bf16 a[48:63], v[252:255], v[156:159], a[48:63]
  s_waitcnt vmcnt(15)
  v_mfma_f32_32x32x16_bf16 a[0:15], v[16:19], v[80:83], a[0:15]
  v_mfma_f32_32x32x16_bf16 a[16:31], v[20:23], v[80:83], a[16:31]
  buffer_load_dwordx4 a[64:67], v9, s[16:19], s32 offen offset:0 sc1
  s_waitcnt vmcnt(15)
  v_mfma_f32_32x32x16_bf16 a[32:47], v[16:19], v[84:87], a[32:47]
  v_mfma_f32_32x32x16_bf16 a[48:63], v[20:23], v[84:87], a[48:63]
  buffer_load_dwordx4 a[68:71], v9, s[16:19], s32 offen offset:1024 sc1
  s_waitcnt vmcnt(15)
  v_mfma_f32_32x32x16_bf16 a[0:15], v[24:27], v[88:91], a[0:15]
  v_mfma_f32_32x32x16_bf16 a[16:31], v[28:31], v[88:91], a[16:31]
  buffer_load_dwordx4 a[72:75], v9, s[16:19], s32 offen offset:2048 sc1
  s_waitcnt vmcnt(15)
  v_mfma_f32_32x32x16_bf16 a[32:47], v[24:27], v[92:95], a[32:47]
  v_mfma_f32_32x32x16_bf16 a[48:63], v[28:31], v[92:95], a[48:63]
  buffer_load_dwordx4 a[76:79], v9, s[16:19], s32 offen offset:3072 sc1
  s_add_u32 s32, s32, 4096
  s_waitcnt vmcnt(15)
  v_mfma_f32_32x32x16_bf16 a[0:15], v[32:35], v[96:99], a[0:15]
  v_mfma_f32_32x32x16_bf16 a[16:31], v[36:39], v[96:99], a[16:31]
  buffer_load_dwordx4 a[80:83], v9, s[16:19], s32 offen offset:0 sc1
  s_waitcnt vmcnt(15)
  v_mfma_f32_32x32x16_bf16 a[32:47], v[32:35], v[100:103], a[32:47]
  v_mfma_f32_32x32x16_bf16 a[48:63], v[36:39], v[100:103], a[48:63]
  buffer_load_dwordx4 a[84:87], v9, s[16:19], s32 offen offset:1024 sc1
  s_waitcnt vmcnt(15)
  v_mfma_f32_32x32x16_bf16 a[0:15], v[40:43], v[104:107], a[0:15]
  v_mfma_f32_32x32x16_bf16 a[16:31], v[44:47], v[104:107], a[16:31]
  buffer_load_dwordx4 a[88:91], v9, s[16:19], s32 offen offset:2048 sc1
  s_waitcnt vmcnt(15)
  v_mfma_f32_32x32x16_bf16 a[32:47], v[40:43], v[108:111], a[32:47]
  v_mfma_f32_32x32x16_bf16 a[48:63], v[44:47], v[108:111], a[48:63]
  buffer_load_dwordx4 a[92:95], v9, s[16:19], s32 offen offset:3072 sc1
  s_add_u32 s32, s32, 4096
  s_waitcnt vmcnt(15)
  v_mfma_f32_32x32x16_bf16 a[0:15], v[48:51], v[112:115], a[0:15]
  v_mfma_f32_32x32x16_bf16 a[16:31], v[52:55], v[112:115], a[16:31]
  buffer_load_dwordx4 a[96:99], v9, s[16:19], s32 offen offset:0 sc1
  s_waitcnt vmcnt(15)
  v_mfma_f32_32x32x16_bf16 a[32:47], v[48:51], v[116:119], a[32:47]
  v_mfma_f32_32x32x16_bf16 a[48:63], v[52:55], v[116:119], a[48:63]
  buffer_load_dwordx4 a[100:103], v9, s[16:19], s32 offen offset:1024 sc1
  s_waitcnt vmcnt(15)
  v_mfma_f32_32x32x16_bf16 a[0:15], v[56:59], v[120:123], a[0:15]
  v_mfma_f32_32x32x16_bf16 a[16:31], v[60:63], v[120:123], a[16:31]
  buffer_load_dwordx4 a[104:107], v9, s[16:19], s32 offen offset:2048 sc1
  s_waitcnt vmcnt(15)
  v_mfma_f32_32x32x16_bf16 a[32:47], v[56:59], v[124:127], a[32:47]
  v_mfma_f32_32x32x16_bf16 a[48:63], v[60:63], v[124:127], a[48:63]
  buffer_load_dwordx4 a[108:111], v9, s[16:19], s32 offen offset:3072 sc1
  s_add_u32 s32, s32, 4096
  s_waitcnt vmcnt(15)
  v_mfma_f32_32x32x16_bf16 a[0:15], v[64:67], v[128:131], a[0:15]
  v_mfma_f32_32x32x16_bf16 a[16:31], v[68:71], v[128:131], a[16:31]
  buffer_load_dwordx4 v[160:163], v9, s[16:19], s32 offen offset:0 sc1
  s_waitcnt vmcnt(15)
  v_mfma_f32_32x32x16_bf16 a[32:47], v[64:67], v[132:135], a[32:47]
  v_mfma_f32_32x32x16_bf16 a[48:63], v[68:71], v[132:135], a[48:63]
  buffer_load_dwordx4 v[164:167], v9, s[16:19], s32 offen offset:1024 sc1
  s_waitcnt vmcnt(15)
  v_mfma_f32_32x32x16_bf16 a[0:15], v[72:75], v[136:139], a[0:15]
  v_mfma_f32_32x32x16_bf16 a[16:31], v[76:79], v[136:139], a[16:31]
  buffer_load_dwordx4 v[168:171], v9, s[16:19], s32 offen offset:2048 sc1
  s_waitcnt vmcnt(15)
  v_mfma_f32_32x32x16_bf16 a[32:47], v[72:75], v[140:143], a[32:47]
  v_mfma_f32_32x32x16_bf16 a[48:63], v[76:79], v[140:143], a[48:63]
  buffer_load_dwordx4 v[172:175], v9, s[16:19], s32 offen offset:3072 sc1
  s_add_u32 s32, s32, 4096
  s_nop 3
  ds_write_b128 v11, a[16:19] offset:0
  ds_write_b128 v11, a[20:23] offset:1024
  ds_write_b128 v11, a[24:27] offset:2048
  ds_write_b128 v11, a[28:31] offset:3072
  ds_write_b128 v12, a[32:35] offset:4096
  ds_write_b128 v12, a[36:39] offset:5120
  ds_write_b128 v12, a[40:43] offset:6144
  ds_write_b128 v12, a[44:47] offset:7168
  s_nop 7
  ds_write_b128 v13, a[48:51] offset:8192
  ds_write_b128 v13, a[52:55] offset:9216
  ds_write_b128 v13, a[56:59] offset:10240
  ds_write_b128 v13, a[60:63] offset:11264
  buffer_load_dwordx4 v[176:179], v9, s[16:19], s32 offen offset:0 sc1
  buffer_load_dwordx4 v[180:183], v9, s[16:19], s32 offen offset:1024 sc1
  v_accvgpr_read_b32 v14, a248
  v_lshlrev_b32 v15, 16, v14
  v_and_b32 v14, 0xffff0000, v14
  v_accvgpr_read_b32 v80, a0
  v_accvgpr_read_b32 v81, a1
  v_pk_add_f32 v[80:81], v[80:81], v[14:15] op_sel:[0,1] op_sel_hi:[1,0]
  buffer_load_dwordx4 v[184:187], v9, s[16:19], s32 offen offset:2048 sc1
  buffer_load_dwordx4 v[188:191], v9, s[16:19], s32 offen offset:3072 sc1
  s_add_u32 s32, s32, 4096
  v_accvgpr_read_b32 v14, a249
  v_lshlrev_b32 v15, 16, v14
  v_and_b32 v14, 0xffff0000, v14
  v_accvgpr_read_b32 v82, a2
  v_accvgpr_read_b32 v83, a3
  v_pk_add_f32 v[82:83], v[82:83], v[14:15] op_sel:[0,1] op_sel_hi:[1,0]
  buffer_load_dwordx4 v[192:195], v9, s[16:19], s32 offen offset:0 sc1
  buffer_load_dwordx4 v[196:199], v9, s[16:19], s32 offen offset:1024 sc1
  v_accvgpr_read_b32 v14, a250
  v_lshlrev_b32 v15, 16, v14
  v_and_b32 v14, 0xffff0000, v14
  v_accvgpr_read_b32 v84, a4
  v_accvgpr_read_b32 v85, a5
  v_pk_add_f32 v[84:85], v[84:85], v[14:15] op_sel:[0,1] op_sel_hi:[1,0]
  buffer_load_dwordx4 v[200:203], v9, s[16:19], s32 offen offset:2048 sc1
  buffer_load_dwordx4 v[204:207], v9, s[16:19], s32 offen offset:3072 sc1
  s_add_u32 s32, s32, 4096
  v_accvgpr_read_b32 v14, a251
  v_lshlrev_b32 v15, 16, v14
  v_and_b32 v14, 0xffff0000, v14
  v_accvgpr_read_b32 v86, a6
  v_accvgpr_read_b32 v87, a7
  v_pk_add_f32 v[86:87], v[86:87], v[14:15] op_sel:[0,1] op_sel_hi:[1,0]
  buffer_load_dwordx4 v[208:211], v9, s[16:19], s32 offen offset:0 sc1
  buffer_load_dwordx4 v[212:215], v9, s[16:19], s32 offen offset:1024 sc1
  v_accvgpr_read_b32 v14, a252
  v_lshlrev_b32 v15, 16, v14
  v_and_b32 v14, 0xffff0000, v14
  v_accvgpr_read_b32 v88, a8
  v_accvgpr_read_b32 v89, a9
  v_pk_add_f32 v[88:89], v[88:89], v[14:15] op_sel:[0,1] op_sel_hi:[1,0]
  buffer_load_dwordx4 v[216:219], v9, s[16:19], s32 offen offset:2048 sc1
  buffer_load_dwordx4 v[220:223], v9, s[16:19], s32 offen offset:3072 sc1
  s_add_u32 s32, s32, 4096
  v_accvgpr_read_b32 v14, a253
  v_lshlrev_b32 v15, 16, v14
  v_and_b32 v14, 0xffff0000, v14
  v_accvgpr_read_b32 v90, a10
  v_accvgpr_read_b32 v91, a11
  v_pk_add_f32 v[90:91], v[90:91], v[14:15] op_sel:[0,1] op_sel_hi:[1,0]
  buffer_load_dwordx4 v[224:227], v9, s[16:19], s33 offen sc1
  v_accvgpr_read_b32 v14, a254
  v_lshlrev_b32 v15, 16, v14
  v_and_b32 v14, 0xffff0000, v14
  v_accvgpr_read_b32 v92, a12
  v_accvgpr_read_b32 v93, a13
  v_pk_add_f32 v[92:93], v[92:93], v[14:15] op_sel:[0,1] op_sel_hi:[1,0]
  v_accvgpr_read_b32 v14, a255
  v_lshlrev_b32 v15, 16, v14
  v_and_b32 v14, 0xffff0000, v14
  v_accvgpr_read_b32 v94, a14
  v_accvgpr_read_b32 v95, a15
  v_pk_add_f32 v[94:95], v[94:95], v[14:15] op_sel:[0,1] op_sel_hi:[1,0]
  s_waitcnt lgkmcnt(0)
  s_barrier
  ds_read_b128 v[96:99], v10 offset:0
  ds_read_b128 v[100:103], v10 offset:1024
  ds_read_b128 v[104:107], v10 offset:2048
  ds_read_b128 v[108:111], v10 offset:3072
  ds_read_b128 v[112:115], v10 offset:4096
  ds_read_b128 v[116:119], v10 offset:5120
  ds_read_b128 v[120:123], v10 offset:6144
  ds_read_b128 v[124:127], v10 offset:7168
  ds_read_b128 v[128:131], v10 offset:8192
  ds_read_b128 v[132:135], v10 offset:9216
  ds_read_b128 v[136:139], v10 offset:10240
  ds_read_b128 v[140:143], v10 offset:11264
  s_waitcnt lgkmcnt(8)
  v_pk_add_f32 v[80:81], v[80:81], v[96:97]
  v_pk_add_f32 v[82:83], v[82:83], v[98:99]
  v_pk_add_f32 v[84:85], v[84:85], v[100:101]
  v_pk_add_f32 v[86:87], v[86:87], v[102:103]
  v_pk_add_f32 v[88:89], v[88:89], v[104:105]
  v_pk_add_f32 v[90:91], v[90:91], v[106:107]
  v_pk_add_f32 v[92:93], v[92:93], v[108:109]
  v_pk_add_f32 v[94:95], v[94:95], v[110:111]
  s_waitcnt lgkmcnt(4)
  v_pk_add_f32 v[80:81], v[80:81], v[112:113]
  v_pk_add_f32 v[82:83], v[82:83], v[114:115]
  v_pk_add_f32 v[84:85], v[84:85], v[116:117]
  v_pk_add_f32 v[86:87], v[86:87], v[118:119]
  v_pk_add_f32 v[88:89], v[88:89], v[120:121]
  v_pk_add_f32 v[90:91], v[90:91], v[122:123]
  v_pk_add_f32 v[92:93], v[92:93], v[124:125]
  v_pk_add_f32 v[94:95], v[94:95], v[126:127]
  s_waitcnt lgkmcnt(0)
  v_pk_add_f32 v[80:81], v[80:81], v[128:129]
  v_pk_add_f32 v[82:83], v[82:83], v[130:131]
  v_pk_add_f32 v[84:85], v[84:85], v[132:133]
  v_pk_add_f32 v[86:87], v[86:87], v[134:135]
  v_pk_add_f32 v[88:89], v[88:89], v[136:137]
  v_pk_add_f32 v[90:91], v[90:91], v[138:139]
  v_pk_add_f32 v[92:93], v[92:93], v[140:141]
  v_pk_add_f32 v[94:95], v[94:95], v[142:143]
  v_cvt_pk_bf16_f32 v96, v80, v81
  v_cvt_pk_bf16_f32 v97, v82, v83
  v_cvt_pk_bf16_f32 v98, v84, v85
  v_cvt_pk_bf16_f32 v99, v86, v87
  v_cvt_pk_bf16_f32 v100, v88, v89
  v_cvt_pk_bf16_f32 v101, v90, v91
  v_cvt_pk_bf16_f32 v102, v92, v93
  v_cvt_pk_bf16_f32 v103, v94, v95
  s_mul_i32 s38, s24, 28
  s_lshl_b32 s39, s25, 1
  s_add_u32 s38, s38, s39
  s_lshl_b32 s38, s38, 10
  s_add_u32 s38, s38, 0
  s_add_u32 s38, s38, 10330112
  s_cmp_eq_u32 s61, 0
  s_cbranch_scc1 S26
  buffer_store_dwordx4 v[96:99], v9, s[16:19], s38 offen offset:0
  buffer_store_dwordx4 v[100:103], v9, s[16:19], s38 offen offset:1024
S26b:
  v_pk_add_f32 v[24:25], v[80:81], v[82:83]
  v_pk_mul_f32 v[26:27], v[80:81], v[80:81]
  v_pk_fma_f32 v[26:27], v[82:83], v[82:83], v[26:27]
  v_pk_add_f32 v[24:25], v[24:25], v[84:85]
  v_pk_fma_f32 v[26:27], v[84:85], v[84:85], v[26:27]
  v_pk_add_f32 v[24:25], v[24:25], v[86:87]
  v_pk_fma_f32 v[26:27], v[86:87], v[86:87], v[26:27]
  v_pk_add_f32 v[24:25], v[24:25], v[88:89]
  v_pk_fma_f32 v[26:27], v[88:89], v[88:89], v[26:27]
  v_pk_add_f32 v[24:25], v[24:25], v[90:91]
  v_pk_fma_f32 v[26:27], v[90:91], v[90:91], v[26:27]
  v_pk_add_f32 v[24:25], v[24:25], v[92:93]
  v_pk_fma_f32 v[26:27], v[92:93], v[92:93], v[26:27]
  v_pk_add_f32 v[24:25], v[24:25], v[94:95]
  v_pk_fma_f32 v[26:27], v[94:95], v[94:95], v[26:27]
  v_add_f32 v24, v24, v25
  v_add_f32 v25, v26, v27
  v_mov_b32 v26, v24
  v_mov_b32 v27, v25
  s_mul_i32 s38, s24, 14
  s_add_u32 s38, s38, s25
  v_permlane32_swap_b32 v24, v26
  v_permlane32_swap_b32 v25, v27
  s_lshl_b32 s38, s38, 8
  s_add_u32 s38, s38, 0
  s_add_u32 s38, s38, 14000128
  v_add_f32 v24, v24, v26
  v_add_f32 v25, v25, v27
  v_lshlrev_b32 v6, 3, v3
  s_cmp_eq_u32 s61, 0
  s_cbranch_scc1 S27
  buffer_store_dwordx2 v[24:25], v6, s[16:19], s38 offen
S27b:
  v_accvgpr_write_b32 a248, v96
  v_accvgpr_write_b32 a249, v97
  v_accvgpr_write_b32 a250, v98
  v_accvgpr_write_b32 a251, v99
  v_accvgpr_write_b32 a252, v100
  v_accvgpr_write_b32 a253, v101
  v_accvgpr_write_b32 a254, v102
  v_accvgpr_write_b32 a255, v103
  s_barrier
  s_branch D_end0
D_skip0:
  s_barrier
  s_bfe_u32 s33, s2, 0x20003
  s_lshl_b32 s33, s33, 2
  s_add_u32 s33, s33, s3
  s_mul_i32 s32, s33, 28672
  s_add_u32 s32, s32, 5394432
  s_lshl_b32 s33, s33, 10
  s_add_u32 s33, s33, 5853184
  buffer_load_dwordx4 a[64:67], v9, s[16:19], s32 offen offset:0 sc1
  buffer_load_dwordx4 a[68:71], v9, s[16:19], s32 offen offset:1024 sc1
  buffer_load_dwordx4 a[72:75], v9, s[16:19], s32 offen offset:2048 sc1
  buffer_load_dwordx4 a[76:79], v9, s[16:19], s32 offen offset:3072 sc1
  s_add_u32 s32, s32, 4096
  buffer_load_dwordx4 a[80:83], v9, s[16:19], s32 offen offset:0 sc1
  buffer_load_dwordx4 a[84:87], v9, s[16:19], s32 offen offset:1024 sc1
  buffer_load_dwordx4 a[88:91], v9, s[16:19], s32 offen offset:2048 sc1
  buffer_load_dwordx4 a[92:95], v9, s[16:19], s32 offen offset:3072 sc1
  s_add_u32 s32, s32, 4096
  buffer_load_dwordx4 a[96:99], v9, s[16:19], s32 offen offset:0 sc1
  buffer_load_dwordx4 a[100:103], v9, s[16:19], s32 offen offset:1024 sc1
  buffer_load_dwordx4 a[104:107], v9, s[16:19], s32 offen offset:2048 sc1
  buffer_load_dwordx4 a[108:111], v9, s[16:19], s32 offen offset:3072 sc1
  s_add_u32 s32, s32, 4096
  buffer_load_dwordx4 v[160:163], v9, s[16:19], s32 offen offset:0 sc1
  buffer_load_dwordx4 v[164:167], v9, s[16:19], s32 offen offset:1024 sc1
  buffer_load_dwordx4 v[168:171], v9, s[16:19], s32 offen offset:2048 sc1
  buffer_load_dwordx4 v[172:175], v9, s[16:19], s32 offen offset:3072 sc1
  s_add_u32 s32, s32, 4096
  buffer_load_dwordx4 v[176:179], v9, s[16:19], s32 offen offset:0 sc1
  buffer_load_dwordx4 v[180:183], v9, s[16:19], s32 offen offset:1024 sc1
  buffer_load_dwordx4 v[184:187], v9, s[16:19], s32 offen offset:2048 sc1
  buffer_load_dwordx4 v[188:191], v9, s[16:19], s32 offen offset:3072 sc1
  s_add_u32 s32, s32, 4096
  buffer_load_dwordx4 v[192:195], v9, s[16:19], s32 offen offset:0 sc1
  buffer_load_dwordx4 v[196:199], v9, s[16:19], s32 offen offset:1024 sc1
  buffer_load_dwordx4 v[200:203], v9, s[16:19], s32 offen offset:2048 sc1
  buffer_load_dwordx4 v[204:207], v9, s[16:19], s32 offen offset:3072 sc1
  s_add_u32 s32, s32, 4096
  buffer_load_dwordx4 v[208:211], v9, s[16:19], s32 offen offset:0 sc1
  buffer_load_dwordx4 v[212:215], v9, s[16:19], s32 offen offset:1024 sc1
  buffer_load_dwordx4 v[216:219], v9, s[16:19], s32 offen offset:2048 sc1
  buffer_load_dwordx4 v[220:223], v9, s[16:19], s32 offen offset:3072 sc1
  s_add_u32 s32, s32, 4096
  buffer_load_dwordx4 v[224:227], v9, s[16:19], s33 offen sc1
D_end0:
  s_and_b32 s24, s2, 7
  s_lshr_b32 s25, s2, 5
  s_lshl_b32 s24, s24, 3
  s_add_u32 s24, s24, s25
  s_bfe_u32 s26, s2, 0x20003
  s_lshl_b32 s26, s26, 2
  s_add_u32 s26, s26, s3
  s_lshr_b32 s36, s2, 6
  s_mul_i32 s36, s36, 7
  v_min_u32 v10, 13, v2
  v_lshrrev_b32 v11, 1, v10
  v_add_u32 v11, s36, v11
  v_and_b32 v10, 1, v10
  s_and_b32 s36, s24, 1
  s_lshl_b32 s36, s36, 1
  v_add_u32 v10, s36, v10
  s_and_b32 s38, s2, 7
  s_lshl_b32 s38, s38, 10
  v_lshl_add_u32 v12, v11, 2, v10
  v_lshl_add_u32 v12, v12, 3, s38
  s_mul_i32 s28, s3, 7168
  s_mul_i32 s27, s24, 28672
  s_add_u32 s27, s27, s28
  s_add_u32 s27, s27, 10330112
  s_add_u32 m0, s28, 114688
  v_add_u32 v6, 114688, v9
  s_mul_i32 s30, s24, 3584
  s_add_u32 s30, s30, 14000128
  v_mul_u32_u24 v5, 1792, v4
  v_lshl_add_u32 v5, v3, 3, v5
  v_lshlrev_b32 v7, 2, v3
  v_add_u32 v7, 147456, v7
  v_lshlrev_b32 v8, 4, v4
  v_add_u32 v8, 147456, v8
  s_add_u32 s38, s9, 21610496
  s_add_u32 s38, s38, s15
  v_mov_b32 v10, s14
  v_mov_b32 v11, 0
  v_mov_b32 v1, 0
  s_waitcnt vmcnt(0)
  s_mov_b64 exec, 1
  s_cmp_eq_u32 s61, 0
  s_cbranch_scc1 S28
  buffer_store_dwordx2 v[10:11], v1, s[16:19], s38 offen
S28b:
  s_mov_b64 exec, -1
  s_mov_b32 s39, 200000
W29:
  s_add_u32 s38, s15, 21610496
  buffer_load_dwordx2 v[14:15], v12, s[16:19], s38 offen sc1
  s_waitcnt vmcnt(0)
  v_cmp_ne_u32 vcc, s14, v14
  s_nop 1
  s_cmp_eq_u64 vcc, 0
  s_cbranch_scc1 Wd30
  s_sub_u32 s39, s39, 1
  s_cmp_lg_u32 s39, 0
  s_cbranch_scc1 W29
Wd30:
  s_mov_b32 s15, 15765504
  buffer_load_dwordx4 v9, s[16:19], s27 offen offset:0 sc1 lds
  buffer_load_dwordx4 v9, s[16:19], s27 offen offset:1024 sc1 lds
  buffer_load_dwordx4 v9, s[16:19], s27 offen offset:2048 sc1 lds
  buffer_load_dwordx4 v9, s[16:19], s27 offen offset:3072 sc1 lds
  s_add_u32 m0, m0, 4096
  s_add_u32 s27, s27, 4096
  buffer_load_dwordx4 v9, s[16:19], s27 offen offset:0 sc1 lds
  buffer_load_dwordx4 v9, s[16:19], s27 offen offset:1024 sc1 lds
  buffer_load_dwordx4 v9, s[16:19], s27 offen offset:2048 sc1 lds
  buffer_load_dwordx2 v[32:33], v5, s[16:19], s30 offen offset:0 sc1
  buffer_load_dwordx2 v[34:35], v5, s[16:19], s30 offen offset:256 sc1
  buffer_load_dwordx2 v[36:37], v5, s[16:19], s30 offen offset:512 sc1
  buffer_load_dwordx2 v[38:39], v5, s[16:19], s30 offen offset:768 sc1
  buffer_load_dwordx2 v[40:41], v5, s[16:19], s30 offen offset:1024 sc1
  buffer_load_dwordx2 v[42:43], v5, s[16:19], s30 offen offset:1280 sc1
  buffer_load_dwordx2 v[44:45], v5, s[16:19], s30 offen offset:1536 sc1
  s_waitcnt vmcnt(7)
  s_barrier
  s_cmp_eq_u32 s26, 15
  s_cbranch_scc1 q1_v
  ds_read_b128 v[96:99], v6 offset:0
  ds_read_b128 v[100:103], v6 offset:1024
  ds_read_b128 v[104:107], v6 offset:2048
  ds_read_b128 v[108:111], v6 offset:3072
  s_waitcnt lgkmcnt(2)
  v_mfma_f32_32x32x16_bf16 v[64:79], a[64:67], v[96:99], 0
  ds_read_b128 v[112:115], v6 offset:4096
  v_mfma_f32_32x32x16_bf16 v[64:79], a[68:71], v[100:103], v[64:79]
  ds_read_b128 v[116:119], v6 offset:5120
  s_waitcnt lgkmcnt(2)
  v_mfma_f32_32x32x16_bf16 v[64:79], a[72:75], v[104:107], v[64:79]
  ds_read_b128 v[96:99], v6 offset:6144
  v_mfma_f32_32x32x16_bf16 v[64:79], a[76:79], v[108:111], v[64:79]
  ds_read_b128 v[100:103], v6 offset:7168
  s_waitcnt lgkmcnt(2)
  v_mfma_f32_32x32x16_bf16 v[64:79], a[80:83], v[112:115], v[64:79]
  ds_read_b128 v[104:107], v6 offset:8192
  v_mfma_f32_32x32x16_bf16 v[64:79], a[84:87], v[116:119], v[64:79]
  ds_read_b128 v[108:111], v6 offset:9216
  s_waitcnt lgkmcnt(2)
  v_mfma_f32_32x32x16_bf16 v[64:79], a[88:91], v[96:99], v[64:79]
  ds_read_b128 v[112:115], v6 offset:10240
  v_mfma_f32_32x32x16_bf16 v[64:79], a[92:95], v[100:103], v[64:79]
  ds_read_b128 v[116:119], v6 offset:11264
  s_waitcnt lgkmcnt(2)
  v_mfma_f32_32x32x16_bf16 v[64:79], a[96:99], v[104:107], v[64:79]
  ds_read_b128 v[96:99], v6 offset:12288
  s_waitcnt vmcnt(0)
  v_add_f32 v32, v32, v34
  v_add_f32 v33, v33, v35
  v_add_f32 v32, v32, v36
  v_add_f32 v33, v33, v37
  v_mfma_f32_32x32x16_bf16 v[64:79], a[100:103], v[108:111], v[64:79]
  ds_read_b128 v[100:103], v6 offset:13312
  v_add_f32 v32, v32, v38
  v_add_f32 v33, v33, v39
  v_add_f32 v32, v32, v40
  v_add_f32 v33, v33, v41
  s_waitcnt lgkmcnt(2)
  v_mfma_f32_32x32x16_bf16 v[64:79], a[104:107], v[112:115], v[64:79]
  ds_read_b128 v[104:107], v6 offset:14336
  v_add_f32 v32, v32, v42
  v_add_f32 v33, v33, v43
  v_add_f32 v32, v32, v44
  v_add_f32 v33, v33, v45
  v_mfma_f32_32x32x16_bf16 v[64:79], a[108:111], v[116:119], v[64:79]
  ds_read_b128 v[108:111], v6 offset:15360
  v_mov_b32 v34, v32
  v_mov_b32 v35, v33
  s_nop 1
  v_permlane32_swap_b32 v32, v34
  s_waitcnt lgkmcnt(2)
  v_mfma_f32_32x32x16_bf16 v[64:79], v[160:163], v[96:99], v[64:79]
  ds_read_b128 v[112:115], v6 offset:16384
  v_permlane32_swap_b32 v33, v35
  s_nop 1
  v_add_f32 v32, v32, v34
  v_add_f32 v33, v33, v35
  v_mfma_f32_32x32x16_bf16 v[64:79], v[164:167], v[100:103], v[64:79]
  ds_read_b128 v[116:119], v6 offset:17408
  v_mul_f32 v32, 0xbb124925, v32
  v_mul_f32 v33, 0x3b124925, v33
  v_fma_f32 v33, -v32, v32, v33
  v_max_f32 v33, 0, v33
  s_waitcnt lgkmcnt(2)
  v_mfma_f32_32x32x16_bf16 v[64:79], v[168:171], v[104:107], v[64:79]
  ds_read_b128 v[96:99], v6 offset:18432
  v_add_f32 v33, 0x3727c5ac, v33
  v_cvt_pk_bf16_f32 v24, v32, v32
  v_rsq_f32 v31, v33
  v_and_b32 v34, 0xffff0000, v24
  v_mfma_f32_32x32x16_bf16 v[64:79], v[172:175], v[108:111], v[64:79]
  ds_read_b128 v[100:103], v6 offset:19456
  v_sub_f32 v34, v32, v34
  v_cvt_pk_bf16_f32 v25, v34, 0
  v_mov_b32 v26, v24
  v_mov_b32 v27, v25
  s_waitcnt lgkmcnt(2)
  v_mfma_f32_32x32x16_bf16 v[64:79], v[176:179], v[112:115], v[64:79]
  ds_read_b128 v[104:107], v6 offset:20480
  v_mfma_f32_32x32x16_bf16 v[64:79], v[180:183], v[116:119], v[64:79]
  ds_read_b128 v[108:111], v6 offset:21504
  s_waitcnt lgkmcnt(2)
  v_mfma_f32_32x32x16_bf16 v[64:79], v[184:187], v[96:99], v[64:79]
  ds_read_b128 v[112:115], v6 offset:22528
  v_mfma_f32_32x32x16_bf16 v[64:79], v[188:191], v[100:103], v[64:79]
  ds_read_b128 v[116:119], v6 offset:23552
  s_waitcnt lgkmcnt(2)
  v_mfma_f32_32x32x16_bf16 v[64:79], v[192:195], v[104:107], v[64:79]
  ds_read_b128 v[96:99], v6 offset:24576
  v_mfma_f32_32x32x16_bf16 v[64:79], v[196:199], v[108:111], v[64:79]
  ds_read_b128 v[100:103], v6 offset:25600
  s_waitcnt lgkmcnt(2)
  v_mfma_f32_32x32x16_bf16 v[64:79], v[200:203], v[112:115], v[64:79]
  ds_read_b128 v[104:107], v6 offset:26624
  v_mfma_f32_32x32x16_bf16 v[64:79], v[204:207], v[116:119], v[64:79]
  ds_read_b128 v[108:111], v6 offset:27648
  s_waitcnt lgkmcnt(2)
  v_mfma_f32_32x32x16_bf16 v[64:79], v[208:211], v[96:99], v[64:79]
  v_mfma_f32_32x32x16_bf16 v[64:79], v[212:215], v[100:103], v[64:79]
  s_waitcnt lgkmcnt(0)
  v_mfma_f32_32x32x16_bf16 v[64:79], v[216:219], v[104:107], v[64:79]
  v_mfma_f32_32x32x16_bf16 v[64:79], v[220:223], v[108:111], v[64:79]
  v_mfma_f32_32x32x16_bf16 v[64:79], v[224:227], v[24:27], v[64:79]
  s_cmp_eq_u32 s26, 14
  s_cbranch_scc1 q1_k
  s_lshl_b32 s27, s24, 15
  s_add_u32 s27, s27, 5869568
  s_lshl_b32 s32, s26, 3
  v_add_u32 v5, s32, v4
  s_mov_b32 s33, 9363
  s_mov_b32 s32, 0x3e8b97f6
  v_mul_f32 v31, s32, v31
  v_add_u32 v6, 0, v5
  v_mul_u32_u24 v7, s33, v6
  v_lshrrev_b32 v7, 16, v7
  v_mul_u32_u24 v11, 7, v7
  v_sub_u32 v6, v6, v11
  v_lshlrev_b32 v7, 11, v7
  v_lshrrev_b32 v11, 2, v6
  v_lshl_add_u32 v7, v11, 10, v7
  v_and_b32 v11, 1, v6
  v_lshl_add_u32 v7, v11, 9, v7
  v_bfe_u32 v11, v6, 1, 1
  v_lshl_add_u32 v7, v11, 3, v7
  v_lshl_add_u32 v16, v3, 4, v7
  v_add_u32 v6, 2, v5
  v_mul_u32_u24 v7, s33, v6
  v_lshrrev_b32 v7, 16, v7
  v_mul_u32_u24 v11, 7, v7
  v_sub_u32 v6, v6, v11
  v_lshlrev_b32 v7, 11, v7
  v_lshrrev_b32 v11, 2, v6
  v_lshl_add_u32 v7, v11, 10, v7
  v_and_b32 v11, 1, v6
  v_lshl_add_u32 v7, v11, 9, v7
  v_bfe_u32 v11, v6, 1, 1
  v_lshl_add_u32 v7, v11, 3, v7
  v_lshl_add_u32 v17, v3, 4, v7
  v_add_u32 v6, 4, v5
  v_mul_u32_u24 v7, s33, v6
  v_lshrrev_b32 v7, 16, v7
  v_mul_u32_u24 v11, 7, v7
  v_sub_u32 v6, v6, v11
  v_lshlrev_b32 v7, 11, v7
  v_lshrrev_b32 v11, 2, v6
  v_lshl_add_u32 v7, v11, 10, v7
  v_and_b32 v11, 1, v6
  v_lshl_add_u32 v7, v11, 9, v7
  v_bfe_u32 v11, v6, 1, 1
  v_lshl_add_u32 v7, v11, 3, v7
  v_lshl_add_u32 v18, v3, 4, v7
  v_add_u32 v6, 6, v5
  v_mul_u32_u24 v7, s33, v6
  v_lshrrev_b32 v7, 16, v7
  v_mul_u32_u24 v11, 7, v7
  v_sub_u32 v6, v6, v11
  v_lshlrev_b32 v7, 11, v7
  v_lshrrev_b32 v11, 2, v6
  v_lshl_add_u32 v7, v11, 10, v7
  v_and_b32 v11, 1, v6
  v_lshl_add_u32 v7, v11, 9, v7
  v_bfe_u32 v11, v6, 1, 1
  v_lshl_add_u32 v7, v11, 3, v7
  v_lshl_add_u32 v19, v3, 4, v7
  v_mul_f32 v64, v31, v64
  v_mul_f32 v65, v31, v65
  v_mul_f32 v66, v31, v66
  v_mul_f32 v67, v31, v67
  v_cvt_pk_bf16_f32 v32, v64, v65
  v_cvt_pk_bf16_f32 v33, v66, v67
  v_mul_f32 v68, v31, v68
  v_mul_f32 v69, v31, v69
  v_mul_f32 v70, v31, v70
  v_mul_f32 v71, v31, v71
  v_cvt_pk_bf16_f32 v34, v68, v69
  v_cvt_pk_bf16_f32 v35, v70, v71
  v_mul_f32 v72, v31, v72
  v_mul_f32 v73, v31, v73
  v_mul_f32 v74, v31, v74
  v_mul_f32 v75, v31, v75
  v_cvt_pk_bf16_f32 v36, v72, v73
  v_cvt_pk_bf16_f32 v37, v74, v75
  v_mul_f32 v76, v31, v76
  v_mul_f32 v77, v31, v77
  v_mul_f32 v78, v31, v78
  v_mul_f32 v79, v31, v79
  v_cvt_pk_bf16_f32 v38, v76, v77
  v_cvt_pk_bf16_f32 v39, v78, v79
  s_cmp_eq_u32 s61, 0
  s_cbranch_scc1 S31
  buffer_store_dwordx2 v[32:33], v16, s[16:19], s27 offen
  buffer_store_dwordx2 v[34:35], v17, s[16:19], s27 offen
  buffer_store_dwordx2 v[36:37], v18, s[16:19], s27 offen
  buffer_store_dwordx2 v[38:39], v19, s[16:19], s27 offen
S31b:
  v_dot2_f32_bf16 v12, v32, v32, 0
  v_dot2_f32_bf16 v12, v33, v33, v12
  v_dot2_f32_bf16 v12, v34, v34, v12
  v_dot2_f32_bf16 v12, v35, v35, v12
  v_dot2_f32_bf16 v12, v36, v36, v12
  v_dot2_f32_bf16 v12, v37, v37, v12
  v_dot2_f32_bf16 v12, v38, v38, v12
  v_dot2_f32_bf16 v12, v39, v39, v12
  s_nop 2
  v_mov_b32 v13, v12
  s_nop 1
  v_permlane32_swap_b32 v12, v13
  s_nop 1
  v_add_f32 v12, v12, v13
  s_nop 1
  v_max_f32_dpp v12, v12, v12 row_shr:1 row_mask:0xf bank_mask:0xf
  s_nop 1
  v_max_f32_dpp v12, v12, v12 row_shr:2 row_mask:0xf bank_mask:0xf
  s_nop 1
  v_max_f32_dpp v12, v12, v12 row_shr:4 row_mask:0xf bank_mask:0xf
  s_nop 1
  v_max_f32_dpp v12, v12, v12 row_shr:8 row_mask:0xf bank_mask:0xf
  s_nop 1
  v_readlane_b32 s36, v12, 15
  v_readlane_b32 s37, v12, 31
  s_nop 3
  s_max_u32 s36, s36, s37
  s_add_u32 s38, s9, 21569536
  s_add_u32 s38, s38, s15
  v_mov_b32 v10, s14
  v_mov_b32 v11, s36
  v_mov_b32 v1, 0
  s_waitcnt vmcnt(0)
  s_mov_b64 exec, 1
  s_cmp_eq_u32 s61, 0
  s_cbranch_scc1 S32
  buffer_store_dwordx2 v[10:11], v1, s[16:19], s38 offen
S32b:
  s_mov_b64 exec, -1
  s_branch q1_fin
q1_k:
  s_lshl_b32 s27, s24, 12
  s_add_u32 s27, s27, 23732224
  v_mov_b32 v13, 0x3f803f80
  v_mov_b32 v14, 0x3f80
  s_nop 7
  v_mul_f32 v64, v31, v64
  v_mul_f32 v65, v31, v65
  v_mul_f32 v66, v31, v66
  v_mul_f32 v67, v31, v67
  v_mul_f32 v68, v31, v68
  v_mul_f32 v69, v31, v69
  v_mul_f32 v70, v31, v70
  v_mul_f32 v71, v31, v71
  v_mul_f32 v72, v31, v72
  v_mul_f32 v73, v31, v73
  v_mul_f32 v74, v31, v74
  v_mul_f32 v75, v31, v75
  v_mul_f32 v76, v31, v76
  v_mul_f32 v77, v31, v77
  v_mul_f32 v78, v31, v78
  v_mul_f32 v79, v31, v79
  v_cvt_pk_bf16_f32 v32, v64, v65
  v_cvt_pk_bf16_f32 v33, v66, v67
  v_cvt_pk_bf16_f32 v34, v68, v69
  v_cvt_pk_bf16_f32 v35, v70, v71
  v_cvt_pk_bf16_f32 v36, v72, v73
  v_cvt_pk_bf16_f32 v37, v74, v75
  v_cvt_pk_bf16_f32 v38, v76, v77
  v_cvt_pk_bf16_f32 v39, v78, v79
  v_cndmask_b32 v42, v38, v13, s[62:63]
  v_cndmask_b32 v43, v39, v14, s[62:63]
  v_mov_b32 v40, v36
  v_mov_b32 v41, v37
  buffer_store_dwordx4 v[32:35], v9, s[16:19], s27 offen sc1
  buffer_store_dwordx4 v[40:43], v9, s[16:19], s27 offen offset:1024 sc1
  v_cndmask_b32 v38, v38, 0, s[62:63]
  v_cndmask_b32 v39, v39, 0, s[62:63]
  v_dot2_f32_bf16 v12, v32, v32, 0
  v_dot2_f32_bf16 v12, v33, v33, v12
  v_dot2_f32_bf16 v12, v34, v34, v12
  v_dot2_f32_bf16 v12, v35, v35, v12
  v_dot2_f32_bf16 v12, v36, v36, v12
  v_dot2_f32_bf16 v12, v37, v37, v12
  v_dot2_f32_bf16 v12, v38, v38, v12
  v_dot2_f32_bf16 v12, v39, v39, v12
  s_nop 2
  v_mov_b32 v13, v12
  s_nop 1
  v_permlane32_swap_b32 v12, v13
  s_nop 1
  v_add_f32 v12, v12, v13
  s_nop 1
  v_max_f32_dpp v12, v12, v12 row_shr:1 row_mask:0xf bank_mask:0xf
  s_nop 1
  v_max_f32_dpp v12, v12, v12 row_shr:2 row_mask:0xf bank_mask:0xf
  s_nop 1
  v_max_f32_dpp v12, v12, v12 row_shr:4 row_mask:0xf bank_mask:0xf
  s_nop 1
  v_max_f32_dpp v12, v12, v12 row_shr:8 row_mask:0xf bank_mask:0xf
  s_nop 1
  v_readlane_b32 s36, v12, 15
  v_readlane_b32 s37, v12, 31
  s_nop 3
  s_max_u32 s36, s36, s37
  s_branch q1_end
q1_v:
  ds_read_b128 v[96:99], v6 offset:0
  ds_read_b128 v[100:103], v6 offset:1024
  ds_read_b128 v[104:107], v6 offset:2048
  ds_read_b128 v[108:111], v6 offset:3072
  s_waitcnt lgkmcnt(2)
  v_mfma_f32_32x32x16_bf16 v[64:79], v[96:99], a[64:67], 0
  ds_read_b128 v[112:115], v6 offset:4096
  v_mfma_f32_32x32x16_bf16 v[64:79], v[100:103], a[68:71], v[64:79]
  ds_read_b128 v[116:119], v6 offset:5120
  s_waitcnt lgkmcnt(2)
  v_mfma_f32_32x32x16_bf16 v[64:79], v[104:107], a[72:75], v[64:79]
  ds_read_b128 v[96:99], v6 offset:6144
  v_mfma_f32_32x32x16_bf16 v[64:79], v[108:111], a[76:79], v[64:79]
  ds_read_b128 v[100:103], v6 offset:7168
  s_waitcnt lgkmcnt(2)
  v_mfma_f32_32x32x16_bf16 v[64:79], v[112:115], a[80:83], v[64:79]
  ds_read_b128 v[104:107], v6 offset:8192
  v_mfma_f32_32x32x16_bf16 v[64:79], v[116:119], a[84:87], v[64:79]
  ds_read_b128 v[108:111], v6 offset:9216
  s_waitcnt lgkmcnt(2)
  v_mfma_f32_32x32x16_bf16 v[64:79], v[96:99], a[88:91], v[64:79]
  ds_read_b128 v[112:115], v6 offset:10240
  v_mfma_f32_32x32x16_bf16 v[64:79], v[100:103], a[92:95], v[64:79]
  ds_read_b128 v[116:119], v6 offset:11264
  s_waitcnt lgkmcnt(2)
  v_mfma_f32_32x32x16_bf16 v[64:79], v[104:107], a[96:99], v[64:79]
  ds_read_b128 v[96:99], v6 offset:12288
  s_waitcnt vmcnt(0)
  v_add_f32 v32, v32, v34
  v_add_f32 v33, v33, v35
  v_add_f32 v32, v32, v36
  v_add_f32 v33, v33, v37
  v_mfma_f32_32x32x16_bf16 v[64:79], v[108:111], a[100:103], v[64:79]
  ds_read_b128 v[100:103], v6 offset:13312
  v_add_f32 v32, v32, v38
  v_add_f32 v33, v33, v39
  v_add_f32 v32, v32, v40
  v_add_f32 v33, v33, v41
  s_waitcnt lgkmcnt(2)
  v_mfma_f32_32x32x16_bf16 v[64:79], v[112:115], a[104:107], v[64:79]
  ds_read_b128 v[104:107], v6 offset:14336
  v_add_f32 v32, v32, v42
  v_add_f32 v33, v33, v43
  v_add_f32 v32, v32, v44
  v_add_f32 v33, v33, v45
  v_mfma_f32_32x32x16_bf16 v[64:79], v[116:119], a[108:111], v[64:79]
  ds_read_b128 v[108:111], v6 offset:15360
  v_mov_b32 v34, v32
  v_mov_b32 v35, v33
  s_nop 1
  v_permlane32_swap_b32 v32, v34
  s_waitcnt lgkmcnt(2)
  v_mfma_f32_32x32x16_bf16 v[64:79], v[96:99], v[160:163], v[64:79]
  ds_read_b128 v[112:115], v6 offset:16384
  v_permlane32_swap_b32 v33, v35
  s_nop 1
  v_add_f32 v32, v32, v34
  v_add_f32 v33, v33, v35
  v_mfma_f32_32x32x16_bf16 v[64:79], v[100:103], v[164:167], v[64:79]
  ds_read_b128 v[116:119], v6 offset:17408
  v_mul_f32 v32, 0xbb124925, v32
  v_mul_f32 v33, 0x3b124925, v33
  v_fma_f32 v33, -v32, v32, v33
  v_max_f32 v33, 0, v33
  s_waitcnt lgkmcnt(2)
  v_mfma_f32_32x32x16_bf16 v[64:79], v[104:107], v[168:171], v[64:79]
  ds_read_b128 v[96:99], v6 offset:18432
  v_add_f32 v33, 0x3727c5ac, v33
  v_cvt_pk_bf16_f32 v24, v32, v32
  v_rsq_f32 v31, v33
  v_and_b32 v34, 0xffff0000, v24
  v_mfma_f32_32x32x16_bf16 v[64:79], v[108:111], v[172:175], v[64:79]
  ds_read_b128 v[100:103], v6 offset:19456
  v_sub_f32 v34, v32, v34
  v_cvt_pk_bf16_f32 v25, v34, 0
  v_mov_b32 v26, v24
  v_mov_b32 v27, v25
  s_waitcnt lgkmcnt(2)
  v_mfma_f32_32x32x16_bf16 v[64:79], v[112:115], v[176:179], v[64:79]
  ds_read_b128 v[104:107], v6 offset:20480
  v_mfma_f32_32x32x16_bf16 v[64:79], v[116:119], v[180:183], v[64:79]
  ds_read_b128 v[108:111], v6 offset:21504
  s_waitcnt lgkmcnt(2)
  v_mfma_f32_32x32x16_bf16 v[64:79], v[96:99], v[184:187], v[64:79]
  ds_read_b128 v[112:115], v6 offset:22528
  v_mfma_f32_32x32x16_bf16 v[64:79], v[100:103], v[188:191], v[64:79]
  ds_read_b128 v[116:119], v6 offset:23552
  s_waitcnt lgkmcnt(2)
  v_mfma_f32_32x32x16_bf16 v[64:79], v[104:107], v[192:195], v[64:79]
  ds_read_b128 v[96:99], v6 offset:24576
  v_mfma_f32_32x32x16_bf16 v[64:79], v[108:111], v[196:199], v[64:79]
  ds_read_b128 v[100:103], v6 offset:25600
  s_waitcnt lgkmcnt(2)
  v_mfma_f32_32x32x16_bf16 v[64:79], v[112:115], v[200:203], v[64:79]
  ds_read_b128 v[104:107], v6 offset:26624
  v_mfma_f32_32x32x16_bf16 v[64:79], v[116:119], v[204:207], v[64:79]
  ds_read_b128 v[108:111], v6 offset:27648
  s_waitcnt lgkmcnt(2)
  v_mfma_f32_32x32x16_bf16 v[64:79], v[96:99], v[208:211], v[64:79]
  v_mfma_f32_32x32x16_bf16 v[64:79], v[100:103], v[212:215], v[64:79]
  s_waitcnt lgkmcnt(0)
  v_mfma_f32_32x32x16_bf16 v[64:79], v[104:107], v[216:219], v[64:79]
  v_mfma_f32_32x32x16_bf16 v[64:79], v[108:111], v[220:223], v[64:79]
  v_mfma_f32_32x32x16_bf16 v[64:79], v[24:27], v[224:227], v[64:79]
  ds_write_b32 v7, v31
  s_waitcnt lgkmcnt(0)
  ds_read_b128 v[80:83], v8 offset:0
  ds_read_b128 v[84:87], v8 offset:32
  ds_read_b128 v[88:91], v8 offset:64
  ds_read_b128 v[92:95], v8 offset:96
  s_lshl_b32 s27, s24, 12
  s_add_u32 s27, s27, 23732224
  v_cmp_eq_u32 vcc, 28, v3
  v_mov_b32 v13, 0x3f803f80
  s_mov_b32 s36, 0
  v_cndmask_b32 v13, 0, v13, vcc
  v_cmp_lt_u32 vcc, 27, v3
  s_nop 7
  s_waitcnt lgkmcnt(0)
  v_mul_f32 v64, v80, v64
  v_mul_f32 v65, v81, v65
  v_mul_f32 v66, v82, v66
  v_mul_f32 v67, v83, v67
  v_mul_f32 v68, v84, v68
  v_mul_f32 v69, v85, v69
  v_mul_f32 v70, v86, v70
  v_mul_f32 v71, v87, v71
  v_mul_f32 v72, v88, v72
  v_mul_f32 v73, v89, v73
  v_mul_f32 v74, v90, v74
  v_mul_f32 v75, v91, v75
  v_mul_f32 v76, v92, v76
  v_mul_f32 v77, v93, v77
  v_mul_f32 v78, v94, v78
  v_mul_f32 v79, v95, v79
  v_cvt_pk_bf16_f32 v32, v64, v65
  v_cvt_pk_bf16_f32 v33, v66, v67
  v_cvt_pk_bf16_f32 v34, v68, v69
  v_cvt_pk_bf16_f32 v35, v70, v71
  v_cvt_pk_bf16_f32 v36, v72, v73
  v_cvt_pk_bf16_f32 v37, v74, v75
  v_cvt_pk_bf16_f32 v38, v76, v77
  v_cvt_pk_bf16_f32 v39, v78, v79
  v_cndmask_b32 v32, v32, v13, vcc
  v_cndmask_b32 v33, v33, v13, vcc
  v_cndmask_b32 v34, v34, v13, vcc
  v_cndmask_b32 v35, v35, v13, vcc
  v_cndmask_b32 v36, v36, v13, vcc
  v_cndmask_b32 v37, v37, v13, vcc
  v_cndmask_b32 v38, v38, v13, vcc
  v_cndmask_b32 v39, v39, v13, vcc
  buffer_store_dwordx4 v[32:35], v9, s[16:19], s27 offen offset:2048 sc1
  buffer_store_dwordx4 v[36:39], v9, s[16:19], s27 offen offset:3072 sc1
q1_end:
  s_and_b32 s35, s3, 1
  s_lshl_b32 s37, s24, 4
  s_add_u32 s35, s35, s37
  s_lshl_b32 s35, s35, 3
  s_add_u32 s38, s35, 21618688
  s_add_u32 s38, s38, s15
  v_mov_b32 v10, s14
  v_mov_b32 v11, s36
  v_mov_b32 v1, 0
  s_waitcnt vmcnt(0)
  s_mov_b64 exec, 1
  buffer_store_dwordx2 v[10:11], v1, s[16:19], s38 offen sc1
  s_mov_b64 exec, -1
q1_fin:
  s_barrier
  s_lshr_b32 s11, s2, 3
  s_mul_i32 s26, s11, 9363
  s_lshr_b32 s26, s26, 16
  s_mul_i32 s27, s26, 7
  s_sub_u32 s25, s11, s27
  s_min_u32 s26, s26, 3
  s_and_b32 s24, s2, 7
  s_lshl_b32 s24, s24, 2
  s_add_u32 s24, s24, s26
  s_lshr_b32 s26, s3, 1
  s_and_b32 s27, s3, 1
  s_lshl_b32 s24, s24, 1
  s_lshl_b32 s25, s25, 1
  s_add_u32 s24, s24, s26
  s_add_u32 s25, s25, s27
  s_xor_b32 s26, s24, 1
  s_xor_b32 s27, s25, 1
  s_lshl_b32 s36, s3, 3
  s_lshl_b32 s96, s25, 5
  s_lshl_b32 s97, s27, 5
  s_add_u32 s96, s96, s36
  s_add_u32 s97, s97, s36
  s_lshl_b32 s96, s96, 10
  s_lshl_b32 s97, s97, 10
  s_add_u32 s96, s96, 4931584
  s_add_u32 s97, s97, 4931584
  s_mul_i32 s36, s3, 28
  s_mul_i32 s98, s25, 112
  s_mul_i32 s99, s27, 112
  s_add_u32 s98, s98, s36
  s_add_u32 s99, s99, s36
  s_lshl_b32 s98, s98, 10
  s_lshl_b32 s99, s99, 10
  s_add_u32 s98, s98, 3325952
  s_add_u32 s99, s99, 3325952
  s_and_b32 s100, s11, 15
  s_mul_i32 s100, s100, 200704
  s_mul_i32 s101, s3, 7168
  s_add_u32 s100, s100, s101
  s_add_u32 s100, s100, 0
  s_mul_i32 s4, s24, 28
  s_lshl_b32 s36, s25, 1
  s_add_u32 s4, s4, s36
  s_lshl_b32 s4, s4, 10
  s_add_u32 s4, s4, 0
  s_add_u32 s4, s4, 10330112
  s_mul_i32 s6, s24, 14
  s_add_u32 s6, s6, s25
  s_lshl_b32 s6, s6, 8
  s_add_u32 s6, s6, 0
  s_add_u32 s6, s6, 14000128
  s_and_b32 s7, s2, 7
  s_lshl_b32 s7, s7, 1
  s_lshr_b32 s36, s11, 4
  s_add_u32 s7, s7, s36
  s_lshl_b32 s7, s7, 2
  s_add_u32 s7, s7, s3
  s_mul_i32 s7, s7, 112
  s_and_b32 s36, s11, 15
  s_mul_i32 s36, s36, 7
  s_add_u32 s7, s7, s36
  s_lshl_b32 s7, s7, 10
  s_add_u32 s7, s7, 0
  s_add_u32 s7, s7, 14229504
  v_lshrrev_b32 v6, 2, v2
  v_lshlrev_b32 v6, 7, v6
  v_lshrrev_b32 v7, 3, v2
  v_lshlrev_b32 v7, 13, v7
  v_add_u32 v7, s9, v7
  s_and_b32 s5, s11, 15
  s_mul_i32 s5, s5, 7168
  s_add_u32 s5, s5, 3211264
  s_and_b32 s24, s2, 7
  s_lshr_b32 s25, s2, 5
  s_lshl_b32 s24, s24, 3
  s_add_u32 s24, s24, s25
  s_bfe_u32 s26, s2, 0x20003
  s_lshl_b32 s8, s24, 2
  s_add_u32 s8, s8, s26
  s_lshl_b32 s8, s8, 2
  s_add_u32 s8, s8, s3
  s_lshl_b32 s8, s8, 11
  s_add_u32 s8, s8, 0
  s_add_u32 s8, s8, 5869568
  s_lshl_b32 s27, s3, 16
  s_add_u32 s27, s27, s15
  s_add_u32 s27, s27, 7966720
  s_add_u32 s20, s12, s27
  s_addc_u32 s21, s13, 0
  s_mov_b32 s22, 65536
  s_mov_b32 s23, 0x20000
  v_and_b32 v10, 15, v2
  s_lshl_b32 s36, s3, 4
  v_add_u32 v10, s36, v10
  v_lshlrev_b32 v10, 7, v10
  v_bfe_u32 v12, v2, 4, 1
  v_lshl_add_u32 v10, v12, 3, v10
  v_add_u32 v10, 49152, v10
  s_mul_i32 s36, s26, 7
  s_lshr_b32 s36, s36, 1
  v_and_b32 v11, 3, v2
  v_add_u32 v11, s36, v11
  s_lshl_b32 s36, s24, 7
  v_lshl_add_u32 v11, v11, 3, s36
  v_lshlrev_b32 v8, 2, v2
  s_lshl_b32 s27, s24, 15
  v_cndmask_b32 v13, v10, v11, s[62:63]
  s_lshl_b32 s36, s3, 2
  s_add_u32 s36, s36, 122880
  v_mov_b32 v12, s36
  v_mov_b32 v5, 122880
  s_add_u32 s27, s27, 0
  s_add_u32 s27, s27, 5869568
  v_mov_b32 v168, 0
  v_mov_b32 v169, 0
  v_mov_b32 v170, 0
  v_mov_b32 v171, 0
  v_mov_b32 v172, 0
  v_mov_b32 v173, 0
  v_mov_b32 v174, 0
  v_mov_b32 v175, 0
  v_mov_b32 v176, 0
  v_mov_b32 v177, 0
  v_mov_b32 v178, 0
  v_mov_b32 v179, 0
  v_mov_b32 v180, 0
  v_mov_b32 v181, 0
  v_mov_b32 v182, 0
  v_mov_b32 v183, 0
  v_mov_b32 v184, 0
  v_mov_b32 v185, 0
  v_mov_b32 v186, 0
  v_mov_b32 v187, 0
  v_mov_b32 v188, 0
  v_mov_b32 v189, 0
  v_mov_b32 v190, 0
  v_mov_b32 v191, 0
  v_mov_b32 v192, 0
  v_mov_b32 v193, 0
  v_mov_b32 v194, 0
  v_mov_b32 v195, 0
  v_mov_b32 v196, 0
  v_mov_b32 v197, 0
  v_mov_b32 v198, 0
  v_mov_b32 v199, 0
  v_mov_b32 v200, 0
  v_mov_b32 v201, 0
  v_mov_b32 v202, 0
  v_mov_b32 v203, 0
  v_mov_b32 v204, 0
  v_mov_b32 v205, 0
  v_mov_b32 v206, 0
  v_mov_b32 v207, 0
  v_mov_b32 v208, 0
  v_mov_b32 v209, 0
  v_mov_b32 v210, 0
  v_mov_b32 v211, 0
  v_mov_b32 v212, 0
  v_mov_b32 v213, 0
  v_mov_b32 v214, 0
  v_mov_b32 v215, 0
  v_mov_b32 v216, 0
  v_mov_b32 v217, 0
  v_mov_b32 v218, 0
  v_mov_b32 v219, 0
  v_mov_b32 v220, 0
  v_mov_b32 v221, 0
  v_mov_b32 v222, 0
  v_mov_b32 v223, 0
  v_mov_b32 v224, 0
  v_mov_b32 v225, 0
  v_mov_b32 v226, 0
  v_mov_b32 v227, 0
  v_mov_b32 v228, 0
  v_mov_b32 v229, 0
  v_mov_b32 v230, 0
  v_mov_b32 v231, 0
  v_mov_b32 v108, 0
  v_mov_b32 v156, 0
  v_mov_b32 v109, 0
  v_mov_b32 v157, 0
  v_mov_b32 v110, 0
  v_mov_b32 v158, 0
  v_mov_b32 v111, 0
  v_mov_b32 v159, 0
  v_mov_b32 v164, 0
  v_mov_b32 v165, 0
  s_mov_b32 s39, 200000
W33:
  s_add_u32 s38, s15, 21569536
  buffer_load_dwordx2 v[14:15], v13, s[16:19], s38 offen sc1
  s_waitcnt vmcnt(0)
  v_cmp_ne_u32 vcc, s14, v14
  s_nop 1
  s_cmp_eq_u64 vcc, 0
  s_cbranch_scc1 Wd34
  s_sub_u32 s39, s39, 1
  s_cmp_lg_u32 s39, 0
  s_cbranch_scc1 W33
Wd34:
  s_mov_b32 s30, 0
  s_add_u32 s28, s3, 1
  s_and_b32 s28, s28, 3
  s_lshl_b32 s29, s26, 2
  s_add_u32 s28, s28, s29
  s_lshl_b32 s28, s28, 11
  s_add_u32 s28, s28, s27
  buffer_load_dwordx4 v[16:19], v9, s[16:19], s28 offen offset:0 sc1
  buffer_load_dwordx4 v[20:23], v9, s[16:19], s28 offen offset:1024 sc1
  buffer_load_dwordx4 v[48:51], v9, s[20:23], s30 offen offset:0 sc1
  buffer_load_dwordx4 v[52:55], v9, s[20:23], s30 offen offset:1024 sc1
  s_add_u32 s28, s3, 2
  s_and_b32 s28, s28, 3
  s_lshl_b32 s29, s26, 2
  s_add_u32 s28, s28, s29
  s_lshl_b32 s28, s28, 11
  s_add_u32 s28, s28, s27
  buffer_load_dwordx4 v[24:27], v9, s[16:19], s28 offen offset:0 sc1
  buffer_load_dwordx4 v[28:31], v9, s[16:19], s28 offen offset:1024 sc1
  buffer_load_dwordx4 v[56:59], v9, s[20:23], s30 offen offset:2048 sc1
  buffer_load_dwordx4 v[60:63], v9, s[20:23], s30 offen offset:3072 sc1
  s_add_u32 s30, s30, 4096
  s_add_u32 s28, s3, 3
  s_and_b32 s28, s28, 3
  s_lshl_b32 s29, s26, 2
  s_add_u32 s28, s28, s29
  s_lshl_b32 s28, s28, 11
  s_add_u32 s28, s28, s27
  buffer_load_dwordx4 v[32:35], v9, s[16:19], s28 offen offset:0 sc1
  buffer_load_dwordx4 v[36:39], v9, s[16:19], s28 offen offset:1024 sc1
  s_add_u32 s28, s3, 4
  s_and_b32 s28, s28, 3
  s_lshl_b32 s29, s26, 2
  s_add_u32 s28, s28, s29
  s_lshl_b32 s28, s28, 11
  s_add_u32 s28, s28, s27
  buffer_load_dwordx4 v[40:43], v9, s[16:19], s28 offen offset:0 sc1
  buffer_load_dwordx4 v[44:47], v9, s[16:19], s28 offen offset:1024 sc1
  buffer_load_dwordx4 v[64:67], v9, s[20:23], s30 offen offset:0 sc1
  buffer_load_dwordx4 v[68:71], v9, s[20:23], s30 offen offset:1024 sc1
  buffer_load_dwordx4 v[72:75], v9, s[20:23], s30 offen offset:2048 sc1
  buffer_load_dwordx4 v[76:79], v9, s[20:23], s30 offen offset:3072 sc1
  s_add_u32 s30, s30, 4096
  buffer_load_dwordx4 v[80:83], v9, s[20:23], s30 offen offset:0 sc1
  buffer_load_dwordx4 v[84:87], v9, s[20:23], s30 offen offset:1024 sc1
  buffer_load_dwordx4 v[88:91], v9, s[20:23], s30 offen offset:2048 sc1
  buffer_load_dwordx4 v[92:95], v9, s[20:23], s30 offen offset:3072 sc1
  s_add_u32 s30, s30, 4096
  s_nop 1
  v_max_f32_dpp v15, v15, v15 row_shr:1 row_mask:0xf bank_mask:0xf
  s_nop 1
  v_max_f32_dpp v15, v15, v15 row_shr:2 row_mask:0xf bank_mask:0xf
  s_nop 1
  v_max_f32_dpp v15, v15, v15 row_shr:4 row_mask:0xf bank_mask:0xf
  s_nop 1
  v_max_f32_dpp v15, v15, v15 row_shr:8 row_mask:0xf bank_mask:0xf
  s_nop 1
  v_readlane_b32 s34, v15, 15
  v_readlane_b32 s35, v15, 47
  s_nop 1
  v_mov_b32 v10, s34
  ds_write_b32 v12, v10
  s_waitcnt lgkmcnt(0)
  s_barrier
  ds_read_b128 v[112:115], v5
  s_waitcnt lgkmcnt(0)
  v_max3_f32 v10, v112, v113, v114
  v_max_f32 v10, v10, v115
  v_mul_f32 v10, s35, v10
  v_cmp_nge_f32 vcc, 0x44e10000, v10
  s_waitcnt vmcnt(8)
  v_cndmask_b32 v22, v22, 0, s[62:63]
  v_cndmask_b32 v23, v23, 0, s[62:63]
  v_cndmask_b32 v30, v30, 0, s[62:63]
  v_cndmask_b32 v31, v31, 0, s[62:63]
  v_cndmask_b32 v38, v38, 0, s[62:63]
  v_cndmask_b32 v39, v39, 0, s[62:63]
  v_cndmask_b32 v46, v46, 0, s[62:63]
  v_cndmask_b32 v47, v47, 0, s[62:63]
  s_cbranch_vccnz A_fb1
A_go1:
  v_mfma_f32_32x32x16_bf16 v[112:127], v[48:51], v[16:19], 0
  v_mfma_f32_32x32x16_bf16 v[112:127], v[52:55], v[20:23], v[112:127]
  s_mov_b32 s31, 5390336
  s_nop 7
  s_nop 3
  v_mfma_f32_32x32x16_bf16 v[128:143], v[48:51], v[24:27], 0
  v_exp_f32 v144, v112
  v_cvt_pk_bf16_f32 v166, v156, v157
  v_exp_f32 v145, v113
  v_cvt_pk_bf16_f32 v167, v158, v159
  v_exp_f32 v146, v114
  buffer_load_dwordx4 a[0:3], v9, s[16:19], s96 offen offset:0 sc1
  v_exp_f32 v147, v115
  v_mfma_f32_32x32x16_bf16 v[128:143], v[52:55], v[28:31], v[128:143]
  v_exp_f32 v148, v116
  v_cvt_pk_bf16_f32 v160, v144, v145
  v_exp_f32 v149, v117
  v_cvt_pk_bf16_f32 v161, v146, v147
  v_exp_f32 v150, v118
  v_exp_f32 v151, v119
  v_mfma_f32_32x32x16_bf16 v[216:231], v[108:111], v[164:167], v[216:231]
  v_exp_f32 v152, v120
  v_cvt_pk_bf16_f32 v162, v148, v149
  v_exp_f32 v153, v121
  v_cvt_pk_bf16_f32 v163, v150, v151
  v_exp_f32 v154, v122
  v_exp_f32 v155, v123
  v_mfma_f32_32x32x16_bf16 v[168:183], v[56:59], v[160:163], v[168:183]
  v_exp_f32 v156, v124
  v_cvt_pk_bf16_f32 v164, v152, v153
  v_exp_f32 v157, v125
  v_cvt_pk_bf16_f32 v165, v154, v155
  v_exp_f32 v158, v126
  v_exp_f32 v159, v127
  v_mfma_f32_32x32x16_bf16 v[112:127], v[48:51], v[32:35], 0
  v_exp_f32 v144, v128
  v_cvt_pk_bf16_f32 v166, v156, v157
  v_exp_f32 v145, v129
  v_cvt_pk_bf16_f32 v167, v158, v159
  v_exp_f32 v146, v130
  v_exp_f32 v147, v131
  v_mfma_f32_32x32x16_bf16 v[112:127], v[52:55], v[36:39], v[112:127]
  v_exp_f32 v148, v132
  v_cvt_pk_bf16_f32 v160, v144, v145
  v_exp_f32 v149, v133
  v_cvt_pk_bf16_f32 v161, v146, v147
  v_exp_f32 v150, v134
  v_exp_f32 v151, v135
  v_mfma_f32_32x32x16_bf16 v[168:183], v[60:63], v[164:167], v[168:183]
  v_exp_f32 v152, v136
  buffer_load_dwordx4 v[96:99], v9, s[20:23], s30 offen offset:0 sc1
  v_cvt_pk_bf16_f32 v162, v148, v149
  v_exp_f32 v153, v137
  buffer_load_dwordx4 v[100:103], v9, s[20:23], s30 offen offset:1024 sc1
  v_cvt_pk_bf16_f32 v163, v150, v151
  v_exp_f32 v154, v138
  buffer_load_dwordx4 v[104:107], v9, s[20:23], s30 offen offset:2048 sc1
  v_exp_f32 v155, v139
  buffer_load_dwordx4 v[108:111], v9, s[20:23], s30 offen offset:3072 sc1
  s_add_u32 s30, s30, 4096
  v_mfma_f32_32x32x16_bf16 v[184:199], v[56:59], v[160:163], v[184:199]
  v_exp_f32 v156, v140
  v_cvt_pk_bf16_f32 v164, v152, v153
  v_exp_f32 v157, v141
  v_cvt_pk_bf16_f32 v165, v154, v155
  v_exp_f32 v158, v142
  v_exp_f32 v159, v143
  v_mfma_f32_32x32x16_bf16 v[128:143], v[48:51], v[40:43], 0
  v_exp_f32 v144, v112
  v_cvt_pk_bf16_f32 v166, v156, v157
  v_exp_f32 v145, v113
  v_cvt_pk_bf16_f32 v167, v158, v159
  v_exp_f32 v146, v114
  s_add_u32 s35, s15, 21569536
  buffer_load_dword v14, v7, s[16:19], s35 offen offset:0
  v_exp_f32 v147, v115
  v_mfma_f32_32x32x16_bf16 v[128:143], v[52:55], v[44:47], v[128:143]
  v_exp_f32 v148, v116
  v_cvt_pk_bf16_f32 v160, v144, v145
  v_exp_f32 v149, v117
  v_cvt_pk_bf16_f32 v161, v146, v147
  v_exp_f32 v150, v118
  v_exp_f32 v151, v119
  v_mfma_f32_32x32x16_bf16 v[184:199], v[60:63], v[164:167], v[184:199]
  v_exp_f32 v152, v120
  v_cvt_pk_bf16_f32 v162, v148, v149
  v_exp_f32 v153, v121
  v_cvt_pk_bf16_f32 v163, v150, v151
  v_exp_f32 v154, v122
  v_exp_f32 v155, v123
  v_mfma_f32_32x32x16_bf16 v[200:215], v[56:59], v[160:163], v[200:215]
  v_exp_f32 v156, v124
  v_cvt_pk_bf16_f32 v164, v152, v153
  v_exp_f32 v157, v125
  v_cvt_pk_bf16_f32 v165, v154, v155
  v_exp_f32 v158, v126
  buffer_load_dwordx4 a[4:7], v9, s[16:19], s97 offen offset:0 sc1
  v_exp_f32 v159, v127
  s_waitcnt vmcnt(11)
  v_mfma_f32_32x32x16_bf16 v[112:127], v[64:67], v[16:19], 0
  v_exp_f32 v144, v128
  v_cvt_pk_bf16_f32 v166, v156, v157
  v_exp_f32 v145, v129
  v_cvt_pk_bf16_f32 v167, v158, v159
  v_exp_f32 v146, v130
  v_exp_f32 v147, v131
  v_mfma_f32_32x32x16_bf16 v[112:127], v[68:71], v[20:23], v[112:127]
  v_exp_f32 v148, v132
  v_cvt_pk_bf16_f32 v160, v144, v145
  v_exp_f32 v149, v133
  v_cvt_pk_bf16_f32 v161, v146, v147
  v_exp_f32 v150, v134
  v_exp_f32 v151, v135
  v_mfma_f32_32x32x16_bf16 v[200:215], v[60:63], v[164:167], v[200:215]
  v_exp_f32 v152, v136
  v_cvt_pk_bf16_f32 v162, v148, v149
  v_exp_f32 v153, v137
  v_cvt_pk_bf16_f32 v163, v150, v151
  v_exp_f32 v154, v138
  v_exp_f32 v155, v139
  v_mfma_f32_32x32x16_bf16 v[216:231], v[56:59], v[160:163], v[216:231]
  v_exp_f32 v156, v140
  v_cvt_pk_bf16_f32 v164, v152, v153
  v_exp_f32 v157, v141
  v_cvt_pk_bf16_f32 v165, v154, v155
  v_exp_f32 v158, v142
  v_exp_f32 v159, v143
  v_mfma_f32_32x32x16_bf16 v[128:143], v[64:67], v[24:27], 0
  v_exp_f32 v144, v112
  v_cvt_pk_bf16_f32 v166, v156, v157
  v_exp_f32 v145, v113
  v_cvt_pk_bf16_f32 v167, v158, v159
  v_exp_f32 v146, v114
  buffer_load_dwordx4 a[8:11], v9, s[16:19], s96 offen offset:1024 sc1
  v_exp_f32 v147, v115
  v_mfma_f32_32x32x16_bf16 v[128:143], v[68:71], v[28:31], v[128:143]
  v_exp_f32 v148, v116
  v_cvt_pk_bf16_f32 v160, v144, v145
  v_exp_f32 v149, v117
  v_cvt_pk_bf16_f32 v161, v146, v147
  v_exp_f32 v150, v118
  v_exp_f32 v151, v119
  v_mfma_f32_32x32x16_bf16 v[216:231], v[60:63], v[164:167], v[216:231]
  v_exp_f32 v152, v120
  v_cvt_pk_bf16_f32 v162, v148, v149
  v_exp_f32 v153, v121
  v_cvt_pk_bf16_f32 v163, v150, v151
  v_exp_f32 v154, v122
  v_exp_f32 v155, v123
  v_mfma_f32_32x32x16_bf16 v[168:183], v[72:75], v[160:163], v[168:183]
  v_exp_f32 v156, v124
  v_cvt_pk_bf16_f32 v164, v152, v153
  v_exp_f32 v157, v125
  v_cvt_pk_bf16_f32 v165, v154, v155
  v_exp_f32 v158, v126
  v_exp_f32 v159, v127
  v_mfma_f32_32x32x16_bf16 v[112:127], v[64:67], v[32:35], 0
  v_exp_f32 v144, v128
  v_cvt_pk_bf16_f32 v166, v156, v157
  v_exp_f32 v145, v129
  v_cvt_pk_bf16_f32 v167, v158, v159
  v_exp_f32 v146, v130
  v_exp_f32 v147, v131
  v_mfma_f32_32x32x16_bf16 v[112:127], v[68:71], v[36:39], v[112:127]
  v_exp_f32 v148, v132
  v_cvt_pk_bf16_f32 v160, v144, v145
  v_exp_f32 v149, v133
  v_cvt_pk_bf16_f32 v161, v146, v147
  v_exp_f32 v150, v134
  v_exp_f32 v151, v135
  v_mfma_f32_32x32x16_bf16 v[168:183], v[76:79], v[164:167], v[168:183]
  v_exp_f32 v152, v136
  buffer_load_dwordx4 v[48:51], v9, s[20:23], s30 offen offset:0 sc1
  v_cvt_pk_bf16_f32 v162, v148, v149
  v_exp_f32 v153, v137
  buffer_load_dwordx4 v[52:55], v9, s[20:23], s30 offen offset:1024 sc1
  v_cvt_pk_bf16_f32 v163, v150, v151
  v_exp_f32 v154, v138
  buffer_load_dwordx4 v[56:59], v9, s[20:23], s30 offen offset:2048 sc1
  v_exp_f32 v155, v139
  buffer_load_dwordx4 v[60:63], v9, s[20:23], s30 offen offset:3072 sc1
  s_add_u32 s30, s30, 4096
  v_mfma_f32_32x32x16_bf16 v[184:199], v[72:75], v[160:163], v[184:199]
  v_exp_f32 v156, v140
  v_cvt_pk_bf16_f32 v164, v152, v153
  v_exp_f32 v157, v141
  v_cvt_pk_bf16_f32 v165, v154, v155
  v_exp_f32 v158, v142
  v_exp_f32 v159, v143
  v_mfma_f32_32x32x16_bf16 v[128:143], v[64:67], v[40:43], 0
  v_exp_f32 v144, v112
  v_cvt_pk_bf16_f32 v166, v156, v157
  v_exp_f32 v145, v113
  v_cvt_pk_bf16_f32 v167, v158, v159
  v_exp_f32 v146, v114
  buffer_load_dwordx4 a[12:15], v9, s[16:19], s97 offen offset:1024 sc1
  v_exp_f32 v147, v115
  v_mfma_f32_32x32x16_bf16 v[128:143], v[68:71], v[44:47], v[128:143]
  v_exp_f32 v148, v116
  v_cvt_pk_bf16_f32 v160, v144, v145
  v_exp_f32 v149, v117
  v_cvt_pk_bf16_f32 v161, v146, v147
  v_exp_f32 v150, v118
  v_exp_f32 v151, v119
  v_mfma_f32_32x32x16_bf16 v[184:199], v[76:79], v[164:167], v[184:199]
  v_exp_f32 v152, v120
  v_cvt_pk_bf16_f32 v162, v148, v149
  v_exp_f32 v153, v121
  v_cvt_pk_bf16_f32 v163, v150, v151
  v_exp_f32 v154, v122
  v_exp_f32 v155, v123
  v_mfma_f32_32x32x16_bf16 v[200:215], v[72:75], v[160:163], v[200:215]
  v_exp_f32 v156, v124
  v_cvt_pk_bf16_f32 v164, v152, v153
  v_exp_f32 v157, v125
  v_cvt_pk_bf16_f32 v165, v154, v155
  v_exp_f32 v158, v126
  v_exp_f32 v159, v127
  s_waitcnt vmcnt(13)
  v_mfma_f32_32x32x16_bf16 v[112:127], v[80:83], v[16:19], 0
  v_exp_f32 v144, v128
  v_cvt_pk_bf16_f32 v166, v156, v157
  v_exp_f32 v145, v129
  v_cvt_pk_bf16_f32 v167, v158, v159
  v_exp_f32 v146, v130
  v_exp_f32 v147, v131
  v_mfma_f32_32x32x16_bf16 v[112:127], v[84:87], v[20:23], v[112:127]
  v_exp_f32 v148, v132
  v_cvt_pk_bf16_f32 v160, v144, v145
  v_exp_f32 v149, v133
  v_cvt_pk_bf16_f32 v161, v146, v147
  v_exp_f32 v150, v134
  v_exp_f32 v151, v135
  v_mfma_f32_32x32x16_bf16 v[200:215], v[76:79], v[164:167], v[200:215]
  v_exp_f32 v152, v136
  v_cvt_pk_bf16_f32 v162, v148, v149
  v_exp_f32 v153, v137
  v_cvt_pk_bf16_f32 v163, v150, v151
  v_exp_f32 v154, v138
  v_exp_f32 v155, v139
  v_mfma_f32_32x32x16_bf16 v[216:231], v[72:75], v[160:163], v[216:231]
  v_exp_f32 v156, v140
  v_cvt_pk_bf16_f32 v164, v152, v153
  v_exp_f32 v157, v141
  v_cvt_pk_bf16_f32 v165, v154, v155
  v_exp_f32 v158, v142
  v_exp_f32 v159, v143
  v_mfma_f32_32x32x16_bf16 v[128:143], v[80:83], v[24:27], 0
  v_exp_f32 v144, v112
  v_cvt_pk_bf16_f32 v166, v156, v157
  v_exp_f32 v145, v113
  v_cvt_pk_bf16_f32 v167, v158, v159
  v_exp_f32 v146, v114
  buffer_load_dwordx4 a[16:19], v9, s[16:19], s96 offen offset:2048 sc1
  v_exp_f32 v147, v115
  v_mfma_f32_32x32x16_bf16 v[128:143], v[84:87], v[28:31], v[128:143]
  v_exp_f32 v148, v116
  v_cvt_pk_bf16_f32 v160, v144, v145
  v_exp_f32 v149, v117
  v_cvt_pk_bf16_f32 v161, v146, v147
  v_exp_f32 v150, v118
  v_exp_f32 v151, v119
  v_mfma_f32_32x32x16_bf16 v[216:231], v[76:79], v[164:167], v[216:231]
  v_exp_f32 v152, v120
  v_cvt_pk_bf16_f32 v162, v148, v149
  v_exp_f32 v153, v121
  v_cvt_pk_bf16_f32 v163, v150, v151
  v_exp_f32 v154, v122
  v_exp_f32 v155, v123
  v_mfma_f32_32x32x16_bf16 v[168:183], v[88:91], v[160:163], v[168:183]
  v_exp_f32 v156, v124
  v_cvt_pk_bf16_f32 v164, v152, v153
  v_exp_f32 v157, v125
  v_cvt_pk_bf16_f32 v165, v154, v155
  v_exp_f32 v158, v126
  v_exp_f32 v159, v127
  v_mfma_f32_32x32x16_bf16 v[112:127], v[80:83], v[32:35], 0
  v_exp_f32 v144, v128
  v_cvt_pk_bf16_f32 v166, v156, v157
  v_exp_f32 v145, v129
  v_cvt_pk_bf16_f32 v167, v158, v159
  v_exp_f32 v146, v130
  v_exp_f32 v147, v131
  v_mfma_f32_32x32x16_bf16 v[112:127], v[84:87], v[36:39], v[112:127]
  v_exp_f32 v148, v132
  v_cvt_pk_bf16_f32 v160, v144, v145
  v_exp_f32 v149, v133
  v_cvt_pk_bf16_f32 v161, v146, v147
  v_exp_f32 v150, v134
  v_exp_f32 v151, v135
  v_mfma_f32_32x32x16_bf16 v[168:183], v[92:95], v[164:167], v[168:183]
  v_exp_f32 v152, v136
  buffer_load_dwordx4 v[64:67], v9, s[20:23], s30 offen offset:0 sc1
  v_cvt_pk_bf16_f32 v162, v148, v149
  v_exp_f32 v153, v137
  buffer_load_dwordx4 v[68:71], v9, s[20:23], s30 offen offset:1024 sc1
  v_cvt_pk_bf16_f32 v163, v150, v151
  v_exp_f32 v154, v138
  buffer_load_dwordx4 v[72:75], v9, s[20:23], s30 offen offset:2048 sc1
  v_exp_f32 v155, v139
  buffer_load_dwordx4 v[76:79], v9, s[20:23], s30 offen offset:3072 sc1
  s_add_u32 s30, s30, 4096
  v_mfma_f32_32x32x16_bf16 v[184:199], v[88:91], v[160:163], v[184:199]
  v_exp_f32 v156, v140
  v_cvt_pk_bf16_f32 v164, v152, v153
  v_exp_f32 v157, v141
  v_cvt_pk_bf16_f32 v165, v154, v155
  v_exp_f32 v158, v142
  v_exp_f32 v159, v143
  v_mfma_f32_32x32x16_bf16 v[128:143], v[80:83], v[40:43], 0
  v_exp_f32 v144, v112
  v_cvt_pk_bf16_f32 v166, v156, v157
  v_exp_f32 v145, v113
  v_cvt_pk_bf16_f32 v167, v158, v159
  v_exp_f32 v146, v114
  buffer_load_dwordx4 a[20:23], v9, s[16:19], s97 offen offset:2048 sc1
  v_exp_f32 v147, v115
  v_mfma_f32_32x32x16_bf16 v[128:143], v[84:87], v[44:47], v[128:143]
  v_exp_f32 v148, v116
  v_cvt_pk_bf16_f32 v160, v144, v145
  v_exp_f32 v149, v117
  v_cvt_pk_bf16_f32 v161, v146, v147
  v_exp_f32 v150, v118
  v_exp_f32 v151, v119
  v_mfma_f32_32x32x16_bf16 v[184:199], v[92:95], v[164:167], v[184:199]
  v_exp_f32 v152, v120
  v_cvt_pk_bf16_f32 v162, v148, v149
  v_exp_f32 v153, v121
  v_cvt_pk_bf16_f32 v163, v150, v151
  v_exp_f32 v154, v122
  v_exp_f32 v155, v123
  v_mfma_f32_32x32x16_bf16 v[200:215], v[88:91], v[160:163], v[200:215]
  v_exp_f32 v156, v124
  v_cvt_pk_bf16_f32 v164, v152, v153
  v_exp_f32 v157, v125
  v_cvt_pk_bf16_f32 v165, v154, v155
  v_exp_f32 v158, v126
  v_exp_f32 v159, v127
  s_waitcnt vmcnt(14)
  v_mfma_f32_32x32x16_bf16 v[112:127], v[96:99], v[16:19], 0
  v_exp_f32 v144, v128
  v_cvt_pk_bf16_f32 v166, v156, v157
  v_exp_f32 v145, v129
  v_cvt_pk_bf16_f32 v167, v158, v159
  v_exp_f32 v146, v130
  v_exp_f32 v147, v131
  v_mfma_f32_32x32x16_bf16 v[112:127], v[100:103], v[20:23], v[112:127]
  v_exp_f32 v148, v132
  v_cvt_pk_bf16_f32 v160, v144, v145
  v_exp_f32 v149, v133
  v_cvt_pk_bf16_f32 v161, v146, v147
  v_exp_f32 v150, v134
  v_exp_f32 v151, v135
  v_mfma_f32_32x32x16_bf16 v[200:215], v[92:95], v[164:167], v[200:215]
  v_exp_f32 v152, v136
  v_cvt_pk_bf16_f32 v162, v148, v149
  v_exp_f32 v153, v137
  v_cvt_pk_bf16_f32 v163, v150, v151
  v_exp_f32 v154, v138
  v_exp_f32 v155, v139
  v_mfma_f32_32x32x16_bf16 v[216:231], v[88:91], v[160:163], v[216:231]
  v_exp_f32 v156, v140
  v_cvt_pk_bf16_f32 v164, v152, v153
  v_exp_f32 v157, v141
  v_cvt_pk_bf16_f32 v165, v154, v155
  v_exp_f32 v158, v142
  v_exp_f32 v159, v143
  v_mfma_f32_32x32x16_bf16 v[128:143], v[96:99], v[24:27], 0
  v_exp_f32 v144, v112
  v_cvt_pk_bf16_f32 v166, v156, v157
  v_exp_f32 v145, v113
  v_cvt_pk_bf16_f32 v167, v158, v159
  v_exp_f32 v146, v114
  buffer_load_dwordx4 a[24:27], v9, s[16:19], s96 offen offset:3072 sc1
  v_exp_f32 v147, v115
  v_mfma_f32_32x32x16_bf16 v[128:143], v[100:103], v[28:31], v[128:143]
  v_exp_f32 v148, v116
  v_cvt_pk_bf16_f32 v160, v144, v145
  v_exp_f32 v149, v117
  v_cvt_pk_bf16_f32 v161, v146, v147
  v_exp_f32 v150, v118
  v_exp_f32 v151, v119
  v_mfma_f32_32x32x16_bf16 v[216:231], v[92:95], v[164:167], v[216:231]
  v_exp_f32 v152, v120
  v_cvt_pk_bf16_f32 v162, v148, v149
  v_exp_f32 v153, v121
  v_cvt_pk_bf16_f32 v163, v150, v151
  v_exp_f32 v154, v122
  v_exp_f32 v155, v123
  v_mfma_f32_32x32x16_bf16 v[168:183], v[104:107], v[160:163], v[168:183]
  v_exp_f32 v156, v124
  v_cvt_pk_bf16_f32 v164, v152, v153
  v_exp_f32 v157, v125
  v_cvt_pk_bf16_f32 v165, v154, v155
  v_exp_f32 v158, v126
  v_exp_f32 v159, v127
  v_mfma_f32_32x32x16_bf16 v[112:127], v[96:99], v[32:35], 0
  v_exp_f32 v144, v128
  v_cvt_pk_bf16_f32 v166, v156, v157
  v_exp_f32 v145, v129
  v_cvt_pk_bf16_f32 v167, v158, v159
  v_exp_f32 v146, v130
  v_exp_f32 v147, v131
  v_mfma_f32_32x32x16_bf16 v[112:127], v[100:103], v[36:39], v[112:127]
  v_exp_f32 v148, v132
  v_cvt_pk_bf16_f32 v160, v144, v145
  v_exp_f32 v149, v133
  v_cvt_pk_bf16_f32 v161, v146, v147
  v_exp_f32 v150, v134
  v_exp_f32 v151, v135
  v_mfma_f32_32x32x16_bf16 v[168:183], v[108:111], v[164:167], v[168:183]
  v_exp_f32 v152, v136
  buffer_load_dwordx4 v[80:83], v9, s[20:23], s30 offen offset:0 sc1
  v_cvt_pk_bf16_f32 v162, v148, v149
  v_exp_f32 v153, v137
  buffer_load_dwordx4 v[84:87], v9, s[20:23], s30 offen offset:1024 sc1
  v_cvt_pk_bf16_f32 v163, v150, v151
  v_exp_f32 v154, v138
  buffer_load_dwordx4 v[88:91], v9, s[20:23], s30 offen offset:2048 sc1
  v_exp_f32 v155, v139
  buffer_load_dwordx4 v[92:95], v9, s[20:23], s30 offen offset:3072 sc1
  s_add_u32 s30, s30, 4096
  v_mfma_f32_32x32x16_bf16 v[184:199], v[104:107], v[160:163], v[184:199]
  v_exp_f32 v156, v140
  v_cvt_pk_bf16_f32 v164, v152, v153
  v_exp_f32 v157, v141
  v_cvt_pk_bf16_f32 v165, v154, v155
  v_exp_f32 v158, v142
  v_exp_f32 v159, v143
  v_mfma_f32_32x32x16_bf16 v[128:143], v[96:99], v[40:43], 0
  v_exp_f32 v144, v112
  v_cvt_pk_bf16_f32 v166, v156, v157
  v_exp_f32 v145, v113
  v_cvt_pk_bf16_f32 v167, v158, v159
  v_exp_f32 v146, v114
  buffer_load_dwordx4 a[28:31], v9, s[16:19], s97 offen offset:3072 sc1
  v_exp_f32 v147, v115
  v_mfma_f32_32x32x16_bf16 v[128:143], v[100:103], v[44:47], v[128:143]
  v_exp_f32 v148, v116
  v_cvt_pk_bf16_f32 v160, v144, v145
  v_exp_f32 v149, v117
  v_cvt_pk_bf16_f32 v161, v146, v147
  v_exp_f32 v150, v118
  v_exp_f32 v151, v119
  v_mfma_f32_32x32x16_bf16 v[184:199], v[108:111], v[164:167], v[184:199]
  v_exp_f32 v152, v120
  v_cvt_pk_bf16_f32 v162, v148, v149
  v_exp_f32 v153, v121
  v_cvt_pk_bf16_f32 v163, v150, v151
  v_exp_f32 v154, v122
  v_exp_f32 v155, v123
  v_mfma_f32_32x32x16_bf16 v[200:215], v[104:107], v[160:163], v[200:215]
  v_exp_f32 v156, v124
  v_cvt_pk_bf16_f32 v164, v152, v153
  v_exp_f32 v157, v125
  v_cvt_pk_bf16_f32 v165, v154, v155
  v_exp_f32 v158, v126
  v_exp_f32 v159, v127
  s_waitcnt vmcnt(13)
  v_mfma_f32_32x32x16_bf16 v[112:127], v[48:51], v[16:19], 0
  v_exp_f32 v144, v128
  v_cvt_pk_bf16_f32 v166, v156, v157
  v_exp_f32 v145, v129
  v_cvt_pk_bf16_f32 v167, v158, v159
  v_exp_f32 v146, v130
  v_exp_f32 v147, v131
  v_mfma_f32_32x32x16_bf16 v[112:127], v[52:55], v[20:23], v[112:127]
  v_exp_f32 v148, v132
  v_cvt_pk_bf16_f32 v160, v144, v145
  v_exp_f32 v149, v133
  v_cvt_pk_bf16_f32 v161, v146, v147
  v_exp_f32 v150, v134
  v_exp_f32 v151, v135
  v_mfma_f32_32x32x16_bf16 v[200:215], v[108:111], v[164:167], v[200:215]
  v_exp_f32 v152, v136
  v_cvt_pk_bf16_f32 v162, v148, v149
  v_exp_f32 v153, v137
  v_cvt_pk_bf16_f32 v163, v150, v151
  v_exp_f32 v154, v138
  v_exp_f32 v155, v139
  v_mfma_f32_32x32x16_bf16 v[216:231], v[104:107], v[160:163], v[216:231]
  v_exp_f32 v156, v140
  v_cvt_pk_bf16_f32 v164, v152, v153
  v_exp_f32 v157, v141
  v_cvt_pk_bf16_f32 v165, v154, v155
  v_exp_f32 v158, v142
  v_exp_f32 v159, v143
  v_mfma_f32_32x32x16_bf16 v[128:143], v[48:51], v[24:27], 0
  v_exp_f32 v144, v112
  v_cvt_pk_bf16_f32 v166, v156, v157
  v_exp_f32 v145, v113
  v_cvt_pk_bf16_f32 v167, v158, v159
  v_exp_f32 v146, v114
  s_add_u32 s96, s96, 4096
  buffer_load_dwordx4 a[32:35], v9, s[16:19], s96 offen offset:0 sc1
  v_exp_f32 v147, v115
  v_mfma_f32_32x32x16_bf16 v[128:143], v[52:55], v[28:31], v[128:143]
  v_exp_f32 v148, v116
  v_cvt_pk_bf16_f32 v160, v144, v145
  v_exp_f32 v149, v117
  v_cvt_pk_bf16_f32 v161, v146, v147
  v_exp_f32 v150, v118
  v_exp_f32 v151, v119
  v_mfma_f32_32x32x16_bf16 v[216:231], v[108:111], v[164:167], v[216:231]
  v_exp_f32 v152, v120
  v_cvt_pk_bf16_f32 v162, v148, v149
  v_exp_f32 v153, v121
  v_cvt_pk_bf16_f32 v163, v150, v151
  v_exp_f32 v154, v122
  v_exp_f32 v155, v123
  v_mfma_f32_32x32x16_bf16 v[168:183], v[56:59], v[160:163], v[168:183]
  v_exp_f32 v156, v124
  v_cvt_pk_bf16_f32 v164, v152, v153
  v_exp_f32 v157, v125
  v_cvt_pk_bf16_f32 v165, v154, v155
  v_exp_f32 v158, v126
  v_exp_f32 v159, v127
  v_mfma_f32_32x32x16_bf16 v[112:127], v[48:51], v[32:35], 0
  v_exp_f32 v144, v128
  v_cvt_pk_bf16_f32 v166, v156, v157
  v_exp_f32 v145, v129
  v_cvt_pk_bf16_f32 v167, v158, v159
  v_exp_f32 v146, v130
  v_exp_f32 v147, v131
  v_mfma_f32_32x32x16_bf16 v[112:127], v[52:55], v[36:39], v[112:127]
  v_exp_f32 v148, v132
  v_cvt_pk_bf16_f32 v160, v144, v145
  v_exp_f32 v149, v133
  v_cvt_pk_bf16_f32 v161, v146, v147
  v_exp_f32 v150, v134
  v_exp_f32 v151, v135
  v_mfma_f32_32x32x16_bf16 v[168:183], v[60:63], v[164:167], v[168:183]
  v_exp_f32 v152, v136
  buffer_load_dwordx4 v[96:99], v9, s[20:23], s30 offen offset:0 sc1
  v_cvt_pk_bf16_f32 v162, v148, v149
  v_exp_f32 v153, v137
  buffer_load_dwordx4 v[100:103], v9, s[20:23], s30 offen offset:1024 sc1
  v_cvt_pk_bf16_f32 v163, v150, v151
  v_exp_f32 v154, v138
  buffer_load_dwordx4 v[104:107], v9, s[20:23], s30 offen offset:2048 sc1
  v_exp_f32 v155, v139
  buffer_load_dwordx4 v[108:111], v9, s[20:23], s30 offen offset:3072 sc1
  s_add_u32 s30, s30, 4096
  v_mfma_f32_32x32x16_bf16 v[184:199], v[56:59], v[160:163], v[184:199]
  v_exp_f32 v156, v140
  v_cvt_pk_bf16_f32 v164, v152, v153
  v_exp_f32 v157, v141
  v_cvt_pk_bf16_f32 v165, v154, v155
  v_exp_f32 v158, v142
  v_exp_f32 v159, v143
  v_mfma_f32_32x32x16_bf16 v[128:143], v[48:51], v[40:43], 0
  v_exp_f32 v144, v112
  v_cvt_pk_bf16_f32 v166, v156, v157
  v_exp_f32 v145, v113
  v_cvt_pk_bf16_f32 v167, v158, v159
  v_exp_f32 v146, v114
  s_add_u32 s97, s97, 4096
  buffer_load_dwordx4 a[36:39], v9, s[16:19], s97 offen offset:0 sc1
  v_exp_f32 v147, v115
  v_mfma_f32_32x32x16_bf16 v[128:143], v[52:55], v[44:47], v[128:143]
  v_exp_f32 v148, v116
  v_cvt_pk_bf16_f32 v160, v144, v145
  v_exp_f32 v149, v117
  v_cvt_pk_bf16_f32 v161, v146, v147
  v_exp_f32 v150, v118
  v_exp_f32 v151, v119
  v_mfma_f32_32x32x16_bf16 v[184:199], v[60:63], v[164:167], v[184:199]
  v_exp_f32 v152, v120
  v_cvt_pk_bf16_f32 v162, v148, v149
  v_exp_f32 v153, v121
  v_cvt_pk_bf16_f32 v163, v150, v151
  v_exp_f32 v154, v122
  v_exp_f32 v155, v123
  v_mfma_f32_32x32x16_bf16 v[200:215], v[56:59], v[160:163], v[200:215]
  v_exp_f32 v156, v124
  v_cvt_pk_bf16_f32 v164, v152, v153
  v_exp_f32 v157, v125
  v_cvt_pk_bf16_f32 v165, v154, v155
  v_exp_f32 v158, v126
  v_exp_f32 v159, v127
  s_waitcnt vmcnt(13)
  v_mfma_f32_32x32x16_bf16 v[112:127], v[64:67], v[16:19], 0
  v_exp_f32 v144, v128
  v_cvt_pk_bf16_f32 v166, v156, v157
  v_exp_f32 v145, v129
  v_cvt_pk_bf16_f32 v167, v158, v159
  v_exp_f32 v146, v130
  v_exp_f32 v147, v131
  v_mfma_f32_32x32x16_bf16 v[112:127], v[68:71], v[20:23], v[112:127]
  v_exp_f32 v148, v132
  v_cvt_pk_bf16_f32 v160, v144, v145
  v_exp_f32 v149, v133
  v_cvt_pk_bf16_f32 v161, v146, v147
  v_exp_f32 v150, v134
  v_exp_f32 v151, v135
  v_mfma_f32_32x32x16_bf16 v[200:215], v[60:63], v[164:167], v[200:215]
  v_exp_f32 v152, v136
  v_cvt_pk_bf16_f32 v162, v148, v149
  v_exp_f32 v153, v137
  v_cvt_pk_bf16_f32 v163, v150, v151
  v_exp_f32 v154, v138
  v_exp_f32 v155, v139
  v_mfma_f32_32x32x16_bf16 v[216:231], v[56:59], v[160:163], v[216:231]
  v_exp_f32 v156, v140
  v_cvt_pk_bf16_f32 v164, v152, v153
  v_exp_f32 v157, v141
  v_cvt_pk_bf16_f32 v165, v154, v155
  v_exp_f32 v158, v142
  v_exp_f32 v159, v143
  v_mfma_f32_32x32x16_bf16 v[128:143], v[64:67], v[24:27], 0
  v_exp_f32 v144, v112
  v_cvt_pk_bf16_f32 v166, v156, v157
  v_exp_f32 v145, v113
  v_cvt_pk_bf16_f32 v167, v158, v159
  v_exp_f32 v146, v114
  buffer_load_dwordx4 a[40:43], v9, s[16:19], s96 offen offset:1024 sc1
  v_exp_f32 v147, v115
  v_mfma_f32_32x32x16_bf16 v[128:143], v[68:71], v[28:31], v[128:143]
  v_exp_f32 v148, v116
  v_cvt_pk_bf16_f32 v160, v144, v145
  v_exp_f32 v149, v117
  v_cvt_pk_bf16_f32 v161, v146, v147
  v_exp_f32 v150, v118
  v_exp_f32 v151, v119
  v_mfma_f32_32x32x16_bf16 v[216:231], v[60:63], v[164:167], v[216:231]
  v_exp_f32 v152, v120
  v_cvt_pk_bf16_f32 v162, v148, v149
  v_exp_f32 v153, v121
  v_cvt_pk_bf16_f32 v163, v150, v151
  v_exp_f32 v154, v122
  v_exp_f32 v155, v123
  v_mfma_f32_32x32x16_bf16 v[168:183], v[72:75], v[160:163], v[168:183]
  v_exp_f32 v156, v124
  v_cvt_pk_bf16_f32 v164, v152, v153
  v_exp_f32 v157, v125
  v_cvt_pk_bf16_f32 v165, v154, v155
  v_exp_f32 v158, v126
  v_exp_f32 v159, v127
  v_mfma_f32_32x32x16_bf16 v[112:127], v[64:67], v[32:35], 0
  v_exp_f32 v144, v128
  v_cvt_pk_bf16_f32 v166, v156, v157
  v_exp_f32 v145, v129
  v_cvt_pk_bf16_f32 v167, v158, v159
  v_exp_f32 v146, v130
  v_exp_f32 v147, v131
  v_mfma_f32_32x32x16_bf16 v[112:127], v[68:71], v[36:39], v[112:127]
  v_exp_f32 v148, v132
  v_cvt_pk_bf16_f32 v160, v144, v145
  v_exp_f32 v149, v133
  v_cvt_pk_bf16_f32 v161, v146, v147
  v_exp_f32 v150, v134
  v_exp_f32 v151, v135
  v_mfma_f32_32x32x16_bf16 v[168:183], v[76:79], v[164:167], v[168:183]
  v_exp_f32 v152, v136
  buffer_load_dwordx4 v[48:51], v9, s[20:23], s30 offen offset:0 sc1
  v_cvt_pk_bf16_f32 v162, v148, v149
  v_exp_f32 v153, v137
  buffer_load_dwordx4 v[52:55], v9, s[20:23], s30 offen offset:1024 sc1
  v_cvt_pk_bf16_f32 v163, v150, v151
  v_exp_f32 v154, v138
  buffer_load_dwordx4 v[56:59], v9, s[20:23], s30 offen offset:2048 sc1
  v_exp_f32 v155, v139
  buffer_load_dwordx4 v[60:63], v9, s[20:23], s30 offen offset:3072 sc1
  s_add_u32 s30, s30, 4096
  v_mfma_f32_32x32x16_bf16 v[184:199], v[72:75], v[160:163], v[184:199]
  v_exp_f32 v156, v140
  v_cvt_pk_bf16_f32 v164, v152, v153
  v_exp_f32 v157, v141
  v_cvt_pk_bf16_f32 v165, v154, v155
  v_exp_f32 v158, v142
  v_exp_f32 v159, v143
  v_mfma_f32_32x32x16_bf16 v[128:143], v[64:67], v[40:43], 0
  v_exp_f32 v144, v112
  v_cvt_pk_bf16_f32 v166, v156, v157
  v_exp_f32 v145, v113
  v_cvt_pk_bf16_f32 v167, v158, v159
  v_exp_f32 v146, v114
  buffer_load_dwordx4 a[44:47], v9, s[16:19], s97 offen offset:1024 sc1
  v_exp_f32 v147, v115
  v_mfma_f32_32x32x16_bf16 v[128:143], v[68:71], v[44:47], v[128:143]
  v_exp_f32 v148, v116
  v_cvt_pk_bf16_f32 v160, v144, v145
  v_exp_f32 v149, v117
  v_cvt_pk_bf16_f32 v161, v146, v147
  v_exp_f32 v150, v118
  v_exp_f32 v151, v119
  v_mfma_f32_32x32x16_bf16 v[184:199], v[76:79], v[164:167], v[184:199]
  v_exp_f32 v152, v120
  v_cvt_pk_bf16_f32 v162, v148, v149
  v_exp_f32 v153, v121
  v_cvt_pk_bf16_f32 v163, v150, v151
  v_exp_f32 v154, v122
  v_exp_f32 v155, v123
  v_mfma_f32_32x32x16_bf16 v[200:215], v[72:75], v[160:163], v[200:215]
  v_exp_f32 v156, v124
  v_cvt_pk_bf16_f32 v164, v152, v153
  v_exp_f32 v157, v125
  v_cvt_pk_bf16_f32 v165, v154, v155
  v_exp_f32 v158, v126
  v_exp_f32 v159, v127
  s_waitcnt vmcnt(13)
  v_mfma_f32_32x32x16_bf16 v[112:127], v[80:83], v[16:19], 0
  v_exp_f32 v144, v128
  v_cvt_pk_bf16_f32 v166, v156, v157
  v_exp_f32 v145, v129
  v_cvt_pk_bf16_f32 v167, v158, v159
  v_exp_f32 v146, v130
  v_exp_f32 v147, v131
  v_mfma_f32_32x32x16_bf16 v[112:127], v[84:87], v[20:23], v[112:127]
  v_exp_f32 v148, v132
  v_cvt_pk_bf16_f32 v160, v144, v145
  v_exp_f32 v149, v133
  v_cvt_pk_bf16_f32 v161, v146, v147
  v_exp_f32 v150, v134
  v_exp_f32 v151, v135
  v_mfma_f32_32x32x16_bf16 v[200:215], v[76:79], v[164:167], v[200:215]
  v_exp_f32 v152, v136
  v_cvt_pk_bf16_f32 v162, v148, v149
  v_exp_f32 v153, v137
  v_cvt_pk_bf16_f32 v163, v150, v151
  v_exp_f32 v154, v138
  v_exp_f32 v155, v139
  v_mfma_f32_32x32x16_bf16 v[216:231], v[72:75], v[160:163], v[216:231]
  v_exp_f32 v156, v140
  v_cvt_pk_bf16_f32 v164, v152, v153
  v_exp_f32 v157, v141
  v_cvt_pk_bf16_f32 v165, v154, v155
  v_exp_f32 v158, v142
  v_exp_f32 v159, v143
  v_mfma_f32_32x32x16_bf16 v[128:143], v[80:83], v[24:27], 0
  v_exp_f32 v144, v112
  v_cvt_pk_bf16_f32 v166, v156, v157
  v_exp_f32 v145, v113
  v_cvt_pk_bf16_f32 v167, v158, v159
  v_exp_f32 v146, v114
  buffer_load_dwordx4 a[48:51], v9, s[16:19], s96 offen offset:2048 sc1
  v_exp_f32 v147, v115
  v_mfma_f32_32x32x16_bf16 v[128:143], v[84:87], v[28:31], v[128:143]
  v_exp_f32 v148, v116
  v_cvt_pk_bf16_f32 v160, v144, v145
  v_exp_f32 v149, v117
  v_cvt_pk_bf16_f32 v161, v146, v147
  v_exp_f32 v150, v118
  v_exp_f32 v151, v119
  v_mfma_f32_32x32x16_bf16 v[216:231], v[76:79], v[164:167], v[216:231]
  v_exp_f32 v152, v120
  v_cvt_pk_bf16_f32 v162, v148, v149
  v_exp_f32 v153, v121
  v_cvt_pk_bf16_f32 v163, v150, v151
  v_exp_f32 v154, v122
  v_exp_f32 v155, v123
  v_mfma_f32_32x32x16_bf16 v[168:183], v[88:91], v[160:163], v[168:183]
  v_exp_f32 v156, v124
  v_cvt_pk_bf16_f32 v164, v152, v153
  v_exp_f32 v157, v125
  v_cvt_pk_bf16_f32 v165, v154, v155
  v_exp_f32 v158, v126
  v_exp_f32 v159, v127
  v_mfma_f32_32x32x16_bf16 v[112:127], v[80:83], v[32:35], 0
  v_exp_f32 v144, v128
  v_cvt_pk_bf16_f32 v166, v156, v157
  v_exp_f32 v145, v129
  v_cvt_pk_bf16_f32 v167, v158, v159
  v_exp_f32 v146, v130
  v_exp_f32 v147, v131
  v_mfma_f32_32x32x16_bf16 v[112:127], v[84:87], v[36:39], v[112:127]
  v_exp_f32 v148, v132
  v_cvt_pk_bf16_f32 v160, v144, v145
  v_exp_f32 v149, v133
  v_cvt_pk_bf16_f32 v161, v146, v147
  v_exp_f32 v150, v134
  v_exp_f32 v151, v135
  v_mfma_f32_32x32x16_bf16 v[168:183], v[92:95], v[164:167], v[168:183]
  v_exp_f32 v152, v136
  buffer_load_dwordx4 v[64:67], v9, s[20:23], s30 offen offset:0 sc1
  v_cvt_pk_bf16_f32 v162, v148, v149
  v_exp_f32 v153, v137
  buffer_load_dwordx4 v[68:71], v9, s[20:23], s30 offen offset:1024 sc1
  v_cvt_pk_bf16_f32 v163, v150, v151
  v_exp_f32 v154, v138
  buffer_load_dwordx4 v[72:75], v9, s[20:23], s30 offen offset:2048 sc1
  v_exp_f32 v155, v139
  buffer_load_dwordx4 v[76:79], v9, s[20:23], s30 offen offset:3072 sc1
  s_add_u32 s30, s30, 4096
  v_mfma_f32_32x32x16_bf16 v[184:199], v[88:91], v[160:163], v[184:199]
  v_exp_f32 v156, v140
  v_cvt_pk_bf16_f32 v164, v152, v153
  v_exp_f32 v157, v141
  v_cvt_pk_bf16_f32 v165, v154, v155
  v_exp_f32 v158, v142
  v_exp_f32 v159, v143
  v_mfma_f32_32x32x16_bf16 v[128:143], v[80:83], v[40:43], 0
  v_exp_f32 v144, v112
  v_cvt_pk_bf16_f32 v166, v156, v157
  v_exp_f32 v145, v113
  v_cvt_pk_bf16_f32 v167, v158, v159
  v_exp_f32 v146, v114
  buffer_load_dwordx4 a[52:55], v9, s[16:19], s97 offen offset:2048 sc1
  v_exp_f32 v147, v115
  v_mfma_f32_32x32x16_bf16 v[128:143], v[84:87], v[44:47], v[128:143]
  v_exp_f32 v148, v116
  v_cvt_pk_bf16_f32 v160, v144, v145
  v_exp_f32 v149, v117
  v_cvt_pk_bf16_f32 v161, v146, v147
  v_exp_f32 v150, v118
  v_exp_f32 v151, v119
  v_mfma_f32_32x32x16_bf16 v[184:199], v[92:95], v[164:167], v[184:199]
  v_exp_f32 v152, v120
  v_cvt_pk_bf16_f32 v162, v148, v149
  v_exp_f32 v153, v121
  v_cvt_pk_bf16_f32 v163, v150, v151
  v_exp_f32 v154, v122
  v_exp_f32 v155, v123
  v_mfma_f32_32x32x16_bf16 v[200:215], v[88:91], v[160:163], v[200:215]
  v_exp_f32 v156, v124
  v_cvt_pk_bf16_f32 v164, v152, v153
  v_exp_f32 v157, v125
  v_cvt_pk_bf16_f32 v165, v154, v155
  v_exp_f32 v158, v126
  v_exp_f32 v159, v127
  s_waitcnt vmcnt(13)
  v_mfma_f32_32x32x16_bf16 v[112:127], v[96:99], v[16:19], 0
  v_exp_f32 v144, v128
  v_cvt_pk_bf16_f32 v166, v156, v157
  v_exp_f32 v145, v129
  v_cvt_pk_bf16_f32 v167, v158, v159
  v_exp_f32 v146, v130
  v_exp_f32 v147, v131
  v_mfma_f32_32x32x16_bf16 v[112:127], v[100:103], v[20:23], v[112:127]
  v_exp_f32 v148, v132
  v_cvt_pk_bf16_f32 v160, v144, v145
  v_exp_f32 v149, v133
  v_cvt_pk_bf16_f32 v161, v146, v147
  v_exp_f32 v150, v134
  v_exp_f32 v151, v135
  v_mfma_f32_32x32x16_bf16 v[200:215], v[92:95], v[164:167], v[200:215]
  v_exp_f32 v152, v136
  v_cvt_pk_bf16_f32 v162, v148, v149
  v_exp_f32 v153, v137
  v_cvt_pk_bf16_f32 v163, v150, v151
  v_exp_f32 v154, v138
  v_exp_f32 v155, v139
  v_mfma_f32_32x32x16_bf16 v[216:231], v[88:91], v[160:163], v[216:231]
  v_exp_f32 v156, v140
  v_cvt_pk_bf16_f32 v164, v152, v153
  v_exp_f32 v157, v141
  v_cvt_pk_bf16_f32 v165, v154, v155
  v_exp_f32 v158, v142
  v_exp_f32 v159, v143
  v_mfma_f32_32x32x16_bf16 v[128:143], v[96:99], v[24:27], 0
  v_exp_f32 v144, v112
  v_cvt_pk_bf16_f32 v166, v156, v157
  v_exp_f32 v145, v113
  v_cvt_pk_bf16_f32 v167, v158, v159
  v_exp_f32 v146, v114
  buffer_load_dwordx4 a[56:59], v9, s[16:19], s96 offen offset:3072 sc1
  v_exp_f32 v147, v115
  v_mfma_f32_32x32x16_bf16 v[128:143], v[100:103], v[28:31], v[128:143]
  v_exp_f32 v148, v116
  v_cvt_pk_bf16_f32 v160, v144, v145
  v_exp_f32 v149, v117
  v_cvt_pk_bf16_f32 v161, v146, v147
  v_exp_f32 v150, v118
  v_exp_f32 v151, v119
  v_mfma_f32_32x32x16_bf16 v[216:231], v[92:95], v[164:167], v[216:231]
  v_exp_f32 v152, v120
  v_cvt_pk_bf16_f32 v162, v148, v149
  v_exp_f32 v153, v121
  v_cvt_pk_bf16_f32 v163, v150, v151
  v_exp_f32 v154, v122
  v_exp_f32 v155, v123
  v_mfma_f32_32x32x16_bf16 v[168:183], v[104:107], v[160:163], v[168:183]
  v_exp_f32 v156, v124
  v_cvt_pk_bf16_f32 v164, v152, v153
  v_exp_f32 v157, v125
  v_cvt_pk_bf16_f32 v165, v154, v155
  v_exp_f32 v158, v126
  v_exp_f32 v159, v127
  v_mfma_f32_32x32x16_bf16 v[112:127], v[96:99], v[32:35], 0
  v_exp_f32 v144, v128
  v_cvt_pk_bf16_f32 v166, v156, v157
  v_exp_f32 v145, v129
  v_cvt_pk_bf16_f32 v167, v158, v159
  v_exp_f32 v146, v130
  v_exp_f32 v147, v131
  v_mfma_f32_32x32x16_bf16 v[112:127], v[100:103], v[36:39], v[112:127]
  v_exp_f32 v148, v132
  v_cvt_pk_bf16_f32 v160, v144, v145
  v_exp_f32 v149, v133
  v_cvt_pk_bf16_f32 v161, v146, v147
  v_exp_f32 v150, v134
  v_exp_f32 v151, v135
  v_mfma_f32_32x32x16_bf16 v[168:183], v[108:111], v[164:167], v[168:183]
  v_exp_f32 v152, v136
  buffer_load_dwordx4 v[80:83], v9, s[20:23], s30 offen offset:0 sc1
  v_cvt_pk_bf16_f32 v162, v148, v149
  v_exp_f32 v153, v137
  buffer_load_dwordx4 v[84:87], v9, s[20:23], s30 offen offset:1024 sc1
  v_cvt_pk_bf16_f32 v163, v150, v151
  v_exp_f32 v154, v138
  buffer_load_dwordx4 v[88:91], v9, s[20:23], s30 offen offset:2048 sc1
  v_exp_f32 v155, v139
  buffer_load_dwordx4 v[92:95], v9, s[20:23], s30 offen offset:3072 sc1
  s_add_u32 s30, s30, 4096
  v_mfma_f32_32x32x16_bf16 v[184:199], v[104:107], v[160:163], v[184:199]
  v_exp_f32 v156, v140
  v_cvt_pk_bf16_f32 v164, v152, v153
  v_exp_f32 v157, v141
  v_cvt_pk_bf16_f32 v165, v154, v155
  v_exp_f32 v158, v142
  v_exp_f32 v159, v143
  v_mfma_f32_32x32x16_bf16 v[128:143], v[96:99], v[40:43], 0
  v_exp_f32 v144, v112
  v_cvt_pk_bf16_f32 v166, v156, v157
  v_exp_f32 v145, v113
  v_cvt_pk_bf16_f32 v167, v158, v159
  v_exp_f32 v146, v114
  buffer_load_dwordx4 a[60:63], v9, s[16:19], s97 offen offset:3072 sc1
  v_exp_f32 v147, v115
  v_mfma_f32_32x32x16_bf16 v[128:143], v[100:103], v[44:47], v[128:143]
  v_exp_f32 v148, v116
  v_cvt_pk_bf16_f32 v160, v144, v145
  v_exp_f32 v149, v117
  v_cvt_pk_bf16_f32 v161, v146, v147
  v_exp_f32 v150, v118
  v_exp_f32 v151, v119
  v_mfma_f32_32x32x16_bf16 v[184:199], v[108:111], v[164:167], v[184:199]
  v_exp_f32 v152, v120
  v_cvt_pk_bf16_f32 v162, v148, v149
  v_exp_f32 v153, v121
  v_cvt_pk_bf16_f32 v163, v150, v151
  v_exp_f32 v154, v122
  v_exp_f32 v155, v123
  v_mfma_f32_32x32x16_bf16 v[200:215], v[104:107], v[160:163], v[200:215]
  v_exp_f32 v156, v124
  v_cvt_pk_bf16_f32 v164, v152, v153
  v_exp_f32 v157, v125
  v_cvt_pk_bf16_f32 v165, v154, v155
  v_exp_f32 v158, v126
  v_exp_f32 v159, v127
  s_waitcnt vmcnt(13)
  v_mfma_f32_32x32x16_bf16 v[112:127], v[48:51], v[16:19], 0
  v_exp_f32 v144, v128
  v_cvt_pk_bf16_f32 v166, v156, v157
  v_exp_f32 v145, v129
  v_cvt_pk_bf16_f32 v167, v158, v159
  v_exp_f32 v146, v130
  v_exp_f32 v147, v131
  v_mfma_f32_32x32x16_bf16 v[112:127], v[52:55], v[20:23], v[112:127]
  v_exp_f32 v148, v132
  v_cvt_pk_bf16_f32 v160, v144, v145
  v_exp_f32 v149, v133
  v_cvt_pk_bf16_f32 v161, v146, v147
  v_exp_f32 v150, v134
  v_exp_f32 v151, v135
  v_mfma_f32_32x32x16_bf16 v[200:215], v[108:111], v[164:167], v[200:215]
  v_exp_f32 v152, v136
  v_cvt_pk_bf16_f32 v162, v148, v149
  v_exp_f32 v153, v137
  v_cvt_pk_bf16_f32 v163, v150, v151
  v_exp_f32 v154, v138
  v_exp_f32 v155, v139
  v_mfma_f32_32x32x16_bf16 v[216:231], v[104:107], v[160:163], v[216:231]
  v_exp_f32 v156, v140
  v_cvt_pk_bf16_f32 v164, v152, v153
  v_exp_f32 v157, v141
  v_cvt_pk_bf16_f32 v165, v154, v155
  v_exp_f32 v158, v142
  v_exp_f32 v159, v143
  v_mfma_f32_32x32x16_bf16 v[128:143], v[48:51], v[24:27], 0
  v_exp_f32 v144, v112
  v_cvt_pk_bf16_f32 v166, v156, v157
  v_exp_f32 v145, v113
  v_cvt_pk_bf16_f32 v167, v158, v159
  v_exp_f32 v146, v114
  buffer_load_dwordx4 a[64:67], v9, s[16:19], s5 offen offset:0 sc1
  v_exp_f32 v147, v115
  v_mfma_f32_32x32x16_bf16 v[128:143], v[52:55], v[28:31], v[128:143]
  v_exp_f32 v148, v116
  v_cvt_pk_bf16_f32 v160, v144, v145
  v_exp_f32 v149, v117
  v_cvt_pk_bf16_f32 v161, v146, v147
  v_exp_f32 v150, v118
  v_exp_f32 v151, v119
  v_mfma_f32_32x32x16_bf16 v[216:231], v[108:111], v[164:167], v[216:231]
  v_exp_f32 v152, v120
  v_cvt_pk_bf16_f32 v162, v148, v149
  v_exp_f32 v153, v121
  v_cvt_pk_bf16_f32 v163, v150, v151
  v_exp_f32 v154, v122
  v_exp_f32 v155, v123
  v_mfma_f32_32x32x16_bf16 v[168:183], v[56:59], v[160:163], v[168:183]
  v_exp_f32 v156, v124
  v_cvt_pk_bf16_f32 v164, v152, v153
  v_exp_f32 v157, v125
  v_cvt_pk_bf16_f32 v165, v154, v155
  v_exp_f32 v158, v126
  v_exp_f32 v159, v127
  v_mfma_f32_32x32x16_bf16 v[112:127], v[48:51], v[32:35], 0
  v_exp_f32 v144, v128
  v_cvt_pk_bf16_f32 v166, v156, v157
  v_exp_f32 v145, v129
  v_cvt_pk_bf16_f32 v167, v158, v159
  v_exp_f32 v146, v130
  v_exp_f32 v147, v131
  v_mfma_f32_32x32x16_bf16 v[112:127], v[52:55], v[36:39], v[112:127]
  v_exp_f32 v148, v132
  v_cvt_pk_bf16_f32 v160, v144, v145
  v_exp_f32 v149, v133
  v_cvt_pk_bf16_f32 v161, v146, v147
  v_exp_f32 v150, v134
  v_exp_f32 v151, v135
  v_mfma_f32_32x32x16_bf16 v[168:183], v[60:63], v[164:167], v[168:183]
  v_exp_f32 v152, v136
  buffer_load_dwordx4 v[96:99], v9, s[20:23], s30 offen offset:0 sc1
  v_cvt_pk_bf16_f32 v162, v148, v149
  v_exp_f32 v153, v137
  buffer_load_dwordx4 v[100:103], v9, s[20:23], s30 offen offset:1024 sc1
  v_cvt_pk_bf16_f32 v163, v150, v151
  v_exp_f32 v154, v138
  buffer_load_dwordx4 v[104:107], v9, s[20:23], s30 offen offset:2048 sc1
  v_exp_f32 v155, v139
  buffer_load_dwordx4 v[108:111], v9, s[20:23], s30 offen offset:3072 sc1
  s_add_u32 s30, s30, 4096
  v_mfma_f32_32x32x16_bf16 v[184:199], v[56:59], v[160:163], v[184:199]
  v_exp_f32 v156, v140
  v_cvt_pk_bf16_f32 v164, v152, v153
  v_exp_f32 v157, v141
  v_cvt_pk_bf16_f32 v165, v154, v155
  v_exp_f32 v158, v142
  v_exp_f32 v159, v143
  v_mfma_f32_32x32x16_bf16 v[128:143], v[48:51], v[40:43], 0
  v_exp_f32 v144, v112
  v_cvt_pk_bf16_f32 v166, v156, v157
  v_exp_f32 v145, v113
  v_cvt_pk_bf16_f32 v167, v158, v159
  v_exp_f32 v146, v114
  buffer_load_dwordx4 a[68:71], v9, s[16:19], s5 offen offset:1024 sc1
  v_exp_f32 v147, v115
  v_mfma_f32_32x32x16_bf16 v[128:143], v[52:55], v[44:47], v[128:143]
  v_exp_f32 v148, v116
  v_cvt_pk_bf16_f32 v160, v144, v145
  v_exp_f32 v149, v117
  v_cvt_pk_bf16_f32 v161, v146, v147
  v_exp_f32 v150, v118
  v_exp_f32 v151, v119
  v_mfma_f32_32x32x16_bf16 v[184:199], v[60:63], v[164:167], v[184:199]
  v_exp_f32 v152, v120
  v_cvt_pk_bf16_f32 v162, v148, v149
  v_exp_f32 v153, v121
  v_cvt_pk_bf16_f32 v163, v150, v151
  v_exp_f32 v154, v122
  v_exp_f32 v155, v123
  v_mfma_f32_32x32x16_bf16 v[200:215], v[56:59], v[160:163], v[200:215]
  v_exp_f32 v156, v124
  v_cvt_pk_bf16_f32 v164, v152, v153
  v_exp_f32 v157, v125
  v_cvt_pk_bf16_f32 v165, v154, v155
  v_exp_f32 v158, v126
  v_exp_f32 v159, v127
  s_waitcnt vmcnt(13)
  v_mfma_f32_32x32x16_bf16 v[112:127], v[64:67], v[16:19], 0
  v_exp_f32 v144, v128
  v_cvt_pk_bf16_f32 v166, v156, v157
  v_exp_f32 v145, v129
  v_cvt_pk_bf16_f32 v167, v158, v159
  v_exp_f32 v146, v130
  v_exp_f32 v147, v131
  v_mfma_f32_32x32x16_bf16 v[112:127], v[68:71], v[20:23], v[112:127]
  v_exp_f32 v148, v132
  v_cvt_pk_bf16_f32 v160, v144, v145
  v_exp_f32 v149, v133
  v_cvt_pk_bf16_f32 v161, v146, v147
  v_exp_f32 v150, v134
  v_exp_f32 v151, v135
  v_mfma_f32_32x32x16_bf16 v[200:215], v[60:63], v[164:167], v[200:215]
  v_exp_f32 v152, v136
  v_cvt_pk_bf16_f32 v162, v148, v149
  v_exp_f32 v153, v137
  v_cvt_pk_bf16_f32 v163, v150, v151
  v_exp_f32 v154, v138
  v_exp_f32 v155, v139
  v_mfma_f32_32x32x16_bf16 v[216:231], v[56:59], v[160:163], v[216:231]
  v_exp_f32 v156, v140
  v_cvt_pk_bf16_f32 v164, v152, v153
  v_exp_f32 v157, v141
  v_cvt_pk_bf16_f32 v165, v154, v155
  v_exp_f32 v158, v142
  v_exp_f32 v159, v143
  v_mfma_f32_32x32x16_bf16 v[128:143], v[64:67], v[24:27], 0
  v_exp_f32 v144, v112
  v_cvt_pk_bf16_f32 v166, v156, v157
  v_exp_f32 v145, v113
  v_cvt_pk_bf16_f32 v167, v158, v159
  v_exp_f32 v146, v114
  buffer_load_dwordx4 a[72:75], v9, s[16:19], s5 offen offset:2048 sc1
  v_exp_f32 v147, v115
  v_mfma_f32_32x32x16_bf16 v[128:143], v[68:71], v[28:31], v[128:143]
  v_exp_f32 v148, v116
  v_cvt_pk_bf16_f32 v160, v144, v145
  v_exp_f32 v149, v117
  v_cvt_pk_bf16_f32 v161, v146, v147
  v_exp_f32 v150, v118
  v_exp_f32 v151, v119
  v_mfma_f32_32x32x16_bf16 v[216:231], v[60:63], v[164:167], v[216:231]
  v_exp_f32 v152, v120
  v_cvt_pk_bf16_f32 v162, v148, v149
  v_exp_f32 v153, v121
  v_cvt_pk_bf16_f32 v163, v150, v151
  v_exp_f32 v154, v122
  v_exp_f32 v155, v123
  v_mfma_f32_32x32x16_bf16 v[168:183], v[72:75], v[160:163], v[168:183]
  v_exp_f32 v156, v124
  v_cvt_pk_bf16_f32 v164, v152, v153
  v_exp_f32 v157, v125
  v_cvt_pk_bf16_f32 v165, v154, v155
  v_exp_f32 v158, v126
  v_exp_f32 v159, v127
  v_mfma_f32_32x32x16_bf16 v[112:127], v[64:67], v[32:35], 0
  v_exp_f32 v144, v128
  v_cvt_pk_bf16_f32 v166, v156, v157
  v_exp_f32 v145, v129
  v_cvt_pk_bf16_f32 v167, v158, v159
  v_exp_f32 v146, v130
  v_exp_f32 v147, v131
  v_mfma_f32_32x32x16_bf16 v[112:127], v[68:71], v[36:39], v[112:127]
  v_exp_f32 v148, v132
  v_cvt_pk_bf16_f32 v160, v144, v145
  v_exp_f32 v149, v133
  v_cvt_pk_bf16_f32 v161, v146, v147
  v_exp_f32 v150, v134
  v_exp_f32 v151, v135
  v_mfma_f32_32x32x16_bf16 v[168:183], v[76:79], v[164:167], v[168:183]
  v_exp_f32 v152, v136
  buffer_load_dwordx4 v[48:51], v9, s[20:23], s30 offen offset:0 sc1
  v_cvt_pk_bf16_f32 v162, v148, v149
  v_exp_f32 v153, v137
  buffer_load_dwordx4 v[52:55], v9, s[20:23], s30 offen offset:1024 sc1
  v_cvt_pk_bf16_f32 v163, v150, v151
  v_exp_f32 v154, v138
  buffer_load_dwordx4 v[56:59], v9, s[20:23], s30 offen offset:2048 sc1
  v_exp_f32 v155, v139
  buffer_load_dwordx4 v[60:63], v9, s[20:23], s30 offen offset:3072 sc1
  s_add_u32 s30, s30, 4096
  v_mfma_f32_32x32x16_bf16 v[184:199], v[72:75], v[160:163], v[184:199]
  v_exp_f32 v156, v140
  v_cvt_pk_bf16_f32 v164, v152, v153
  v_exp_f32 v157, v141
  v_cvt_pk_bf16_f32 v165, v154, v155
  v_exp_f32 v158, v142
  v_exp_f32 v159, v143
  v_mfma_f32_32x32x16_bf16 v[128:143], v[64:67], v[40:43], 0
  v_exp_f32 v144, v112
  v_cvt_pk_bf16_f32 v166, v156, v157
  v_exp_f32 v145, v113
  v_cvt_pk_bf16_f32 v167, v158, v159
  v_exp_f32 v146, v114
  buffer_load_dwordx4 a[76:79], v9, s[16:19], s5 offen offset:3072 sc1
  v_exp_f32 v147, v115
  v_mfma_f32_32x32x16_bf16 v[128:143], v[68:71], v[44:47], v[128:143]
  v_exp_f32 v148, v116
  v_cvt_pk_bf16_f32 v160, v144, v145
  v_exp_f32 v149, v117
  v_cvt_pk_bf16_f32 v161, v146, v147
  v_exp_f32 v150, v118
  v_exp_f32 v151, v119
  v_mfma_f32_32x32x16_bf16 v[184:199], v[76:79], v[164:167], v[184:199]
  v_exp_f32 v152, v120
  v_cvt_pk_bf16_f32 v162, v148, v149
  v_exp_f32 v153, v121
  v_cvt_pk_bf16_f32 v163, v150, v151
  v_exp_f32 v154, v122
  v_exp_f32 v155, v123
  v_mfma_f32_32x32x16_bf16 v[200:215], v[72:75], v[160:163], v[200:215]
  v_exp_f32 v156, v124
  v_cvt_pk_bf16_f32 v164, v152, v153
  v_exp_f32 v157, v125
  v_cvt_pk_bf16_f32 v165, v154, v155
  v_exp_f32 v158, v126
  v_exp_f32 v159, v127
  s_waitcnt vmcnt(13)
  v_mfma_f32_32x32x16_bf16 v[112:127], v[80:83], v[16:19], 0
  v_exp_f32 v144, v128
  v_cvt_pk_bf16_f32 v166, v156, v157
  v_exp_f32 v145, v129
  v_cvt_pk_bf16_f32 v167, v158, v159
  v_exp_f32 v146, v130
  v_exp_f32 v147, v131
  v_mfma_f32_32x32x16_bf16 v[112:127], v[84:87], v[20:23], v[112:127]
  v_exp_f32 v148, v132
  v_cvt_pk_bf16_f32 v160, v144, v145
  v_exp_f32 v149, v133
  v_cvt_pk_bf16_f32 v161, v146, v147
  v_exp_f32 v150, v134
  v_exp_f32 v151, v135
  v_mfma_f32_32x32x16_bf16 v[200:215], v[76:79], v[164:167], v[200:215]
  v_exp_f32 v152, v136
  v_cvt_pk_bf16_f32 v162, v148, v149
  v_exp_f32 v153, v137
  v_cvt_pk_bf16_f32 v163, v150, v151
  v_exp_f32 v154, v138
  v_exp_f32 v155, v139
  v_mfma_f32_32x32x16_bf16 v[216:231], v[72:75], v[160:163], v[216:231]
  v_exp_f32 v156, v140
  v_cvt_pk_bf16_f32 v164, v152, v153
  v_exp_f32 v157, v141
  v_cvt_pk_bf16_f32 v165, v154, v155
  v_exp_f32 v158, v142
  v_exp_f32 v159, v143
  v_mfma_f32_32x32x16_bf16 v[128:143], v[80:83], v[24:27], 0
  v_exp_f32 v144, v112
  v_cvt_pk_bf16_f32 v166, v156, v157
  v_exp_f32 v145, v113
  v_cvt_pk_bf16_f32 v167, v158, v159
  v_exp_f32 v146, v114
  s_add_u32 s5, s5, 4096
  buffer_load_dwordx4 a[80:83], v9, s[16:19], s5 offen offset:0 sc1
  v_exp_f32 v147, v115
  v_mfma_f32_32x32x16_bf16 v[128:143], v[84:87], v[28:31], v[128:143]
  v_exp_f32 v148, v116
  v_cvt_pk_bf16_f32 v160, v144, v145
  v_exp_f32 v149, v117
  v_cvt_pk_bf16_f32 v161, v146, v147
  v_exp_f32 v150, v118
  v_exp_f32 v151, v119
  v_mfma_f32_32x32x16_bf16 v[216:231], v[76:79], v[164:167], v[216:231]
  v_exp_f32 v152, v120
  v_cvt_pk_bf16_f32 v162, v148, v149
  v_exp_f32 v153, v121
  v_cvt_pk_bf16_f32 v163, v150, v151
  v_exp_f32 v154, v122
  v_exp_f32 v155, v123
  v_mfma_f32_32x32x16_bf16 v[168:183], v[88:91], v[160:163], v[168:183]
  v_exp_f32 v156, v124
  v_cvt_pk_bf16_f32 v164, v152, v153
  v_exp_f32 v157, v125
  v_cvt_pk_bf16_f32 v165, v154, v155
  v_exp_f32 v158, v126
  v_exp_f32 v159, v127
  v_mfma_f32_32x32x16_bf16 v[112:127], v[80:83], v[32:35], 0
  v_exp_f32 v144, v128
  v_cvt_pk_bf16_f32 v166, v156, v157
  v_exp_f32 v145, v129
  v_cvt_pk_bf16_f32 v167, v158, v159
  v_exp_f32 v146, v130
  v_exp_f32 v147, v131
  v_mfma_f32_32x32x16_bf16 v[112:127], v[84:87], v[36:39], v[112:127]
  v_exp_f32 v148, v132
  v_cvt_pk_bf16_f32 v160, v144, v145
  v_exp_f32 v149, v133
  v_cvt_pk_bf16_f32 v161, v146, v147
  v_exp_f32 v150, v134
  v_exp_f32 v151, v135
  v_mfma_f32_32x32x16_bf16 v[168:183], v[92:95], v[164:167], v[168:183]
  v_exp_f32 v152, v136
  buffer_load_dwordx4 v[64:67], v9, s[20:23], s30 offen offset:0 sc1
  v_cvt_pk_bf16_f32 v162, v148, v149
  v_exp_f32 v153, v137
  buffer_load_dwordx4 v[68:71], v9, s[20:23], s30 offen offset:1024 sc1
  v_cvt_pk_bf16_f32 v163, v150, v151
  v_exp_f32 v154, v138
  buffer_load_dwordx4 v[72:75], v9, s[20:23], s30 offen offset:2048 sc1
  v_exp_f32 v155, v139
  buffer_load_dwordx4 v[76:79], v9, s[20:23], s30 offen offset:3072 sc1
  s_add_u32 s30, s30, 4096
  v_mfma_f32_32x32x16_bf16 v[184:199], v[88:91], v[160:163], v[184:199]
  v_exp_f32 v156, v140
  v_cvt_pk_bf16_f32 v164, v152, v153
  v_exp_f32 v157, v141
  v_cvt_pk_bf16_f32 v165, v154, v155
  v_exp_f32 v158, v142
  v_exp_f32 v159, v143
  v_mfma_f32_32x32x16_bf16 v[128:143], v[80:83], v[40:43], 0
  v_exp_f32 v144, v112
  v_cvt_pk_bf16_f32 v166, v156, v157
  v_exp_f32 v145, v113
  v_cvt_pk_bf16_f32 v167, v158, v159
  v_exp_f32 v146, v114
  buffer_load_dwordx4 a[84:87], v9, s[16:19], s5 offen offset:1024 sc1
  v_exp_f32 v147, v115
  v_mfma_f32_32x32x16_bf16 v[128:143], v[84:87], v[44:47], v[128:143]
  v_exp_f32 v148, v116
  v_cvt_pk_bf16_f32 v160, v144, v145
  v_exp_f32 v149, v117
  v_cvt_pk_bf16_f32 v161, v146, v147
  v_exp_f32 v150, v118
  v_exp_f32 v151, v119
  v_mfma_f32_32x32x16_bf16 v[184:199], v[92:95], v[164:167], v[184:199]
  v_exp_f32 v152, v120
  v_cvt_pk_bf16_f32 v162, v148, v149
  v_exp_f32 v153, v121
  v_cvt_pk_bf16_f32 v163, v150, v151
  v_exp_f32 v154, v122
  v_exp_f32 v155, v123
  v_mfma_f32_32x32x16_bf16 v[200:215], v[88:91], v[160:163], v[200:215]
  v_exp_f32 v156, v124
  v_cvt_pk_bf16_f32 v164, v152, v153
  v_exp_f32 v157, v125
  v_cvt_pk_bf16_f32 v165, v154, v155
  v_exp_f32 v158, v126
  v_exp_f32 v159, v127
  s_waitcnt vmcnt(13)
  v_mfma_f32_32x32x16_bf16 v[112:127], v[96:99], v[16:19], 0
  v_exp_f32 v144, v128
  v_cvt_pk_bf16_f32 v166, v156, v157
  v_exp_f32 v145, v129
  v_cvt_pk_bf16_f32 v167, v158, v159
  v_exp_f32 v146, v130
  v_exp_f32 v147, v131
  v_mfma_f32_32x32x16_bf16 v[112:127], v[100:103], v[20:23], v[112:127]
  v_exp_f32 v148, v132
  v_cvt_pk_bf16_f32 v160, v144, v145
  v_exp_f32 v149, v133
  v_cvt_pk_bf16_f32 v161, v146, v147
  v_exp_f32 v150, v134
  v_exp_f32 v151, v135
  v_mfma_f32_32x32x16_bf16 v[200:215], v[92:95], v[164:167], v[200:215]
  v_exp_f32 v152, v136
  v_cvt_pk_bf16_f32 v162, v148, v149
  v_exp_f32 v153, v137
  v_cvt_pk_bf16_f32 v163, v150, v151
  v_exp_f32 v154, v138
  v_exp_f32 v155, v139
  v_mfma_f32_32x32x16_bf16 v[216:231], v[88:91], v[160:163], v[216:231]
  v_exp_f32 v156, v140
  v_cvt_pk_bf16_f32 v164, v152, v153
  v_exp_f32 v157, v141
  v_cvt_pk_bf16_f32 v165, v154, v155
  v_exp_f32 v158, v142
  v_exp_f32 v159, v143
  v_mfma_f32_32x32x16_bf16 v[128:143], v[96:99], v[24:27], 0
  v_exp_f32 v144, v112
  v_cvt_pk_bf16_f32 v166, v156, v157
  v_exp_f32 v145, v113
  v_cvt_pk_bf16_f32 v167, v158, v159
  v_exp_f32 v146, v114
  buffer_load_dwordx4 a[88:91], v9, s[16:19], s5 offen offset:2048 sc1
  v_exp_f32 v147, v115
  v_mfma_f32_32x32x16_bf16 v[128:143], v[100:103], v[28:31], v[128:143]
  v_exp_f32 v148, v116
  v_cvt_pk_bf16_f32 v160, v144, v145
  v_exp_f32 v149, v117
  v_cvt_pk_bf16_f32 v161, v146, v147
  v_exp_f32 v150, v118
  v_exp_f32 v151, v119
  v_mfma_f32_32x32x16_bf16 v[216:231], v[92:95], v[164:167], v[216:231]
  v_exp_f32 v152, v120
  v_cvt_pk_bf16_f32 v162, v148, v149
  v_exp_f32 v153, v121
  v_cvt_pk_bf16_f32 v163, v150, v151
  v_exp_f32 v154, v122
  v_exp_f32 v155, v123
  v_mfma_f32_32x32x16_bf16 v[168:183], v[104:107], v[160:163], v[168:183]
  v_exp_f32 v156, v124
  v_cvt_pk_bf16_f32 v164, v152, v153
  v_exp_f32 v157, v125
  v_cvt_pk_bf16_f32 v165, v154, v155
  v_exp_f32 v158, v126
  v_exp_f32 v159, v127
  v_mfma_f32_32x32x16_bf16 v[112:127], v[96:99], v[32:35], 0
  v_exp_f32 v144, v128
  v_cvt_pk_bf16_f32 v166, v156, v157
  v_exp_f32 v145, v129
  v_cvt_pk_bf16_f32 v167, v158, v159
  v_exp_f32 v146, v130
  v_exp_f32 v147, v131
  v_mfma_f32_32x32x16_bf16 v[112:127], v[100:103], v[36:39], v[112:127]
  v_exp_f32 v148, v132
  v_cvt_pk_bf16_f32 v160, v144, v145
  v_exp_f32 v149, v133
  v_cvt_pk_bf16_f32 v161, v146, v147
  v_exp_f32 v150, v134
  v_exp_f32 v151, v135
  v_mfma_f32_32x32x16_bf16 v[168:183], v[108:111], v[164:167], v[168:183]
  v_exp_f32 v152, v136
  buffer_load_dwordx4 v[80:83], v9, s[20:23], s30 offen offset:0 sc1
  v_cvt_pk_bf16_f32 v162, v148, v149
  v_exp_f32 v153, v137
  buffer_load_dwordx4 v[84:87], v9, s[20:23], s30 offen offset:1024 sc1
  v_cvt_pk_bf16_f32 v163, v150, v151
  v_exp_f32 v154, v138
  buffer_load_dwordx4 v[88:91], v9, s[20:23], s30 offen offset:2048 sc1
  v_exp_f32 v155, v139
  buffer_load_dwordx4 v[92:95], v9, s[20:23], s30 offen offset:3072 sc1
  s_add_u32 s30, s30, 4096
  v_mfma_f32_32x32x16_bf16 v[184:199], v[104:107], v[160:163], v[184:199]
  v_exp_f32 v156, v140
  v_cvt_pk_bf16_f32 v164, v152, v153
  v_exp_f32 v157, v141
  v_cvt_pk_bf16_f32 v165, v154, v155
  v_exp_f32 v158, v142
  v_exp_f32 v159, v143
  v_mfma_f32_32x32x16_bf16 v[128:143], v[96:99], v[40:43], 0
  v_exp_f32 v144, v112
  v_cvt_pk_bf16_f32 v166, v156, v157
  v_exp_f32 v145, v113
  v_cvt_pk_bf16_f32 v167, v158, v159
  v_exp_f32 v146, v114
  s_add_u32 s100, s100, 114688
  buffer_load_dwordx4 a[92:95], v9, s[16:19], s100 offen offset:0 sc1
  v_exp_f32 v147, v115
  v_mfma_f32_32x32x16_bf16 v[128:143], v[100:103], v[44:47], v[128:143]
  v_exp_f32 v148, v116
  v_cvt_pk_bf16_f32 v160, v144, v145
  v_exp_f32 v149, v117
  v_cvt_pk_bf16_f32 v161, v146, v147
  v_exp_f32 v150, v118
  v_exp_f32 v151, v119
  v_mfma_f32_32x32x16_bf16 v[184:199], v[108:111], v[164:167], v[184:199]
  v_exp_f32 v152, v120
  v_cvt_pk_bf16_f32 v162, v148, v149
  v_exp_f32 v153, v121
  v_cvt_pk_bf16_f32 v163, v150, v151
  v_exp_f32 v154, v122
  v_exp_f32 v155, v123
  v_mfma_f32_32x32x16_bf16 v[200:215], v[104:107], v[160:163], v[200:215]
  v_exp_f32 v156, v124
  v_cvt_pk_bf16_f32 v164, v152, v153
  v_exp_f32 v157, v125
  v_cvt_pk_bf16_f32 v165, v154, v155
  v_exp_f32 v158, v126
  v_exp_f32 v159, v127
  s_waitcnt vmcnt(13)
  v_mfma_f32_32x32x16_bf16 v[112:127], v[48:51], v[16:19], 0
  v_exp_f32 v144, v128
  v_cvt_pk_bf16_f32 v166, v156, v157
  v_exp_f32 v145, v129
  v_cvt_pk_bf16_f32 v167, v158, v159
  v_exp_f32 v146, v130
  v_exp_f32 v147, v131
  v_mfma_f32_32x32x16_bf16 v[112:127], v[52:55], v[20:23], v[112:127]
  v_exp_f32 v148, v132
  v_cvt_pk_bf16_f32 v160, v144, v145
  v_exp_f32 v149, v133
  v_cvt_pk_bf16_f32 v161, v146, v147
  v_exp_f32 v150, v134
  v_exp_f32 v151, v135
  v_mfma_f32_32x32x16_bf16 v[200:215], v[108:111], v[164:167], v[200:215]
  v_exp_f32 v152, v136
  v_cvt_pk_bf16_f32 v162, v148, v149
  v_exp_f32 v153, v137
  v_cvt_pk_bf16_f32 v163, v150, v151
  v_exp_f32 v154, v138
  v_exp_f32 v155, v139
  v_mfma_f32_32x32x16_bf16 v[216:231], v[104:107], v[160:163], v[216:231]
  v_exp_f32 v156, v140
  v_cvt_pk_bf16_f32 v164, v152, v153
  v_exp_f32 v157, v141
  v_cvt_pk_bf16_f32 v165, v154, v155
  v_exp_f32 v158, v142
  v_exp_f32 v159, v143
  v_mfma_f32_32x32x16_bf16 v[128:143], v[48:51], v[24:27], 0
  v_exp_f32 v144, v112
  v_cvt_pk_bf16_f32 v166, v156, v157
  v_exp_f32 v145, v113
  v_cvt_pk_bf16_f32 v167, v158, v159
  v_exp_f32 v146, v114
  buffer_load_dwordx4 a[96:99], v9, s[16:19], s100 offen offset:1024 sc1
  v_exp_f32 v147, v115
  v_mfma_f32_32x32x16_bf16 v[128:143], v[52:55], v[28:31], v[128:143]
  v_exp_f32 v148, v116
  v_cvt_pk_bf16_f32 v160, v144, v145
  v_exp_f32 v149, v117
  v_cvt_pk_bf16_f32 v161, v146, v147
  v_exp_f32 v150, v118
  v_exp_f32 v151, v119
  v_mfma_f32_32x32x16_bf16 v[216:231], v[108:111], v[164:167], v[216:231]
  v_exp_f32 v152, v120
  v_cvt_pk_bf16_f32 v162, v148, v149
  v_exp_f32 v153, v121
  v_cvt_pk_bf16_f32 v163, v150, v151
  v_exp_f32 v154, v122
  v_exp_f32 v155, v123
  v_mfma_f32_32x32x16_bf16 v[168:183], v[56:59], v[160:163], v[168:183]
  v_exp_f32 v156, v124
  v_cvt_pk_bf16_f32 v164, v152, v153
  v_exp_f32 v157, v125
  v_cvt_pk_bf16_f32 v165, v154, v155
  v_exp_f32 v158, v126
  v_exp_f32 v159, v127
  v_mfma_f32_32x32x16_bf16 v[112:127], v[48:51], v[32:35], 0
  v_exp_f32 v144, v128
  v_cvt_pk_bf16_f32 v166, v156, v157
  v_exp_f32 v145, v129
  v_cvt_pk_bf16_f32 v167, v158, v159
  v_exp_f32 v146, v130
  v_exp_f32 v147, v131
  v_mfma_f32_32x32x16_bf16 v[112:127], v[52:55], v[36:39], v[112:127]
  v_exp_f32 v148, v132
  v_cvt_pk_bf16_f32 v160, v144, v145
  v_exp_f32 v149, v133
  v_cvt_pk_bf16_f32 v161, v146, v147
  v_exp_f32 v150, v134
  v_exp_f32 v151, v135
  v_mfma_f32_32x32x16_bf16 v[168:183], v[60:63], v[164:167], v[168:183]
  v_exp_f32 v152, v136
  buffer_load_dwordx4 v[96:99], v9, s[20:23], s30 offen offset:0 sc1
  v_cvt_pk_bf16_f32 v162, v148, v149
  v_exp_f32 v153, v137
  buffer_load_dwordx4 v[100:103], v9, s[20:23], s30 offen offset:1024 sc1
  v_cvt_pk_bf16_f32 v163, v150, v151
  v_exp_f32 v154, v138
  buffer_load_dwordx4 v[104:107], v9, s[20:23], s30 offen offset:2048 sc1
  v_exp_f32 v155, v139
  buffer_load_dwordx4 v[108:111], v9, s[20:23], s30 offen offset:3072 sc1
  s_add_u32 s30, s30, 4096
  v_mfma_f32_32x32x16_bf16 v[184:199], v[56:59], v[160:163], v[184:199]
  v_exp_f32 v156, v140
  v_cvt_pk_bf16_f32 v164, v152, v153
  v_exp_f32 v157, v141
  v_cvt_pk_bf16_f32 v165, v154, v155
  v_exp_f32 v158, v142
  v_exp_f32 v159, v143
  v_mfma_f32_32x32x16_bf16 v[128:143], v[48:51], v[40:43], 0
  v_exp_f32 v144, v112
  v_cvt_pk_bf16_f32 v166, v156, v157
  v_exp_f32 v145, v113
  v_cvt_pk_bf16_f32 v167, v158, v159
  v_exp_f32 v146, v114
  buffer_load_dwordx4 a[100:103], v9, s[16:19], s100 offen offset:2048 sc1
  v_exp_f32 v147, v115
  v_mfma_f32_32x32x16_bf16 v[128:143], v[52:55], v[44:47], v[128:143]
  v_exp_f32 v148, v116
  v_cvt_pk_bf16_f32 v160, v144, v145
  v_exp_f32 v149, v117
  v_cvt_pk_bf16_f32 v161, v146, v147
  v_exp_f32 v150, v118
  v_exp_f32 v151, v119
  v_mfma_f32_32x32x16_bf16 v[184:199], v[60:63], v[164:167], v[184:199]
  v_exp_f32 v152, v120
  v_cvt_pk_bf16_f32 v162, v148, v149
  v_exp_f32 v153, v121
  v_cvt_pk_bf16_f32 v163, v150, v151
  v_exp_f32 v154, v122
  v_exp_f32 v155, v123
  v_mfma_f32_32x32x16_bf16 v[200:215], v[56:59], v[160:163], v[200:215]
  v_exp_f32 v156, v124
  v_cvt_pk_bf16_f32 v164, v152, v153
  v_exp_f32 v157, v125
  v_cvt_pk_bf16_f32 v165, v154, v155
  v_exp_f32 v158, v126
  v_exp_f32 v159, v127
  s_waitcnt vmcnt(13)
  v_mfma_f32_32x32x16_bf16 v[112:127], v[64:67], v[16:19], 0
  v_exp_f32 v144, v128
  v_cvt_pk_bf16_f32 v166, v156, v157
  v_exp_f32 v145, v129
  v_cvt_pk_bf16_f32 v167, v158, v159
  v_exp_f32 v146, v130
  v_exp_f32 v147, v131
  v_mfma_f32_32x32x16_bf16 v[112:127], v[68:71], v[20:23], v[112:127]
  v_exp_f32 v148, v132
  v_cvt_pk_bf16_f32 v160, v144, v145
  v_exp_f32 v149, v133
  v_cvt_pk_bf16_f32 v161, v146, v147
  v_exp_f32 v150, v134
  v_exp_f32 v151, v135
  v_mfma_f32_32x32x16_bf16 v[200:215], v[60:63], v[164:167], v[200:215]
  v_exp_f32 v152, v136
  v_cvt_pk_bf16_f32 v162, v148, v149
  v_exp_f32 v153, v137
  v_cvt_pk_bf16_f32 v163, v150, v151
  v_exp_f32 v154, v138
  v_exp_f32 v155, v139
  v_mfma_f32_32x32x16_bf16 v[216:231], v[56:59], v[160:163], v[216:231]
  v_exp_f32 v156, v140
  v_cvt_pk_bf16_f32 v164, v152, v153
  v_exp_f32 v157, v141
  v_cvt_pk_bf16_f32 v165, v154, v155
  v_exp_f32 v158, v142
  v_exp_f32 v159, v143
  v_mfma_f32_32x32x16_bf16 v[128:143], v[64:67], v[24:27], 0
  v_exp_f32 v144, v112
  v_cvt_pk_bf16_f32 v166, v156, v157
  v_exp_f32 v145, v113
  v_cvt_pk_bf16_f32 v167, v158, v159
  v_exp_f32 v146, v114
  buffer_load_dwordx4 a[104:107], v9, s[16:19], s100 offen offset:3072 sc1
  v_exp_f32 v147, v115
  v_mfma_f32_32x32x16_bf16 v[128:143], v[68:71], v[28:31], v[128:143]
  v_exp_f32 v148, v116
  v_cvt_pk_bf16_f32 v160, v144, v145
  v_exp_f32 v149, v117
  v_cvt_pk_bf16_f32 v161, v146, v147
  v_exp_f32 v150, v118
  v_exp_f32 v151, v119
  v_mfma_f32_32x32x16_bf16 v[216:231], v[60:63], v[164:167], v[216:231]
  v_exp_f32 v152, v120
  v_cvt_pk_bf16_f32 v162, v148, v149
  v_exp_f32 v153, v121
  v_cvt_pk_bf16_f32 v163, v150, v151
  v_exp_f32 v154, v122
  v_exp_f32 v155, v123
  v_mfma_f32_32x32x16_bf16 v[168:183], v[72:75], v[160:163], v[168:183]
  v_exp_f32 v156, v124
  v_cvt_pk_bf16_f32 v164, v152, v153
  v_exp_f32 v157, v125
  v_cvt_pk_bf16_f32 v165, v154, v155
  v_exp_f32 v158, v126
  v_exp_f32 v159, v127
  v_mfma_f32_32x32x16_bf16 v[112:127], v[64:67], v[32:35], 0
  v_exp_f32 v144, v128
  v_cvt_pk_bf16_f32 v166, v156, v157
  v_exp_f32 v145, v129
  v_cvt_pk_bf16_f32 v167, v158, v159
  v_exp_f32 v146, v130
  v_exp_f32 v147, v131
  v_mfma_f32_32x32x16_bf16 v[112:127], v[68:71], v[36:39], v[112:127]
  v_exp_f32 v148, v132
  v_cvt_pk_bf16_f32 v160, v144, v145
  v_exp_f32 v149, v133
  v_cvt_pk_bf16_f32 v161, v146, v147
  v_exp_f32 v150, v134
  v_exp_f32 v151, v135
  v_mfma_f32_32x32x16_bf16 v[168:183], v[76:79], v[164:167], v[168:183]
  v_exp_f32 v152, v136
  v_cvt_pk_bf16_f32 v162, v148, v149
  v_exp_f32 v153, v137
  v_cvt_pk_bf16_f32 v163, v150, v151
  v_exp_f32 v154, v138
  v_exp_f32 v155, v139
  v_mfma_f32_32x32x16_bf16 v[184:199], v[72:75], v[160:163], v[184:199]
  v_exp_f32 v156, v140
  v_cvt_pk_bf16_f32 v164, v152, v153
  v_exp_f32 v157, v141
  v_cvt_pk_bf16_f32 v165, v154, v155
  v_exp_f32 v158, v142
  v_exp_f32 v159, v143
  v_mfma_f32_32x32x16_bf16 v[128:143], v[64:67], v[40:43], 0
  v_exp_f32 v144, v112
  v_cvt_pk_bf16_f32 v166, v156, v157
  v_exp_f32 v145, v113
  v_cvt_pk_bf16_f32 v167, v158, v159
  v_exp_f32 v146, v114
  s_add_u32 s100, s100, 4096
  buffer_load_dwordx4 a[108:111], v9, s[16:19], s100 offen offset:0 sc1
  v_exp_f32 v147, v115
  v_mfma_f32_32x32x16_bf16 v[128:143], v[68:71], v[44:47], v[128:143]
  v_exp_f32 v148, v116
  v_cvt_pk_bf16_f32 v160, v144, v145
  v_exp_f32 v149, v117
  v_cvt_pk_bf16_f32 v161, v146, v147
  v_exp_f32 v150, v118
  v_exp_f32 v151, v119
  v_mfma_f32_32x32x16_bf16 v[184:199], v[76:79], v[164:167], v[184:199]
  v_exp_f32 v152, v120
  v_cvt_pk_bf16_f32 v162, v148, v149
  v_exp_f32 v153, v121
  v_cvt_pk_bf16_f32 v163, v150, v151
  v_exp_f32 v154, v122
  v_exp_f32 v155, v123
  v_mfma_f32_32x32x16_bf16 v[200:215], v[72:75], v[160:163], v[200:215]
  v_exp_f32 v156, v124
  v_cvt_pk_bf16_f32 v164, v152, v153
  v_exp_f32 v157, v125
  v_cvt_pk_bf16_f32 v165, v154, v155
  v_exp_f32 v158, v126
  v_exp_f32 v159, v127
  s_waitcnt vmcnt(9)
  v_mfma_f32_32x32x16_bf16 v[112:127], v[80:83], v[16:19], 0
  v_exp_f32 v144, v128
  v_cvt_pk_bf16_f32 v166, v156, v157
  v_exp_f32 v145, v129
  v_cvt_pk_bf16_f32 v167, v158, v159
  v_exp_f32 v146, v130
  v_exp_f32 v147, v131
  v_mfma_f32_32x32x16_bf16 v[112:127], v[84:87], v[20:23], v[112:127]
  v_exp_f32 v148, v132
  v_cvt_pk_bf16_f32 v160, v144, v145
  v_exp_f32 v149, v133
  v_cvt_pk_bf16_f32 v161, v146, v147
  v_exp_f32 v150, v134
  v_exp_f32 v151, v135
  v_mfma_f32_32x32x16_bf16 v[200:215], v[76:79], v[164:167], v[200:215]
  v_exp_f32 v152, v136
  v_cvt_pk_bf16_f32 v162, v148, v149
  v_exp_f32 v153, v137
  v_cvt_pk_bf16_f32 v163, v150, v151
  v_exp_f32 v154, v138
  v_exp_f32 v155, v139
  v_mfma_f32_32x32x16_bf16 v[216:231], v[72:75], v[160:163], v[216:231]
  v_exp_f32 v156, v140
  v_cvt_pk_bf16_f32 v164, v152, v153
  v_exp_f32 v157, v141
  v_cvt_pk_bf16_f32 v165, v154, v155
  v_exp_f32 v158, v142
  v_exp_f32 v159, v143
  v_mfma_f32_32x32x16_bf16 v[128:143], v[80:83], v[24:27], 0
  s_add_u32 s28, s3, 1
  s_and_b32 s28, s28, 3
  s_mul_i32 s28, s28, 12288
  s_add_u32 s28, s28, 114688
  v_add_u32 v10, s28, v9
  s_add_u32 s28, s3, 2
  s_and_b32 s28, s28, 3
  s_mul_i32 s28, s28, 12288
  s_add_u32 s28, s28, 114688
  v_add_u32 v11, s28, v9
  s_add_u32 s28, s3, 3
  s_and_b32 s28, s28, 3
  s_mul_i32 s28, s28, 12288
  s_add_u32 s28, s28, 114688
  v_add_u32 v12, s28, v9
  s_add_u32 s28, s3, 4
  s_and_b32 s28, s28, 3
  s_mul_i32 s28, s28, 12288
  s_add_u32 s28, s28, 114688
  v_add_u32 v13, s28, v9
  v_exp_f32 v144, v112
  v_cvt_pk_bf16_f32 v166, v156, v157
  v_exp_f32 v145, v113
  v_cvt_pk_bf16_f32 v167, v158, v159
  v_exp_f32 v146, v114
  v_exp_f32 v147, v115
  v_mfma_f32_32x32x16_bf16 v[128:143], v[84:87], v[28:31], v[128:143]
  v_exp_f32 v148, v116
  v_cvt_pk_bf16_f32 v160, v144, v145
  v_exp_f32 v149, v117
  v_cvt_pk_bf16_f32 v161, v146, v147
  v_exp_f32 v150, v118
  v_exp_f32 v151, v119
  v_mfma_f32_32x32x16_bf16 v[216:231], v[76:79], v[164:167], v[216:231]
  v_exp_f32 v152, v120
  v_cvt_pk_bf16_f32 v162, v148, v149
  v_exp_f32 v153, v121
  v_cvt_pk_bf16_f32 v163, v150, v151
  v_exp_f32 v154, v122
  v_exp_f32 v155, v123
  v_mfma_f32_32x32x16_bf16 v[168:183], v[88:91], v[160:163], v[168:183]
  v_exp_f32 v156, v124
  v_cvt_pk_bf16_f32 v164, v152, v153
  v_exp_f32 v157, v125
  v_cvt_pk_bf16_f32 v165, v154, v155
  v_exp_f32 v158, v126
  v_exp_f32 v159, v127
  v_mfma_f32_32x32x16_bf16 v[112:127], v[80:83], v[32:35], 0
  v_exp_f32 v144, v128
  v_cvt_pk_bf16_f32 v166, v156, v157
  v_exp_f32 v145, v129
  v_cvt_pk_bf16_f32 v167, v158, v159
  v_exp_f32 v146, v130
  v_exp_f32 v147, v131
  v_mfma_f32_32x32x16_bf16 v[112:127], v[84:87], v[36:39], v[112:127]
  v_exp_f32 v148, v132
  v_cvt_pk_bf16_f32 v160, v144, v145
  v_exp_f32 v149, v133
  v_cvt_pk_bf16_f32 v161, v146, v147
  v_exp_f32 v150, v134
  v_exp_f32 v151, v135
  v_mfma_f32_32x32x16_bf16 v[168:183], v[92:95], v[164:167], v[168:183]
  v_exp_f32 v152, v136
  v_cvt_pk_bf16_f32 v162, v148, v149
  v_exp_f32 v153, v137
  v_cvt_pk_bf16_f32 v163, v150, v151
  v_exp_f32 v154, v138
  v_exp_f32 v155, v139
  v_mfma_f32_32x32x16_bf16 v[184:199], v[88:91], v[160:163], v[184:199]
  v_exp_f32 v156, v140
  v_cvt_pk_bf16_f32 v164, v152, v153
  v_exp_f32 v157, v141
  v_cvt_pk_bf16_f32 v165, v154, v155
  v_exp_f32 v158, v142
  v_exp_f32 v159, v143
  v_mfma_f32_32x32x16_bf16 v[128:143], v[80:83], v[40:43], 0
  v_exp_f32 v144, v112
  v_cvt_pk_bf16_f32 v166, v156, v157
  v_exp_f32 v145, v113
  v_cvt_pk_bf16_f32 v167, v158, v159
  v_exp_f32 v146, v114
  v_exp_f32 v147, v115
  v_mfma_f32_32x32x16_bf16 v[128:143], v[84:87], v[44:47], v[128:143]
  v_exp_f32 v148, v116
  v_cvt_pk_bf16_f32 v160, v144, v145
  v_exp_f32 v149, v117
  v_cvt_pk_bf16_f32 v161, v146, v147
  v_exp_f32 v150, v118
  v_exp_f32 v151, v119
  v_mfma_f32_32x32x16_bf16 v[184:199], v[92:95], v[164:167], v[184:199]
  v_exp_f32 v152, v120
  v_cvt_pk_bf16_f32 v162, v148, v149
  v_exp_f32 v153, v121
  v_cvt_pk_bf16_f32 v163, v150, v151
  v_exp_f32 v154, v122
  v_exp_f32 v155, v123
  v_mfma_f32_32x32x16_bf16 v[200:215], v[88:91], v[160:163], v[200:215]
  v_exp_f32 v156, v124
  v_cvt_pk_bf16_f32 v164, v152, v153
  v_exp_f32 v157, v125
  v_cvt_pk_bf16_f32 v165, v154, v155
  v_exp_f32 v158, v126
  v_exp_f32 v159, v127
  s_waitcnt vmcnt(3)
  v_mfma_f32_32x32x16_bf16 v[112:127], v[96:99], v[16:19], 0
  v_exp_f32 v144, v128
  v_cvt_pk_bf16_f32 v166, v156, v157
  v_exp_f32 v145, v129
  v_cvt_pk_bf16_f32 v167, v158, v159
  v_exp_f32 v146, v130
  v_exp_f32 v147, v131
  v_mfma_f32_32x32x16_bf16 v[112:127], v[100:103], v[20:23], v[112:127]
  v_exp_f32 v148, v132
  v_cvt_pk_bf16_f32 v160, v144, v145
  v_exp_f32 v149, v133
  v_cvt_pk_bf16_f32 v161, v146, v147
  v_exp_f32 v150, v134
  v_exp_f32 v151, v135
  v_mfma_f32_32x32x16_bf16 v[200:215], v[92:95], v[164:167], v[200:215]
  v_exp_f32 v152, v136
  v_cvt_pk_bf16_f32 v162, v148, v149
  v_exp_f32 v153, v137
  v_cvt_pk_bf16_f32 v163, v150, v151
  v_exp_f32 v154, v138
  v_exp_f32 v155, v139
  v_mfma_f32_32x32x16_bf16 v[216:231], v[88:91], v[160:163], v[216:231]
  v_exp_f32 v156, v140
  v_cvt_pk_bf16_f32 v164, v152, v153
  v_exp_f32 v157, v141
  v_cvt_pk_bf16_f32 v165, v154, v155
  v_exp_f32 v158, v142
  v_exp_f32 v159, v143
  v_mfma_f32_32x32x16_bf16 v[128:143], v[96:99], v[24:27], 0
  v_exp_f32 v144, v112
  v_cvt_pk_bf16_f32 v166, v156, v157
  v_exp_f32 v145, v113
  v_cvt_pk_bf16_f32 v167, v158, v159
  v_exp_f32 v146, v114
  v_exp_f32 v147, v115
  v_mfma_f32_32x32x16_bf16 v[128:143], v[100:103], v[28:31], v[128:143]
  v_exp_f32 v148, v116
  v_cvt_pk_bf16_f32 v160, v144, v145
  v_exp_f32 v149, v117
  v_cvt_pk_bf16_f32 v161, v146, v147
  v_exp_f32 v150, v118
  v_exp_f32 v151, v119
  v_mfma_f32_32x32x16_bf16 v[216:231], v[92:95], v[164:167], v[216:231]
  v_exp_f32 v152, v120
  v_cvt_pk_bf16_f32 v162, v148, v149
  v_exp_f32 v153, v121
  v_cvt_pk_bf16_f32 v163, v150, v151
  v_exp_f32 v154, v122
  v_exp_f32 v155, v123
  v_mfma_f32_32x32x16_bf16 v[168:183], v[104:107], v[160:163], v[168:183]
  v_exp_f32 v156, v124
  v_cvt_pk_bf16_f32 v164, v152, v153
  v_exp_f32 v157, v125
  v_cvt_pk_bf16_f32 v165, v154, v155
  v_exp_f32 v158, v126
  v_exp_f32 v159, v127
  v_mfma_f32_32x32x16_bf16 v[112:127], v[96:99], v[32:35], 0
  v_exp_f32 v144, v128
  v_cvt_pk_bf16_f32 v166, v156, v157
  v_exp_f32 v145, v129
  v_cvt_pk_bf16_f32 v167, v158, v159
  v_exp_f32 v146, v130
  v_exp_f32 v147, v131
  v_mfma_f32_32x32x16_bf16 v[112:127], v[100:103], v[36:39], v[112:127]
  v_exp_f32 v148, v132
  v_cvt_pk_bf16_f32 v160, v144, v145
  v_exp_f32 v149, v133
  v_cvt_pk_bf16_f32 v161, v146, v147
  v_exp_f32 v150, v134
  v_exp_f32 v151, v135
  v_mfma_f32_32x32x16_bf16 v[168:183], v[108:111], v[164:167], v[168:183]
  v_exp_f32 v152, v136
  v_cvt_pk_bf16_f32 v162, v148, v149
  v_exp_f32 v153, v137
  v_cvt_pk_bf16_f32 v163, v150, v151
  v_exp_f32 v154, v138
  v_exp_f32 v155, v139
  v_mfma_f32_32x32x16_bf16 v[184:199], v[104:107], v[160:163], v[184:199]
  v_exp_f32 v156, v140
  v_cvt_pk_bf16_f32 v164, v152, v153
  v_exp_f32 v157, v141
  v_cvt_pk_bf16_f32 v165, v154, v155
  v_exp_f32 v158, v142
  v_exp_f32 v159, v143
  v_mfma_f32_32x32x16_bf16 v[128:143], v[96:99], v[40:43], 0
  v_exp_f32 v144, v112
  v_cvt_pk_bf16_f32 v166, v156, v157
  v_exp_f32 v145, v113
  v_cvt_pk_bf16_f32 v167, v158, v159
  v_exp_f32 v146, v114
  v_exp_f32 v147, v115
  v_mfma_f32_32x32x16_bf16 v[128:143], v[100:103], v[44:47], v[128:143]
  v_exp_f32 v148, v116
  v_cvt_pk_bf16_f32 v160, v144, v145
  v_exp_f32 v149, v117
  v_cvt_pk_bf16_f32 v161, v146, v147
  v_exp_f32 v150, v118
  v_exp_f32 v151, v119
  v_mfma_f32_32x32x16_bf16 v[184:199], v[108:111], v[164:167], v[184:199]
  v_exp_f32 v152, v120
  v_cvt_pk_bf16_f32 v162, v148, v149
  v_exp_f32 v153, v121
  v_cvt_pk_bf16_f32 v163, v150, v151
  v_exp_f32 v154, v122
  v_exp_f32 v155, v123
  v_mfma_f32_32x32x16_bf16 v[200:215], v[104:107], v[160:163], v[200:215]
  v_exp_f32 v156, v124
  v_cvt_pk_bf16_f32 v164, v152, v153
  v_exp_f32 v157, v125
  ds_write_b128 v10, v[168:171] offset:0
  v_cvt_pk_bf16_f32 v165, v154, v155
  v_exp_f32 v158, v126
  ds_write_b128 v10, v[172:175] offset:1024
  v_exp_f32 v159, v127
  v_exp_f32 v144, v128
  v_cvt_pk_bf16_f32 v166, v156, v157
  v_exp_f32 v145, v129
  v_cvt_pk_bf16_f32 v167, v158, v159
  v_exp_f32 v146, v130
  ds_write_b128 v10, v[176:179] offset:2048
  ds_write_b128 v10, v[180:183] offset:3072
  v_exp_f32 v147, v131
  v_exp_f32 v148, v132
  v_cvt_pk_bf16_f32 v160, v144, v145
  v_exp_f32 v149, v133
  v_cvt_pk_bf16_f32 v161, v146, v147
  v_exp_f32 v150, v134
  v_exp_f32 v151, v135
  v_mfma_f32_32x32x16_bf16 v[200:215], v[108:111], v[164:167], v[200:215]
  v_exp_f32 v152, v136
  v_cvt_pk_bf16_f32 v162, v148, v149
  v_exp_f32 v153, v137
  v_cvt_pk_bf16_f32 v163, v150, v151
  v_exp_f32 v154, v138
  v_exp_f32 v155, v139
  v_mfma_f32_32x32x16_bf16 v[216:231], v[104:107], v[160:163], v[216:231]
  v_exp_f32 v156, v140
  v_cvt_pk_bf16_f32 v164, v152, v153
  v_exp_f32 v157, v141
  ds_write_b128 v11, v[184:187] offset:4096
  v_cvt_pk_bf16_f32 v165, v154, v155
  v_exp_f32 v158, v142
  ds_write_b128 v11, v[188:191] offset:5120
  v_exp_f32 v159, v143
  v_cvt_pk_bf16_f32 v166, v156, v157
  v_cvt_pk_bf16_f32 v167, v158, v159
  ds_write_b128 v11, v[192:195] offset:6144
  ds_write_b128 v11, v[196:199] offset:7168
  v_mfma_f32_32x32x16_bf16 v[216:231], v[108:111], v[164:167], v[216:231]
  ds_write_b128 v12, v[200:203] offset:8192
  ds_write_b128 v12, v[204:207] offset:9216
  ds_write_b128 v12, v[208:211] offset:10240
  ds_write_b128 v12, v[212:215] offset:11264
  s_mov_b32 s27, s8
  s_waitcnt lgkmcnt(0)
  s_barrier
  ds_read_b128 v[168:171], v13 offset:0
  ds_read_b128 v[172:175], v13 offset:1024
  ds_read_b128 v[176:179], v13 offset:2048
  ds_read_b128 v[180:183], v13 offset:3072
  ds_read_b128 v[184:187], v13 offset:4096
  ds_read_b128 v[188:191], v13 offset:5120
  ds_read_b128 v[192:195], v13 offset:6144
  ds_read_b128 v[196:199], v13 offset:7168
  ds_read_b128 v[200:203], v13 offset:8192
  ds_read_b128 v[204:207], v13 offset:9216
  ds_read_b128 v[208:211], v13 offset:10240
  ds_read_b128 v[212:215], v13 offset:11264
  s_waitcnt lgkmcnt(8)
  v_pk_add_f32 v[216:217], v[216:217], v[168:169]
  v_pk_add_f32 v[218:219], v[218:219], v[170:171]
  v_pk_add_f32 v[220:221], v[220:221], v[172:173]
  v_pk_add_f32 v[222:223], v[222:223], v[174:175]
  v_pk_add_f32 v[224:225], v[224:225], v[176:177]
  v_pk_add_f32 v[226:227], v[226:227], v[178:179]
  v_pk_add_f32 v[228:229], v[228:229], v[180:181]
  v_pk_add_f32 v[230:231], v[230:231], v[182:183]
  s_waitcnt lgkmcnt(4)
  v_pk_add_f32 v[216:217], v[216:217], v[184:185]
  v_pk_add_f32 v[218:219], v[218:219], v[186:187]
  v_pk_add_f32 v[220:221], v[220:221], v[188:189]
  v_pk_add_f32 v[222:223], v[222:223], v[190:191]
  v_pk_add_f32 v[224:225], v[224:225], v[192:193]
  v_pk_add_f32 v[226:227], v[226:227], v[194:195]
  v_pk_add_f32 v[228:229], v[228:229], v[196:197]
  v_pk_add_f32 v[230:231], v[230:231], v[198:199]
  s_waitcnt lgkmcnt(0)
  v_pk_add_f32 v[228:229], v[228:229], v[212:213]
  v_mov_b32 v11, v228
  v_mov_b32 v12, v228
  v_pk_add_f32 v[216:217], v[216:217], v[200:201]
  v_pk_add_f32 v[218:219], v[218:219], v[202:203]
  v_permlane32_swap_b32 v11, v12
  v_pk_add_f32 v[220:221], v[220:221], v[204:205]
  v_pk_add_f32 v[222:223], v[222:223], v[206:207]
  v_rcp_f32 v12, v12
  v_pk_add_f32 v[224:225], v[224:225], v[208:209]
  v_pk_add_f32 v[226:227], v[226:227], v[210:211]
  v_pk_add_f32 v[230:231], v[230:231], v[214:215]
  v_pk_mul_f32 v[216:217], v[216:217], v[12:13] op_sel_hi:[1,0]
  v_cvt_pk_bf16_f32 v160, v216, v217
  v_pk_mul_f32 v[218:219], v[218:219], v[12:13] op_sel_hi:[1,0]
  v_cvt_pk_bf16_f32 v161, v218, v219
  v_pk_mul_f32 v[220:221], v[220:221], v[12:13] op_sel_hi:[1,0]
  v_cvt_pk_bf16_f32 v162, v220, v221
  v_pk_mul_f32 v[222:223], v[222:223], v[12:13] op_sel_hi:[1,0]
  v_cvt_pk_bf16_f32 v163, v222, v223
  v_pk_mul_f32 v[224:225], v[224:225], v[12:13] op_sel_hi:[1,0]
  v_cvt_pk_bf16_f32 v164, v224, v225
  v_pk_mul_f32 v[226:227], v[226:227], v[12:13] op_sel_hi:[1,0]
  v_cvt_pk_bf16_f32 v165, v226, v227
  v_pk_mul_f32 v[228:229], v[228:229], v[12:13] op_sel_hi:[1,0]
  v_cvt_pk_bf16_f32 v166, v228, v229
  v_pk_mul_f32 v[230:231], v[230:231], v[12:13] op_sel_hi:[1,0]
  v_cvt_pk_bf16_f32 v167, v230, v231
  v_cndmask_b32 v166, v166, 0, s[62:63]
  v_cndmask_b32 v167, v167, 0, s[62:63]
  s_cmp_eq_u32 s61, 0
  s_cbranch_scc1 S35
  buffer_store_dwordx4 v[160:163], v9, s[16:19], s27 offen
  buffer_store_dwordx4 v[164:167], v9, s[16:19], s27 offen offset:1024
S35b:
  s_barrier
  s_lshr_b32 s11, s2, 3
  s_mul_i32 s26, s11, 9363
  s_lshr_b32 s26, s26, 16
  s_mul_i32 s27, s26, 7
  s_sub_u32 s25, s11, s27
  s_min_u32 s26, s26, 3
  s_and_b32 s24, s2, 7
  s_lshl_b32 s24, s24, 2
  s_add_u32 s24, s24, s26
  s_lshr_b32 s26, s3, 1
  s_and_b32 s27, s3, 1
  s_lshl_b32 s24, s24, 1
  s_lshl_b32 s25, s25, 1
  s_add_u32 s24, s24, s26
  s_add_u32 s25, s25, s27
  s_xor_b32 s26, s24, 1
  s_xor_b32 s27, s25, 1
  s_and_b32 s36, s24, 6
  v_bfe_u32 v10, v2, 2, 1
  v_add_u32 v10, s36, v10
  v_lshl_add_u32 v11, v10, 2, s3
  v_and_b32 v10, 3, v2
  s_and_b32 s38, s2, 7
  s_lshl_b32 s38, s38, 10
  v_lshl_add_u32 v14, v11, 2, v10
  v_lshl_add_u32 v14, v14, 3, s38
  s_lshl_b32 s36, s3, 3
  s_lshl_b32 s30, s24, 5
  s_lshl_b32 s31, s26, 5
  s_add_u32 s30, s30, s36
  s_add_u32 s31, s31, s36
  s_lshl_b32 s30, s30, 10
  s_lshl_b32 s31, s31, 10
  s_add_u32 s36, 0, 5869568
  s_add_u32 s30, s30, s36
  s_add_u32 s31, s31, s36
  s_xor_b32 s39, s3, 0
  s_mul_i32 s39, s39, 12288
  s_add_u32 s39, s39, 114688
  v_add_u32 v10, s39, v9
  s_xor_b32 s39, s3, 1
  s_mul_i32 s39, s39, 12288
  s_add_u32 s39, s39, 114688
  v_add_u32 v11, s39, v9
  s_xor_b32 s39, s3, 2
  s_mul_i32 s39, s39, 12288
  s_add_u32 s39, s39, 114688
  v_add_u32 v12, s39, v9
  s_xor_b32 s39, s3, 3
  s_mul_i32 s39, s39, 12288
  s_add_u32 s39, s39, 114688
  v_add_u32 v13, s39, v9
  s_add_u32 s38, s9, 21577728
  s_add_u32 s38, s38, s15
  v_mov_b32 v6, s14
  v_mov_b32 v7, 0
  v_mov_b32 v1, 0
  s_waitcnt vmcnt(0)
  s_mov_b64 exec, 1
  s_cmp_eq_u32 s61, 0
  s_cbranch_scc1 S36
  buffer_store_dwordx2 v[6:7], v1, s[16:19], s38 offen
S36b:
  s_mov_b64 exec, -1
  s_cmp_ge_u32 s11, 28
  s_cbranch_scc1 O_skip1
  s_mov_b32 s39, 200000
W37:
  s_add_u32 s38, s15, 21577728
  buffer_load_dwordx2 v[16:17], v14, s[16:19], s38 offen sc1
  s_waitcnt vmcnt(0)
  v_cmp_ne_u32 vcc, s14, v16
  s_nop 1
  s_cmp_eq_u64 vcc, 0
  s_cbranch_scc1 Wd38
  s_sub_u32 s39, s39, 1
  s_cmp_lg_u32 s39, 0
  s_cbranch_scc1 W37
Wd38:
  buffer_load_dwordx4 v[80:83], v9, s[16:19], s30 offen offset:0 sc1
  buffer_load_dwordx4 v[84:87], v9, s[16:19], s31 offen offset:0 sc1
  buffer_load_dwordx4 v[88:91], v9, s[16:19], s30 offen offset:1024 sc1
  buffer_load_dwordx4 v[92:95], v9, s[16:19], s31 offen offset:1024 sc1
  buffer_load_dwordx4 v[96:99], v9, s[16:19], s30 offen offset:2048 sc1
  buffer_load_dwordx4 v[100:103], v9, s[16:19], s31 offen offset:2048 sc1
  buffer_load_dwordx4 v[104:107], v9, s[16:19], s30 offen offset:3072 sc1
  buffer_load_dwordx4 v[108:111], v9, s[16:19], s31 offen offset:3072 sc1
  s_add_u32 s30, s30, 4096
  buffer_load_dwordx4 v[112:115], v9, s[16:19], s30 offen offset:0 sc1
  s_add_u32 s31, s31, 4096
  buffer_load_dwordx4 v[116:119], v9, s[16:19], s31 offen offset:0 sc1
  buffer_load_dwordx4 v[120:123], v9, s[16:19], s30 offen offset:1024 sc1
  buffer_load_dwordx4 v[124:127], v9, s[16:19], s31 offen offset:1024 sc1
  buffer_load_dwordx4 v[128:131], v9, s[16:19], s30 offen offset:2048 sc1
  buffer_load_dwordx4 v[132:135], v9, s[16:19], s31 offen offset:2048 sc1
  buffer_load_dwordx4 v[136:139], v9, s[16:19], s30 offen offset:3072 sc1
  buffer_load_dwordx4 v[140:143], v9, s[16:19], s31 offen offset:3072 sc1
  s_waitcnt vmcnt(15)
  v_mfma_f32_32x32x16_bf16 v[16:31], a[0:3], v[80:83], 0
  v_mfma_f32_32x32x16_bf16 v[32:47], a[4:7], v[80:83], 0
  s_waitcnt vmcnt(14)
  v_mfma_f32_32x32x16_bf16 v[48:63], a[0:3], v[84:87], 0
  v_mfma_f32_32x32x16_bf16 v[64:79], a[4:7], v[84:87], 0
  s_waitcnt vmcnt(13)
  v_mfma_f32_32x32x16_bf16 v[16:31], a[8:11], v[88:91], v[16:31]
  v_mfma_f32_32x32x16_bf16 v[32:47], a[12:15], v[88:91], v[32:47]
  s_waitcnt vmcnt(12)
  v_mfma_f32_32x32x16_bf16 v[48:63], a[8:11], v[92:95], v[48:63]
  v_mfma_f32_32x32x16_bf16 v[64:79], a[12:15], v[92:95], v[64:79]
  s_waitcnt vmcnt(11)
  v_mfma_f32_32x32x16_bf16 v[16:31], a[16:19], v[96:99], v[16:31]
  v_mfma_f32_32x32x16_bf16 v[32:47], a[20:23], v[96:99], v[32:47]
  s_waitcnt vmcnt(10)
  v_mfma_f32_32x32x16_bf16 v[48:63], a[16:19], v[100:103], v[48:63]
  v_mfma_f32_32x32x16_bf16 v[64:79], a[20:23], v[100:103], v[64:79]
  s_waitcnt vmcnt(9)
  v_mfma_f32_32x32x16_bf16 v[16:31], a[24:27], v[104:107], v[16:31]
  v_mfma_f32_32x32x16_bf16 v[32:47], a[28:31], v[104:107], v[32:47]
  s_waitcnt vmcnt(8)
  v_mfma_f32_32x32x16_bf16 v[48:63], a[24:27], v[108:111], v[48:63]
  v_mfma_f32_32x32x16_bf16 v[64:79], a[28:31], v[108:111], v[64:79]
  s_waitcnt vmcnt(7)
  v_mfma_f32_32x32x16_bf16 v[16:31], a[32:35], v[112:115], v[16:31]
  v_mfma_f32_32x32x16_bf16 v[32:47], a[36:39], v[112:115], v[32:47]
  s_waitcnt vmcnt(6)
  v_mfma_f32_32x32x16_bf16 v[48:63], a[32:35], v[116:119], v[48:63]
  v_mfma_f32_32x32x16_bf16 v[64:79], a[36:39], v[116:119], v[64:79]
  s_waitcnt vmcnt(5)
  v_mfma_f32_32x32x16_bf16 v[16:31], a[40:43], v[120:123], v[16:31]
  v_mfma_f32_32x32x16_bf16 v[32:47], a[44:47], v[120:123], v[32:47]
  s_waitcnt vmcnt(4)
  v_mfma_f32_32x32x16_bf16 v[48:63], a[40:43], v[124:127], v[48:63]
  v_mfma_f32_32x32x16_bf16 v[64:79], a[44:47], v[124:127], v[64:79]
  s_waitcnt vmcnt(3)
  v_mfma_f32_32x32x16_bf16 v[16:31], a[48:51], v[128:131], v[16:31]
  v_mfma_f32_32x32x16_bf16 v[32:47], a[52:55], v[128:131], v[32:47]
  s_waitcnt vmcnt(2)
  v_mfma_f32_32x32x16_bf16 v[48:63], a[48:51], v[132:135], v[48:63]
  v_mfma_f32_32x32x16_bf16 v[64:79], a[52:55], v[132:135], v[64:79]
  s_waitcnt vmcnt(1)
  v_mfma_f32_32x32x16_bf16 v[16:31], a[56:59], v[136:139], v[16:31]
  v_mfma_f32_32x32x16_bf16 v[32:47], a[60:63], v[136:139], v[32:47]
  s_waitcnt vmcnt(0)
  v_mfma_f32_32x32x16_bf16 v[48:63], a[56:59], v[140:143], v[48:63]
  v_mfma_f32_32x32x16_bf16 v[64:79], a[60:63], v[140:143], v[64:79]
  s_nop 3
  ds_write_b128 v11, v[32:35] offset:0
  ds_write_b128 v11, v[36:39] offset:1024
  ds_write_b128 v11, v[40:43] offset:2048
  ds_write_b128 v11, v[44:47] offset:3072
  ds_write_b128 v12, v[48:51] offset:4096
  ds_write_b128 v12, v[52:55] offset:5120
  ds_write_b128 v12, v[56:59] offset:6144
  ds_write_b128 v12, v[60:63] offset:7168
  s_nop 7
  ds_write_b128 v13, v[64:67] offset:8192
  ds_write_b128 v13, v[68:71] offset:9216
  ds_write_b128 v13, v[72:75] offset:10240
  ds_write_b128 v13, v[76:79] offset:11264
  v_accvgpr_read_b32 v14, a248
  v_lshlrev_b32 v15, 16, v14
  v_and_b32 v14, 0xffff0000, v14
  v_pk_add_f32 v[80:81], v[16:17], v[14:15] op_sel:[0,1] op_sel_hi:[1,0]
  v_accvgpr_read_b32 v14, a249
  v_lshlrev_b32 v15, 16, v14
  v_and_b32 v14, 0xffff0000, v14
  v_pk_add_f32 v[82:83], v[18:19], v[14:15] op_sel:[0,1] op_sel_hi:[1,0]
  v_accvgpr_read_b32 v14, a250
  v_lshlrev_b32 v15, 16, v14
  v_and_b32 v14, 0xffff0000, v14
  v_pk_add_f32 v[84:85], v[20:21], v[14:15] op_sel:[0,1] op_sel_hi:[1,0]
  v_accvgpr_read_b32 v14, a251
  v_lshlrev_b32 v15, 16, v14
  v_and_b32 v14, 0xffff0000, v14
  v_pk_add_f32 v[86:87], v[22:23], v[14:15] op_sel:[0,1] op_sel_hi:[1,0]
  v_accvgpr_read_b32 v14, a252
  v_lshlrev_b32 v15, 16, v14
  v_and_b32 v14, 0xffff0000, v14
  v_pk_add_f32 v[88:89], v[24:25], v[14:15] op_sel:[0,1] op_sel_hi:[1,0]
  v_accvgpr_read_b32 v14, a253
  v_lshlrev_b32 v15, 16, v14
  v_and_b32 v14, 0xffff0000, v14
  v_pk_add_f32 v[90:91], v[26:27], v[14:15] op_sel:[0,1] op_sel_hi:[1,0]
  v_accvgpr_read_b32 v14, a254
  v_lshlrev_b32 v15, 16, v14
  v_and_b32 v14, 0xffff0000, v14
  v_pk_add_f32 v[92:93], v[28:29], v[14:15] op_sel:[0,1] op_sel_hi:[1,0]
  v_accvgpr_read_b32 v14, a255
  v_lshlrev_b32 v15, 16, v14
  v_and_b32 v14, 0xffff0000, v14
  v_pk_add_f32 v[94:95], v[30:31], v[14:15] op_sel:[0,1] op_sel_hi:[1,0]
  s_waitcnt lgkmcnt(0)
  s_barrier
  ds_read_b128 v[96:99], v10 offset:0
  ds_read_b128 v[100:103], v10 offset:1024
  ds_read_b128 v[104:107], v10 offset:2048
  ds_read_b128 v[108:111], v10 offset:3072
  ds_read_b128 v[112:115], v10 offset:4096
  ds_read_b128 v[116:119], v10 offset:5120
  ds_read_b128 v[120:123], v10 offset:6144
  ds_read_b128 v[124:127], v10 offset:7168
  ds_read_b128 v[128:131], v10 offset:8192
  ds_read_b128 v[132:135], v10 offset:9216
  ds_read_b128 v[136:139], v10 offset:10240
  ds_read_b128 v[140:143], v10 offset:11264
  s_waitcnt lgkmcnt(8)
  v_pk_add_f32 v[80:81], v[80:81], v[96:97]
  v_pk_add_f32 v[82:83], v[82:83], v[98:99]
  v_pk_add_f32 v[84:85], v[84:85], v[100:101]
  v_pk_add_f32 v[86:87], v[86:87], v[102:103]
  v_pk_add_f32 v[88:89], v[88:89], v[104:105]
  v_pk_add_f32 v[90:91], v[90:91], v[106:107]
  v_pk_add_f32 v[92:93], v[92:93], v[108:109]
  v_pk_add_f32 v[94:95], v[94:95], v[110:111]
  s_waitcnt lgkmcnt(4)
  v_pk_add_f32 v[80:81], v[80:81], v[112:113]
  v_pk_add_f32 v[82:83], v[82:83], v[114:115]
  v_pk_add_f32 v[84:85], v[84:85], v[116:117]
  v_pk_add_f32 v[86:87], v[86:87], v[118:119]
  v_pk_add_f32 v[88:89], v[88:89], v[120:121]
  v_pk_add_f32 v[90:91], v[90:91], v[122:123]
  v_pk_add_f32 v[92:93], v[92:93], v[124:125]
  v_pk_add_f32 v[94:95], v[94:95], v[126:127]
  s_waitcnt lgkmcnt(0)
  v_pk_add_f32 v[80:81], v[80:81], v[128:129]
  v_pk_add_f32 v[82:83], v[82:83], v[130:131]
  v_pk_add_f32 v[84:85], v[84:85], v[132:133]
  v_pk_add_f32 v[86:87], v[86:87], v[134:135]
  v_pk_add_f32 v[88:89], v[88:89], v[136:137]
  v_pk_add_f32 v[90:91], v[90:91], v[138:139]
  v_pk_add_f32 v[92:93], v[92:93], v[140:141]
  v_pk_add_f32 v[94:95], v[94:95], v[142:143]
  v_cvt_pk_bf16_f32 v96, v80, v81
  v_cvt_pk_bf16_f32 v97, v82, v83
  v_cvt_pk_bf16_f32 v98, v84, v85
  v_cvt_pk_bf16_f32 v99, v86, v87
  v_cvt_pk_bf16_f32 v100, v88, v89
  v_cvt_pk_bf16_f32 v101, v90, v91
  v_cvt_pk_bf16_f32 v102, v92, v93
  v_cvt_pk_bf16_f32 v103, v94, v95
  s_mul_i32 s38, s24, 28
  s_lshl_b32 s39, s25, 1
  s_add_u32 s38, s38, s39
  s_lshl_b32 s38, s38, 10
  s_add_u32 s38, s38, 0
  s_add_u32 s38, s38, 10330112
  s_cmp_eq_u32 s61, 0
  s_cbranch_scc1 S39
  buffer_store_dwordx4 v[96:99], v9, s[16:19], s38 offen offset:0
  buffer_store_dwordx4 v[100:103], v9, s[16:19], s38 offen offset:1024
S39b:
  v_pk_add_f32 v[24:25], v[80:81], v[82:83]
  v_pk_mul_f32 v[26:27], v[80:81], v[80:81]
  v_pk_fma_f32 v[26:27], v[82:83], v[82:83], v[26:27]
  v_pk_add_f32 v[24:25], v[24:25], v[84:85]
  v_pk_fma_f32 v[26:27], v[84:85], v[84:85], v[26:27]
  v_pk_add_f32 v[24:25], v[24:25], v[86:87]
  v_pk_fma_f32 v[26:27], v[86:87], v[86:87], v[26:27]
  v_pk_add_f32 v[24:25], v[24:25], v[88:89]
  v_pk_fma_f32 v[26:27], v[88:89], v[88:89], v[26:27]
  v_pk_add_f32 v[24:25], v[24:25], v[90:91]
  v_pk_fma_f32 v[26:27], v[90:91], v[90:91], v[26:27]
  v_pk_add_f32 v[24:25], v[24:25], v[92:93]
  v_pk_fma_f32 v[26:27], v[92:93], v[92:93], v[26:27]
  v_pk_add_f32 v[24:25], v[24:25], v[94:95]
  v_pk_fma_f32 v[26:27], v[94:95], v[94:95], v[26:27]
  v_add_f32 v24, v24, v25
  v_add_f32 v25, v26, v27
  v_mov_b32 v26, v24
  v_mov_b32 v27, v25
  s_mul_i32 s38, s24, 14
  s_add_u32 s38, s38, s25
  v_permlane32_swap_b32 v24, v26
  v_permlane32_swap_b32 v25, v27
  s_lshl_b32 s38, s38, 8
  s_add_u32 s38, s38, 0
  s_add_u32 s38, s38, 14000128
  v_add_f32 v24, v24, v26
  v_add_f32 v25, v25, v27
  v_lshlrev_b32 v6, 3, v3
  s_cmp_eq_u32 s61, 0
  s_cbranch_scc1 S40
  buffer_store_dwordx2 v[24:25], v6, s[16:19], s38 offen
S40b:
  v_accvgpr_write_b32 a248, v96
  v_accvgpr_write_b32 a249, v97
  v_accvgpr_write_b32 a250, v98
  v_accvgpr_write_b32 a251, v99
  v_accvgpr_write_b32 a252, v100
  v_accvgpr_write_b32 a253, v101
  v_accvgpr_write_b32 a254, v102
  v_accvgpr_write_b32 a255, v103
  s_add_u32 s38, s9, 21585920
  s_add_u32 s38, s38, s15
  v_mov_b32 v10, s14
  v_mov_b32 v11, 0
  v_mov_b32 v1, 0
  s_waitcnt vmcnt(0)
  s_mov_b64 exec, 1
  s_cmp_eq_u32 s61, 0
  s_cbranch_scc1 S41
  buffer_store_dwordx2 v[10:11], v1, s[16:19], s38 offen
S41b:
  s_mov_b64 exec, -1
  s_barrier
O_skip1:
  s_and_b32 s24, s2, 7
  s_lshr_b32 s26, s2, 7
  s_lshl_b32 s26, s26, 2
  s_add_u32 s26, s26, s3
  s_lshl_b32 s24, s24, 3
  s_add_u32 s24, s24, s26
  s_bfe_u32 s25, s2, 0x40003
  s_lshr_b32 s36, s26, 1
  s_mul_i32 s36, s36, 7
  v_min_u32 v10, 13, v2
  v_lshrrev_b32 v11, 1, v10
  v_add_u32 v11, s36, v11
  v_and_b32 v10, 1, v10
  s_and_b32 s36, s26, 1
  s_lshl_b32 s36, s36, 1
  v_add_u32 v10, s36, v10
  s_and_b32 s38, s2, 7
  s_lshl_b32 s38, s38, 10
  v_lshl_add_u32 v14, v11, 2, v10
  v_lshl_add_u32 v14, v14, 3, s38
  s_mul_i32 s26, s24, 28672
  s_add_u32 s26, s26, 0
  s_add_u32 s26, s26, 10330112
  s_mul_i32 s28, s3, 7168
  s_mul_i32 s27, s25, 200704
  s_add_u32 s27, s27, s28
  s_add_u32 s27, s27, 0
  v_mov_b32 v10, v9
  v_add_u32 v11, 57344, v9
  v_add_u32 v12, 114688, v9
  v_mul_u32_u24 v5, 1792, v4
  v_lshl_add_u32 v5, v3, 3, v5
  s_mul_i32 s30, s24, 3584
  s_add_u32 s30, s30, 0
  s_add_u32 s30, s30, 14000128
  s_mul_i32 s31, s25, 7168
  s_add_u32 s31, s31, 3211264
  s_add_u32 s32, s31, 4096
  s_mul_i32 s33, s24, 112
  s_mul_i32 s34, s25, 7
  s_add_u32 s33, s33, s34
  s_lshl_b32 s33, s33, 10
  s_add_u32 s33, s33, 0
  s_add_u32 s33, s33, 14229504
  s_add_u32 s34, s33, 4096
  s_lshr_b32 s36, s2, 3
  s_mul_i32 s37, s36, 9363
  s_lshr_b32 s37, s37, 16
  s_mul_i32 s37, s37, 7
  s_sub_u32 s36, s36, s37
  s_lshl_b32 s36, s36, 1
  s_and_b32 s37, s3, 1
  s_add_u32 s96, s36, s37
  s_xor_b32 s97, s96, 1
  s_mul_i32 s36, s3, 28
  s_mul_i32 s96, s96, 112
  s_add_u32 s96, s96, s36
  s_lshl_b32 s96, s96, 10
  s_add_u32 s96, s96, 3325952
  s_mul_i32 s97, s97, 112
  s_add_u32 s97, s97, s36
  s_lshl_b32 s97, s97, 10
  s_add_u32 s97, s97, 3325952
  s_add_u32 s38, s15, 21585920
  buffer_load_dwordx2 v[16:17], v14, s[16:19], s38 offen sc1
  v_add_u32 v13, s28, v12
  ds_write_b128 v13, a[92:95] offset:0
  ds_write_b128 v13, a[96:99] offset:1024
  ds_write_b128 v13, a[100:103] offset:2048
  ds_write_b128 v13, a[104:107] offset:3072
  ds_write_b128 v13, a[108:111] offset:4096
  v_accvgpr_read_b32 v160, a84
  v_accvgpr_read_b32 v161, a85
  v_accvgpr_read_b32 v162, a86
  v_accvgpr_read_b32 v163, a87
  v_accvgpr_read_b32 v164, a88
  v_accvgpr_read_b32 v165, a89
  v_accvgpr_read_b32 v166, a90
  v_accvgpr_read_b32 v167, a91
  v_accvgpr_read_b32 v168, a72
  v_accvgpr_read_b32 v169, a73
  v_accvgpr_read_b32 v170, a74
  v_accvgpr_read_b32 v171, a75
  v_accvgpr_read_b32 v172, a76
  v_accvgpr_read_b32 v173, a77
  v_accvgpr_read_b32 v174, a78
  v_accvgpr_read_b32 v175, a79
  v_accvgpr_read_b32 v176, a80
  v_accvgpr_read_b32 v177, a81
  v_accvgpr_read_b32 v178, a82
  v_accvgpr_read_b32 v179, a83
  v_accvgpr_read_b32 v180, a64
  v_accvgpr_read_b32 v181, a65
  v_accvgpr_read_b32 v182, a66
  v_accvgpr_read_b32 v183, a67
  v_accvgpr_read_b32 v184, a68
  v_accvgpr_read_b32 v185, a69
  v_accvgpr_read_b32 v186, a70
  v_accvgpr_read_b32 v187, a71
  s_waitcnt lgkmcnt(0)
  ds_read_b128 v[128:131], v10 offset:0
  ds_read_b128 v[132:135], v10 offset:28672
  ds_read_b128 v[136:139], v11 offset:0
  s_mov_b32 s39, 200000
W42:
  s_waitcnt vmcnt(0)
  v_cmp_ne_u32 vcc, s14, v16
  s_nop 1
  s_cmp_eq_u64 vcc, 0
  s_cbranch_scc1 Wd43
  s_add_u32 s38, s15, 21585920
  buffer_load_dwordx2 v[16:17], v14, s[16:19], s38 offen sc1
  s_sub_u32 s39, s39, 1
  s_cmp_lg_u32 s39, 0
  s_cbranch_scc1 W42
Wd43:
  buffer_load_dwordx4 a[0:3], v9, s[16:19], s26 offen offset:0 sc1
  buffer_load_dwordx4 a[4:7], v9, s[16:19], s26 offen offset:1024 sc1
  buffer_load_dwordx4 a[8:11], v9, s[16:19], s26 offen offset:2048 sc1
  buffer_load_dwordx4 a[12:15], v9, s[16:19], s26 offen offset:3072 sc1
  s_add_u32 s26, s26, 4096
  buffer_load_dwordx4 a[16:19], v9, s[16:19], s26 offen offset:0 sc1
  buffer_load_dwordx4 a[20:23], v9, s[16:19], s26 offen offset:1024 sc1
  buffer_load_dwordx4 a[24:27], v9, s[16:19], s26 offen offset:2048 sc1
  buffer_load_dwordx4 a[28:31], v9, s[16:19], s26 offen offset:3072 sc1
  s_add_u32 s26, s26, 4096
  s_waitcnt vmcnt(7)
  s_waitcnt lgkmcnt(0)
  v_mfma_f32_32x32x16_bf16 v[16:31], v[128:131], a[0:3], 0
  ds_read_b128 v[144:147], v10 offset:1024
  ds_read_b128 v[148:151], v10 offset:29696
  ds_read_b128 v[152:155], v11 offset:1024
  v_mfma_f32_32x32x16_bf16 v[32:47], v[132:135], a[0:3], 0
  buffer_load_dwordx4 a[32:35], v9, s[16:19], s26 offen offset:0 sc1
  v_mfma_f32_32x32x16_bf16 v[48:63], v[136:139], a[0:3], 0
  buffer_load_dwordx2 v[200:201], v5, s[16:19], s30 offen offset:0 sc1
  s_waitcnt vmcnt(8)
  s_waitcnt lgkmcnt(0)
  v_mfma_f32_32x32x16_bf16 v[16:31], v[144:147], a[4:7], v[16:31]
  ds_read_b128 v[128:131], v10 offset:2048
  ds_read_b128 v[132:135], v10 offset:30720
  ds_read_b128 v[136:139], v11 offset:2048
  v_mfma_f32_32x32x16_bf16 v[32:47], v[148:151], a[4:7], v[32:47]
  buffer_load_dwordx4 a[36:39], v9, s[16:19], s26 offen offset:1024 sc1
  v_mfma_f32_32x32x16_bf16 v[48:63], v[152:155], a[4:7], v[48:63]
  buffer_load_dwordx2 v[202:203], v5, s[16:19], s30 offen offset:256 sc1
  s_waitcnt vmcnt(9)
  s_waitcnt lgkmcnt(0)
  v_mfma_f32_32x32x16_bf16 v[16:31], v[128:131], a[8:11], v[16:31]
  ds_read_b128 v[144:147], v10 offset:3072
  ds_read_b128 v[148:151], v10 offset:31744
  ds_read_b128 v[152:155], v11 offset:3072
  v_mfma_f32_32x32x16_bf16 v[32:47], v[132:135], a[8:11], v[32:47]
  buffer_load_dwordx4 a[40:43], v9, s[16:19], s26 offen offset:2048 sc1
  v_mfma_f32_32x32x16_bf16 v[48:63], v[136:139], a[8:11], v[48:63]
  buffer_load_dwordx2 v[204:205], v5, s[16:19], s30 offen offset:512 sc1
  s_waitcnt vmcnt(10)
  s_waitcnt lgkmcnt(0)
  v_mfma_f32_32x32x16_bf16 v[16:31], v[144:147], a[12:15], v[16:31]
  ds_read_b128 v[128:131], v10 offset:4096
  ds_read_b128 v[132:135], v10 offset:32768
  ds_read_b128 v[136:139], v11 offset:4096
  v_mfma_f32_32x32x16_bf16 v[32:47], v[148:151], a[12:15], v[32:47]
  buffer_load_dwordx4 a[44:47], v9, s[16:19], s26 offen offset:3072 sc1
  s_add_u32 s26, s26, 4096
  v_mfma_f32_32x32x16_bf16 v[48:63], v[152:155], a[12:15], v[48:63]
  buffer_load_dwordx2 v[206:207], v5, s[16:19], s30 offen offset:768 sc1
  s_waitcnt vmcnt(11)
  s_waitcnt lgkmcnt(0)
  v_mfma_f32_32x32x16_bf16 v[16:31], v[128:131], a[16:19], v[16:31]
  ds_read_b128 v[144:147], v10 offset:5120
  ds_read_b128 v[148:151], v10 offset:33792
  ds_read_b128 v[152:155], v11 offset:5120
  v_mfma_f32_32x32x16_bf16 v[32:47], v[132:135], a[16:19], v[32:47]
  buffer_load_dwordx4 a[48:51], v9, s[16:19], s26 offen offset:0 sc1
  v_mfma_f32_32x32x16_bf16 v[48:63], v[136:139], a[16:19], v[48:63]
  buffer_load_dwordx2 v[208:209], v5, s[16:19], s30 offen offset:1024 sc1
  s_waitcnt vmcnt(12)
  s_waitcnt lgkmcnt(0)
  v_mfma_f32_32x32x16_bf16 v[16:31], v[144:147], a[20:23], v[16:31]
  ds_read_b128 v[128:131], v10 offset:6144
  ds_read_b128 v[132:135], v10 offset:34816
  ds_read_b128 v[136:139], v11 offset:6144
  v_mfma_f32_32x32x16_bf16 v[32:47], v[148:151], a[20:23], v[32:47]
  buffer_load_dwordx4 a[52:55], v9, s[16:19], s26 offen offset:1024 sc1
  v_mfma_f32_32x32x16_bf16 v[48:63], v[152:155], a[20:23], v[48:63]
  buffer_load_dwordx2 v[210:211], v5, s[16:19], s30 offen offset:1280 sc1
  s_waitcnt vmcnt(13)
  s_waitcnt lgkmcnt(0)
  v_mfma_f32_32x32x16_bf16 v[16:31], v[128:131], a[24:27], v[16:31]
  ds_read_b128 v[144:147], v10 offset:7168
  ds_read_b128 v[148:151], v10 offset:35840
  ds_read_b128 v[152:155], v11 offset:7168
  v_mfma_f32_32x32x16_bf16 v[32:47], v[132:135], a[24:27], v[32:47]
  buffer_load_dwordx4 a[56:59], v9, s[16:19], s26 offen offset:2048 sc1
  v_mfma_f32_32x32x16_bf16 v[48:63], v[136:139], a[24:27], v[48:63]
  buffer_load_dwordx2 v[212:213], v5, s[16:19], s30 offen offset:1536 sc1
  s_waitcnt vmcnt(14)
  s_waitcnt lgkmcnt(0)
  v_mfma_f32_32x32x16_bf16 v[16:31], v[144:147], a[28:31], v[16:31]
  ds_read_b128 v[128:131], v10 offset:8192
  ds_read_b128 v[132:135], v10 offset:36864
  ds_read_b128 v[136:139], v11 offset:8192
  v_mfma_f32_32x32x16_bf16 v[32:47], v[148:151], a[28:31], v[32:47]
  buffer_load_dwordx4 a[60:63], v9, s[16:19], s26 offen offset:3072 sc1
  s_add_u32 s26, s26, 4096
  v_mfma_f32_32x32x16_bf16 v[48:63], v[152:155], a[28:31], v[48:63]
  s_add_u32 m0, s28, 118784
  s_add_u32 s29, s27, 118784
  buffer_load_dwordx4 v9, s[16:19], s29 offen offset:1024 sc1 lds
  s_waitcnt vmcnt(15)
  s_waitcnt lgkmcnt(0)
  v_mfma_f32_32x32x16_bf16 v[16:31], v[128:131], a[32:35], v[16:31]
  ds_read_b128 v[144:147], v10 offset:9216
  ds_read_b128 v[148:151], v10 offset:37888
  ds_read_b128 v[152:155], v11 offset:9216
  v_mfma_f32_32x32x16_bf16 v[32:47], v[132:135], a[32:35], v[32:47]
  buffer_load_dwordx4 a[64:67], v9, s[16:19], s26 offen offset:0 sc1
  v_mfma_f32_32x32x16_bf16 v[48:63], v[136:139], a[32:35], v[48:63]
  buffer_load_dwordx4 v9, s[16:19], s29 offen offset:2048 sc1 lds
  s_waitcnt vmcnt(15)
  s_waitcnt lgkmcnt(0)
  v_mfma_f32_32x32x16_bf16 v[16:31], v[144:147], a[36:39], v[16:31]
  ds_read_b128 v[128:131], v10 offset:10240
  ds_read_b128 v[132:135], v10 offset:38912
  ds_read_b128 v[136:139], v11 offset:10240
  v_mfma_f32_32x32x16_bf16 v[32:47], v[148:151], a[36:39], v[32:47]
  buffer_load_dwordx4 a[68:71], v9, s[16:19], s26 offen offset:1024 sc1
  v_mfma_f32_32x32x16_bf16 v[48:63], v[152:155], a[36:39], v[48:63]
  s_waitcnt vmcnt(14)
  s_waitcnt lgkmcnt(0)
  v_mfma_f32_32x32x16_bf16 v[16:31], v[128:131], a[40:43], v[16:31]
  ds_read_b128 v[144:147], v10 offset:11264
  ds_read_b128 v[148:151], v10 offset:39936
  ds_read_b128 v[152:155], v11 offset:11264
  v_mfma_f32_32x32x16_bf16 v[32:47], v[132:135], a[40:43], v[32:47]
  buffer_load_dwordx4 a[72:75], v9, s[16:19], s26 offen offset:2048 sc1
  v_mfma_f32_32x32x16_bf16 v[48:63], v[136:139], a[40:43], v[48:63]
  s_waitcnt vmcnt(13)
  s_waitcnt lgkmcnt(0)
  v_mfma_f32_32x32x16_bf16 v[16:31], v[144:147], a[44:47], v[16:31]
  ds_read_b128 v[128:131], v10 offset:12288
  ds_read_b128 v[132:135], v10 offset:40960
  ds_read_b128 v[136:139], v11 offset:12288
  v_mfma_f32_32x32x16_bf16 v[32:47], v[148:151], a[44:47], v[32:47]
  buffer_load_dwordx4 a[76:79], v9, s[16:19], s26 offen offset:3072 sc1
  s_add_u32 s26, s26, 4096
  v_mfma_f32_32x32x16_bf16 v[48:63], v[152:155], a[44:47], v[48:63]
  s_waitcnt vmcnt(12)
  s_waitcnt lgkmcnt(0)
  v_mfma_f32_32x32x16_bf16 v[16:31], v[128:131], a[48:51], v[16:31]
  ds_read_b128 v[144:147], v10 offset:13312
  ds_read_b128 v[148:151], v10 offset:41984
  ds_read_b128 v[152:155], v11 offset:13312
  v_mfma_f32_32x32x16_bf16 v[32:47], v[132:135], a[48:51], v[32:47]
  buffer_load_dwordx4 a[80:83], v9, s[16:19], s26 offen offset:0 sc1
  v_mfma_f32_32x32x16_bf16 v[48:63], v[136:139], a[48:51], v[48:63]
  s_waitcnt vmcnt(11)
  s_waitcnt lgkmcnt(0)
  v_mfma_f32_32x32x16_bf16 v[16:31], v[144:147], a[52:55], v[16:31]
  ds_read_b128 v[128:131], v10 offset:14336
  ds_read_b128 v[132:135], v10 offset:43008
  ds_read_b128 v[136:139], v11 offset:14336
  v_mfma_f32_32x32x16_bf16 v[32:47], v[148:151], a[52:55], v[32:47]
  buffer_load_dwordx4 a[84:87], v9, s[16:19], s26 offen offset:1024 sc1
  v_mfma_f32_32x32x16_bf16 v[48:63], v[152:155], a[52:55], v[48:63]
  s_waitcnt vmcnt(10)
  s_waitcnt lgkmcnt(0)
  v_mfma_f32_32x32x16_bf16 v[16:31], v[128:131], a[56:59], v[16:31]
  ds_read_b128 v[144:147], v10 offset:15360
  ds_read_b128 v[148:151], v10 offset:44032
  ds_read_b128 v[152:155], v11 offset:15360
  v_mfma_f32_32x32x16_bf16 v[32:47], v[132:135], a[56:59], v[32:47]
  buffer_load_dwordx4 a[88:91], v9, s[16:19], s26 offen offset:2048 sc1
  v_mfma_f32_32x32x16_bf16 v[48:63], v[136:139], a[56:59], v[48:63]
  s_waitcnt vmcnt(9)
  s_waitcnt lgkmcnt(0)
  v_mfma_f32_32x32x16_bf16 v[16:31], v[144:147], a[60:63], v[16:31]
  ds_read_b128 v[128:131], v10 offset:16384
  ds_read_b128 v[132:135], v10 offset:45056
  ds_read_b128 v[136:139], v11 offset:16384
  v_mfma_f32_32x32x16_bf16 v[32:47], v[148:151], a[60:63], v[32:47]
  buffer_load_dwordx4 a[92:95], v9, s[16:19], s26 offen offset:3072 sc1
  s_add_u32 s26, s26, 4096
  v_mfma_f32_32x32x16_bf16 v[48:63], v[152:155], a[60:63], v[48:63]
  s_waitcnt vmcnt(8)
  s_waitcnt lgkmcnt(0)
  v_mfma_f32_32x32x16_bf16 v[16:31], v[128:131], a[64:67], v[16:31]
  ds_read_b128 v[144:147], v10 offset:17408
  ds_read_b128 v[148:151], v10 offset:46080
  ds_read_b128 v[152:155], v11 offset:17408
  v_mfma_f32_32x32x16_bf16 v[32:47], v[132:135], a[64:67], v[32:47]
  buffer_load_dwordx4 a[96:99], v9, s[16:19], s26 offen offset:0 sc1
  v_mfma_f32_32x32x16_bf16 v[48:63], v[136:139], a[64:67], v[48:63]
  s_waitcnt vmcnt(7)
  s_waitcnt lgkmcnt(0)
  v_mfma_f32_32x32x16_bf16 v[16:31], v[144:147], a[68:71], v[16:31]
  ds_read_b128 v[128:131], v10 offset:18432
  ds_read_b128 v[132:135], v10 offset:47104
  ds_read_b128 v[136:139], v11 offset:18432
  v_mfma_f32_32x32x16_bf16 v[32:47], v[148:151], a[68:71], v[32:47]
  buffer_load_dwordx4 a[100:103], v9, s[16:19], s26 offen offset:1024 sc1
  v_mfma_f32_32x32x16_bf16 v[48:63], v[152:155], a[68:71], v[48:63]
  s_waitcnt vmcnt(7)
  s_waitcnt lgkmcnt(0)
  v_mfma_f32_32x32x16_bf16 v[16:31], v[128:131], a[72:75], v[16:31]
  ds_read_b128 v[144:147], v10 offset:19456
  ds_read_b128 v[148:151], v10 offset:48128
  ds_read_b128 v[152:155], v11 offset:19456
  v_mfma_f32_32x32x16_bf16 v[32:47], v[132:135], a[72:75], v[32:47]
  buffer_load_dwordx4 a[104:107], v9, s[16:19], s26 offen offset:2048 sc1
  v_add_f32 v200, v200, v202
  v_add_f32 v201, v201, v203
  v_add_f32 v200, v200, v204
  v_add_f32 v201, v201, v205
  v_add_f32 v200, v200, v206
  v_mfma_f32_32x32x16_bf16 v[48:63], v[136:139], a[72:75], v[48:63]
  v_add_f32 v201, v201, v207
  v_add_f32 v200, v200, v208
  v_add_f32 v201, v201, v209
  v_add_f32 v200, v200, v210
  v_add_f32 v201, v201, v211
  s_waitcnt vmcnt(7)
  s_waitcnt lgkmcnt(0)
  v_mfma_f32_32x32x16_bf16 v[16:31], v[144:147], a[76:79], v[16:31]
  ds_read_b128 v[128:131], v10 offset:20480
  ds_read_b128 v[132:135], v10 offset:49152
  ds_read_b128 v[136:139], v11 offset:20480
  v_mfma_f32_32x32x16_bf16 v[32:47], v[148:151], a[76:79], v[32:47]
  buffer_load_dwordx4 a[108:111], v9, s[16:19], s26 offen offset:3072 sc1
  s_add_u32 s26, s26, 4096
  v_add_f32 v200, v200, v212
  v_add_f32 v201, v201, v213
  v_mov_b32 v202, v200
  v_mov_b32 v203, v201
  s_nop 1
  v_mfma_f32_32x32x16_bf16 v[48:63], v[152:155], a[76:79], v[48:63]
  v_permlane32_swap_b32 v200, v202
  v_permlane32_swap_b32 v201, v203
  s_nop 1
  v_add_f32 v200, v200, v202
  v_add_f32 v201, v201, v203
  s_waitcnt vmcnt(7)
  s_waitcnt lgkmcnt(0)
  v_mfma_f32_32x32x16_bf16 v[16:31], v[128:131], a[80:83], v[16:31]
  ds_read_b128 v[144:147], v10 offset:21504
  ds_read_b128 v[148:151], v10 offset:50176
  ds_read_b128 v[152:155], v11 offset:21504
  v_mfma_f32_32x32x16_bf16 v[32:47], v[132:135], a[80:83], v[32:47]
  v_mul_f32 v200, 0xbb124925, v200
  v_mul_f32 v201, 0x3b124925, v201
  v_fma_f32 v201, -v200, v200, v201
  v_max_f32 v201, 0, v201
  v_add_f32 v201, 0x3727c5ac, v201
  v_mfma_f32_32x32x16_bf16 v[48:63], v[136:139], a[80:83], v[48:63]
  v_cvt_pk_bf16_f32 v192, v200, v200
  v_rsq_f32 v197, v201
  v_and_b32 v202, 0xffff0000, v192
  v_mul_f32 v196, v201, v197
  v_sub_f32 v202, v200, v202
  s_waitcnt vmcnt(6)
  s_waitcnt lgkmcnt(0)
  v_mfma_f32_32x32x16_bf16 v[16:31], v[144:147], a[84:87], v[16:31]
  ds_read_b128 v[128:131], v10 offset:22528
  ds_read_b128 v[132:135], v10 offset:51200
  ds_read_b128 v[136:139], v11 offset:22528
  v_mfma_f32_32x32x16_bf16 v[32:47], v[148:151], a[84:87], v[32:47]
  v_mul_f32 v197, 0xbfb8aa3b, v197
  v_cvt_pk_bf16_f32 v193, v202, 0
  v_mov_b32 v194, v192
  v_mov_b32 v195, v193
  v_mfma_f32_32x32x16_bf16 v[48:63], v[152:155], a[84:87], v[48:63]
  s_waitcnt vmcnt(5)
  s_waitcnt lgkmcnt(0)
  v_mfma_f32_32x32x16_bf16 v[16:31], v[128:131], a[88:91], v[16:31]
  ds_read_b128 v[144:147], v10 offset:23552
  ds_read_b128 v[148:151], v10 offset:52224
  ds_read_b128 v[152:155], v11 offset:23552
  v_mfma_f32_32x32x16_bf16 v[32:47], v[132:135], a[88:91], v[32:47]
  v_mfma_f32_32x32x16_bf16 v[48:63], v[136:139], a[88:91], v[48:63]
  s_waitcnt vmcnt(4)
  s_waitcnt lgkmcnt(0)
  v_mfma_f32_32x32x16_bf16 v[16:31], v[144:147], a[92:95], v[16:31]
  ds_read_b128 v[128:131], v10 offset:24576
  ds_read_b128 v[132:135], v10 offset:53248
  ds_read_b128 v[136:139], v11 offset:24576
  v_mfma_f32_32x32x16_bf16 v[32:47], v[148:151], a[92:95], v[32:47]
  v_mfma_f32_32x32x16_bf16 v[48:63], v[152:155], a[92:95], v[48:63]
  s_waitcnt vmcnt(3)
  s_waitcnt lgkmcnt(0)
  v_mfma_f32_32x32x16_bf16 v[16:31], v[128:131], a[96:99], v[16:31]
  ds_read_b128 v[144:147], v10 offset:25600
  ds_read_b128 v[148:151], v10 offset:54272
  ds_read_b128 v[152:155], v11 offset:25600
  v_mfma_f32_32x32x16_bf16 v[32:47], v[132:135], a[96:99], v[32:47]
  v_mfma_f32_32x32x16_bf16 v[48:63], v[136:139], a[96:99], v[48:63]
  s_waitcnt vmcnt(2)
  s_waitcnt lgkmcnt(0)
  v_mfma_f32_32x32x16_bf16 v[16:31], v[144:147], a[100:103], v[16:31]
  ds_read_b128 v[128:131], v10 offset:26624
  ds_read_b128 v[132:135], v10 offset:55296
  ds_read_b128 v[136:139], v11 offset:26624
  v_mfma_f32_32x32x16_bf16 v[32:47], v[148:151], a[100:103], v[32:47]
  v_mfma_f32_32x32x16_bf16 v[48:63], v[152:155], a[100:103], v[48:63]
  s_waitcnt vmcnt(1)
  s_waitcnt lgkmcnt(0)
  v_mfma_f32_32x32x16_bf16 v[16:31], v[128:131], a[104:107], v[16:31]
  ds_read_b128 v[144:147], v10 offset:27648
  ds_read_b128 v[148:151], v10 offset:56320
  ds_read_b128 v[152:155], v11 offset:27648
  v_mfma_f32_32x32x16_bf16 v[32:47], v[132:135], a[104:107], v[32:47]
  v_mfma_f32_32x32x16_bf16 v[48:63], v[136:139], a[104:107], v[48:63]
  s_waitcnt vmcnt(0)
  s_waitcnt lgkmcnt(0)
  s_barrier
  v_mfma_f32_32x32x16_bf16 v[16:31], v[144:147], a[108:111], v[16:31]
  ds_read_b128 v[128:131], v11 offset:28672
  ds_read_b128 v[132:135], v11 offset:29696
  ds_read_b128 v[136:139], v11 offset:30720
  ds_read_b128 v[140:143], v11 offset:31744
  v_mfma_f32_32x32x16_bf16 v[32:47], v[148:151], a[108:111], v[32:47]
  v_mfma_f32_32x32x16_bf16 v[48:63], v[152:155], a[108:111], v[48:63]
  s_nop 0
  v_mfma_f32_32x32x16_bf16 v[16:31], v[160:163], v[192:195], v[16:31]
  v_mfma_f32_32x32x16_bf16 v[32:47], v[164:167], v[192:195], v[32:47]
  v_mfma_f32_32x32x16_bf16 v[48:63], v[168:171], v[192:195], v[48:63]
  s_waitcnt lgkmcnt(2)
  v_mfma_f32_32x32x16_bf16 v[64:79], v[128:131], a[0:3], 0
  ds_read_b128 v[144:147], v11 offset:32768
  s_add_u32 m0, s28, 0
  s_add_u32 s29, s27, 0
  buffer_load_dwordx4 v9, s[16:19], s29 offen offset:0 sc1 lds
  v_mfma_f32_32x32x16_bf16 v[64:79], v[132:135], a[4:7], v[64:79]
  ds_read_b128 v[148:151], v11 offset:33792
  s_waitcnt lgkmcnt(2)
  v_mfma_f32_32x32x16_bf16 v[64:79], v[136:139], a[8:11], v[64:79]
  ds_read_b128 v[128:131], v11 offset:34816
  buffer_load_dwordx4 v9, s[16:19], s29 offen offset:1024 sc1 lds
  v_mfma_f32_32x32x16_bf16 v[64:79], v[140:143], a[12:15], v[64:79]
  ds_read_b128 v[132:135], v11 offset:35840
  v_mul_f32 v216, v197, v16
  v_mul_f32 v217, v197, v17
  v_mul_f32 v218, v197, v18
  v_mul_f32 v219, v197, v19
  s_waitcnt lgkmcnt(2)
  v_mfma_f32_32x32x16_bf16 v[64:79], v[144:147], a[16:19], v[64:79]
  ds_read_b128 v[136:139], v11 offset:36864
  buffer_load_dwordx4 v9, s[16:19], s29 offen offset:2048 sc1 lds
  v_mfma_f32_32x32x16_bf16 v[64:79], v[148:151], a[20:23], v[64:79]
  ds_read_b128 v[140:143], v11 offset:37888
  v_exp_f32 v216, v216
  v_exp_f32 v217, v217
  s_waitcnt lgkmcnt(2)
  v_mfma_f32_32x32x16_bf16 v[64:79], v[128:131], a[24:27], v[64:79]
  ds_read_b128 v[144:147], v11 offset:38912
  buffer_load_dwordx4 v9, s[16:19], s29 offen offset:3072 sc1 lds
  v_mfma_f32_32x32x16_bf16 v[64:79], v[132:135], a[28:31], v[64:79]
  ds_read_b128 v[148:151], v11 offset:39936
  v_exp_f32 v218, v218
  v_exp_f32 v219, v219
  v_fma_f32 v216, v216, v196, v196
  s_waitcnt lgkmcnt(2)
  v_mfma_f32_32x32x16_bf16 v[64:79], v[136:139], a[32:35], v[64:79]
  ds_read_b128 v[128:131], v11 offset:40960
  s_add_u32 m0, s28, 4096
  s_add_u32 s29, s27, 4096
  buffer_load_dwordx4 v9, s[16:19], s29 offen offset:0 sc1 lds
  v_mfma_f32_32x32x16_bf16 v[64:79], v[140:143], a[36:39], v[64:79]
  ds_read_b128 v[132:135], v11 offset:41984
  v_fma_f32 v217, v217, v196, v196
  v_fma_f32 v218, v218, v196, v196
  v_fma_f32 v219, v219, v196, v196
  v_rcp_f32 v216, v216
  s_waitcnt lgkmcnt(2)
  v_mfma_f32_32x32x16_bf16 v[64:79], v[144:147], a[40:43], v[64:79]
  ds_read_b128 v[136:139], v11 offset:43008
  buffer_load_dwordx4 v9, s[16:19], s29 offen offset:1024 sc1 lds
  v_mfma_f32_32x32x16_bf16 v[64:79], v[148:151], a[44:47], v[64:79]
  ds_read_b128 v[140:143], v11 offset:44032
  v_rcp_f32 v217, v217
  v_rcp_f32 v218, v218
  s_waitcnt lgkmcnt(2)
  v_mfma_f32_32x32x16_bf16 v[64:79], v[128:131], a[48:51], v[64:79]
  ds_read_b128 v[144:147], v11 offset:45056
  buffer_load_dwordx4 v9, s[16:19], s29 offen offset:2048 sc1 lds
  v_mfma_f32_32x32x16_bf16 v[64:79], v[132:135], a[52:55], v[64:79]
  ds_read_b128 v[148:151], v11 offset:46080
  v_rcp_f32 v219, v219
  v_mul_f32 v216, v216, v24
  v_mul_f32 v217, v217, v25
  v_mul_f32 v218, v218, v26
  s_waitcnt lgkmcnt(2)
  v_mfma_f32_32x32x16_bf16 v[64:79], v[136:139], a[56:59], v[64:79]
  ds_read_b128 v[128:131], v11 offset:47104
  s_add_u32 m0, s28, 28672
  s_add_u32 s29, s27, 28672
  buffer_load_dwordx4 v9, s[16:19], s29 offen offset:0 sc1 lds
  v_mfma_f32_32x32x16_bf16 v[64:79], v[140:143], a[60:63], v[64:79]
  ds_read_b128 v[132:135], v11 offset:48128
  v_mul_f32 v219, v219, v27
  v_cvt_pk_bf16_f32 v224, v216, v217
  v_cvt_pk_bf16_f32 v225, v218, v219
  v_mul_f32 v220, v197, v20
  v_mul_f32 v221, v197, v21
  s_waitcnt lgkmcnt(2)
  v_mfma_f32_32x32x16_bf16 v[64:79], v[144:147], a[64:67], v[64:79]
  ds_read_b128 v[136:139], v11 offset:49152
  buffer_load_dwordx4 v9, s[16:19], s29 offen offset:1024 sc1 lds
  v_mfma_f32_32x32x16_bf16 v[64:79], v[148:151], a[68:71], v[64:79]
  ds_read_b128 v[140:143], v11 offset:50176
  v_mul_f32 v222, v197, v22
  v_mul_f32 v223, v197, v23
  v_exp_f32 v220, v220
  s_waitcnt lgkmcnt(2)
  v_mfma_f32_32x32x16_bf16 v[64:79], v[128:131], a[72:75], v[64:79]
  ds_read_b128 v[144:147], v11 offset:51200
  buffer_load_dwordx4 v9, s[16:19], s29 offen offset:2048 sc1 lds
  v_mfma_f32_32x32x16_bf16 v[64:79], v[132:135], a[76:79], v[64:79]
  ds_read_b128 v[148:151], v11 offset:52224
  v_exp_f32 v221, v221
  v_exp_f32 v222, v222
  s_waitcnt lgkmcnt(2)
  v_mfma_f32_32x32x16_bf16 v[64:79], v[136:139], a[80:83], v[64:79]
  ds_read_b128 v[128:131], v11 offset:53248
  buffer_load_dwordx4 v9, s[16:19], s29 offen offset:3072 sc1 lds
  v_mfma_f32_32x32x16_bf16 v[64:79], v[140:143], a[84:87], v[64:79]
  ds_read_b128 v[132:135], v11 offset:54272
  v_exp_f32 v223, v223
  v_fma_f32 v220, v220, v196, v196
  v_fma_f32 v221, v221, v196, v196
  v_fma_f32 v222, v222, v196, v196
  s_waitcnt lgkmcnt(2)
  v_mfma_f32_32x32x16_bf16 v[64:79], v[144:147], a[88:91], v[64:79]
  ds_read_b128 v[136:139], v11 offset:55296
  s_add_u32 m0, s28, 32768
  s_add_u32 s29, s27, 32768
  buffer_load_dwordx4 v9, s[16:19], s29 offen offset:0 sc1 lds
  v_mfma_f32_32x32x16_bf16 v[64:79], v[148:151], a[92:95], v[64:79]
  ds_read_b128 v[140:143], v11 offset:56320
  v_fma_f32 v223, v223, v196, v196
  v_rcp_f32 v220, v220
  v_rcp_f32 v221, v221
  s_waitcnt lgkmcnt(2)
  v_mfma_f32_32x32x16_bf16 v[64:79], v[128:131], a[96:99], v[64:79]
  s_barrier
  ds_read_b128 v[144:147], v12 offset:0
  buffer_load_dwordx4 v9, s[16:19], s29 offen offset:1024 sc1 lds
  v_mfma_f32_32x32x16_bf16 v[64:79], v[132:135], a[100:103], v[64:79]
  ds_read_b128 v[148:151], v12 offset:1024
  v_rcp_f32 v222, v222
  v_rcp_f32 v223, v223
  v_mul_f32 v220, v220, v28
  s_waitcnt lgkmcnt(2)
  v_mfma_f32_32x32x16_bf16 v[64:79], v[136:139], a[104:107], v[64:79]
  ds_read_b128 v[128:131], v12 offset:2048
  buffer_load_dwordx4 v9, s[16:19], s29 offen offset:2048 sc1 lds
  v_mfma_f32_32x32x16_bf16 v[64:79], v[140:143], a[108:111], v[64:79]
  ds_read_b128 v[132:135], v12 offset:3072
  v_mul_f32 v221, v221, v29
  v_mul_f32 v222, v222, v30
  v_mul_f32 v223, v223, v31
  v_cvt_pk_bf16_f32 v226, v220, v221
  v_cvt_pk_bf16_f32 v227, v222, v223
  v_mfma_f32_32x32x16_bf16 v[64:79], v[172:175], v[192:195], v[64:79]
  buffer_store_dwordx4 v[224:227], v9, s[16:19], s34 offen offset:1024 sc1
  v_mul_f32 v216, v197, v32
  s_waitcnt lgkmcnt(2)
  v_mfma_f32_32x32x16_bf16 v[80:95], v[144:147], a[0:3], 0
  ds_read_b128 v[136:139], v12 offset:4096
  v_mul_f32 v217, v197, v33
  v_mul_f32 v218, v197, v34
  v_mul_f32 v219, v197, v35
  v_mfma_f32_32x32x16_bf16 v[80:95], v[148:151], a[4:7], v[80:95]
  ds_read_b128 v[140:143], v12 offset:5120
  v_exp_f32 v216, v216
  v_exp_f32 v217, v217
  s_waitcnt lgkmcnt(2)
  v_mfma_f32_32x32x16_bf16 v[80:95], v[128:131], a[8:11], v[80:95]
  ds_read_b128 v[144:147], v12 offset:6144
  v_exp_f32 v218, v218
  v_exp_f32 v219, v219
  v_mfma_f32_32x32x16_bf16 v[80:95], v[132:135], a[12:15], v[80:95]
  ds_read_b128 v[148:151], v12 offset:7168
  v_fma_f32 v216, v216, v196, v196
  v_fma_f32 v217, v217, v196, v196
  v_fma_f32 v218, v218, v196, v196
  v_fma_f32 v219, v219, v196, v196
  s_waitcnt lgkmcnt(2)
  v_mfma_f32_32x32x16_bf16 v[80:95], v[136:139], a[16:19], v[80:95]
  ds_read_b128 v[128:131], v12 offset:8192
  v_rcp_f32 v216, v216
  v_rcp_f32 v217, v217
  v_mfma_f32_32x32x16_bf16 v[80:95], v[140:143], a[20:23], v[80:95]
  ds_read_b128 v[132:135], v12 offset:9216
  v_rcp_f32 v218, v218
  v_rcp_f32 v219, v219
  v_mul_f32 v216, v216, v40
  s_waitcnt lgkmcnt(2)
  v_mfma_f32_32x32x16_bf16 v[80:95], v[144:147], a[24:27], v[80:95]
  ds_read_b128 v[136:139], v12 offset:10240
  v_mul_f32 v217, v217, v41
  v_mul_f32 v218, v218, v42
  v_mul_f32 v219, v219, v43
  v_cvt_pk_bf16_f32 v228, v216, v217
  v_mfma_f32_32x32x16_bf16 v[80:95], v[148:151], a[28:31], v[80:95]
  ds_read_b128 v[140:143], v12 offset:11264
  v_cvt_pk_bf16_f32 v229, v218, v219
  v_mul_f32 v220, v197, v36
  v_mul_f32 v221, v197, v37
  v_mul_f32 v222, v197, v38
  v_mul_f32 v223, v197, v39
  s_waitcnt lgkmcnt(2)
  v_mfma_f32_32x32x16_bf16 v[80:95], v[128:131], a[32:35], v[80:95]
  ds_read_b128 v[144:147], v12 offset:12288
  v_exp_f32 v220, v220
  v_exp_f32 v221, v221
  v_mfma_f32_32x32x16_bf16 v[80:95], v[132:135], a[36:39], v[80:95]
  ds_read_b128 v[148:151], v12 offset:13312
  v_exp_f32 v222, v222
  v_exp_f32 v223, v223
  v_fma_f32 v220, v220, v196, v196
  s_waitcnt lgkmcnt(2)
  v_mfma_f32_32x32x16_bf16 v[80:95], v[136:139], a[40:43], v[80:95]
  ds_read_b128 v[128:131], v12 offset:14336
  v_fma_f32 v221, v221, v196, v196
  v_fma_f32 v222, v222, v196, v196
  v_fma_f32 v223, v223, v196, v196
  v_mfma_f32_32x32x16_bf16 v[80:95], v[140:143], a[44:47], v[80:95]
  ds_read_b128 v[132:135], v12 offset:15360
  v_rcp_f32 v220, v220
  v_rcp_f32 v221, v221
  s_waitcnt lgkmcnt(2)
  v_mfma_f32_32x32x16_bf16 v[80:95], v[144:147], a[48:51], v[80:95]
  ds_read_b128 v[136:139], v12 offset:16384
  v_rcp_f32 v222, v222
  v_rcp_f32 v223, v223
  v_mfma_f32_32x32x16_bf16 v[80:95], v[148:151], a[52:55], v[80:95]
  ds_read_b128 v[140:143], v12 offset:17408
  v_mul_f32 v220, v220, v44
  v_mul_f32 v221, v221, v45
  v_mul_f32 v222, v222, v46
  v_mul_f32 v223, v223, v47
  v_cvt_pk_bf16_f32 v230, v220, v221
  s_waitcnt lgkmcnt(2)
  v_mfma_f32_32x32x16_bf16 v[80:95], v[128:131], a[56:59], v[80:95]
  ds_read_b128 v[144:147], v12 offset:18432
  v_cvt_pk_bf16_f32 v231, v222, v223
  v_mfma_f32_32x32x16_bf16 v[80:95], v[132:135], a[60:63], v[80:95]
  ds_read_b128 v[148:151], v12 offset:19456
  buffer_store_dwordx4 v[228:231], v9, s[16:19], s34 offen offset:2048 sc1
  v_mul_f32 v216, v197, v48
  s_waitcnt lgkmcnt(2)
  v_mfma_f32_32x32x16_bf16 v[80:95], v[136:139], a[64:67], v[80:95]
  ds_read_b128 v[128:131], v12 offset:20480
  v_mul_f32 v217, v197, v49
  v_mul_f32 v218, v197, v50
  v_mul_f32 v219, v197, v51
  v_mfma_f32_32x32x16_bf16 v[80:95], v[140:143], a[68:71], v[80:95]
  ds_read_b128 v[132:135], v12 offset:21504
  v_exp_f32 v216, v216
  v_exp_f32 v217, v217
  s_waitcnt lgkmcnt(2)
  v_mfma_f32_32x32x16_bf16 v[80:95], v[144:147], a[72:75], v[80:95]
  ds_read_b128 v[136:139], v12 offset:22528
  v_exp_f32 v218, v218
  v_exp_f32 v219, v219
  v_mfma_f32_32x32x16_bf16 v[80:95], v[148:151], a[76:79], v[80:95]
  ds_read_b128 v[140:143], v12 offset:23552
  v_fma_f32 v216, v216, v196, v196
  v_fma_f32 v217, v217, v196, v196
  v_fma_f32 v218, v218, v196, v196
  v_fma_f32 v219, v219, v196, v196
  s_waitcnt lgkmcnt(2)
  v_mfma_f32_32x32x16_bf16 v[80:95], v[128:131], a[80:83], v[80:95]
  ds_read_b128 v[144:147], v12 offset:24576
  v_rcp_f32 v216, v216
  v_rcp_f32 v217, v217
  v_mfma_f32_32x32x16_bf16 v[80:95], v[132:135], a[84:87], v[80:95]
  ds_read_b128 v[148:151], v12 offset:25600
  v_rcp_f32 v218, v218
  v_rcp_f32 v219, v219
  v_mul_f32 v216, v216, v56
  s_waitcnt lgkmcnt(2)
  v_mfma_f32_32x32x16_bf16 v[80:95], v[136:139], a[88:91], v[80:95]
  ds_read_b128 v[128:131], v12 offset:26624
  v_mul_f32 v217, v217, v57
  v_mul_f32 v218, v218, v58
  v_mul_f32 v219, v219, v59
  v_cvt_pk_bf16_f32 v224, v216, v217
  v_mfma_f32_32x32x16_bf16 v[80:95], v[140:143], a[92:95], v[80:95]
  ds_read_b128 v[132:135], v12 offset:27648
  v_cvt_pk_bf16_f32 v225, v218, v219
  v_mul_f32 v220, v197, v52
  v_mul_f32 v221, v197, v53
  v_mul_f32 v222, v197, v54
  v_mul_f32 v223, v197, v55
  s_waitcnt lgkmcnt(2)
  v_mfma_f32_32x32x16_bf16 v[80:95], v[144:147], a[96:99], v[80:95]
  s_waitcnt vmcnt(9)
  s_barrier
  ds_read_b128 v[136:139], v10 offset:0
  v_exp_f32 v220, v220
  v_mfma_f32_32x32x16_bf16 v[80:95], v[148:151], a[100:103], v[80:95]
  ds_read_b128 v[140:143], v10 offset:1024
  v_exp_f32 v221, v221
  v_exp_f32 v222, v222
  s_waitcnt lgkmcnt(2)
  v_mfma_f32_32x32x16_bf16 v[80:95], v[128:131], a[104:107], v[80:95]
  ds_read_b128 v[144:147], v10 offset:2048
  v_exp_f32 v223, v223
  v_fma_f32 v220, v220, v196, v196
  v_fma_f32 v221, v221, v196, v196
  v_mfma_f32_32x32x16_bf16 v[80:95], v[132:135], a[108:111], v[80:95]
  ds_read_b128 v[148:151], v10 offset:3072
  v_fma_f32 v222, v222, v196, v196
  v_fma_f32 v223, v223, v196, v196
  v_rcp_f32 v220, v220
  v_mfma_f32_32x32x16_bf16 v[80:95], v[176:179], v[192:195], v[80:95]
  v_rcp_f32 v221, v221
  v_rcp_f32 v222, v222
  s_waitcnt lgkmcnt(2)
  v_mfma_f32_32x32x16_bf16 v[96:111], v[136:139], a[0:3], 0
  ds_read_b128 v[128:131], v10 offset:4096
  v_rcp_f32 v223, v223
  v_mul_f32 v220, v220, v60
  v_mul_f32 v221, v221, v61
  v_mfma_f32_32x32x16_bf16 v[96:111], v[140:143], a[4:7], v[96:111]
  ds_read_b128 v[132:135], v10 offset:5120
  v_mul_f32 v222, v222, v62
  v_mul_f32 v223, v223, v63
  v_cvt_pk_bf16_f32 v226, v220, v221
  v_cvt_pk_bf16_f32 v227, v222, v223
  s_waitcnt lgkmcnt(2)
  v_mfma_f32_32x32x16_bf16 v[96:111], v[144:147], a[8:11], v[96:111]
  ds_read_b128 v[136:139], v10 offset:6144
  buffer_store_dwordx4 v[224:227], v9, s[16:19], s33 offen offset:2048 sc1
  v_mfma_f32_32x32x16_bf16 v[96:111], v[148:151], a[12:15], v[96:111]
  ds_read_b128 v[140:143], v10 offset:7168
  v_mul_f32 v216, v197, v64
  v_mul_f32 v217, v197, v65
  v_mul_f32 v218, v197, v66
  v_mul_f32 v219, v197, v67
  s_waitcnt lgkmcnt(2)
  v_mfma_f32_32x32x16_bf16 v[96:111], v[128:131], a[16:19], v[96:111]
  ds_read_b128 v[144:147], v10 offset:8192
  v_exp_f32 v216, v216
  v_exp_f32 v217, v217
  v_mfma_f32_32x32x16_bf16 v[96:111], v[132:135], a[20:23], v[96:111]
  ds_read_b128 v[148:151], v10 offset:9216
  v_exp_f32 v218, v218
  v_exp_f32 v219, v219
  v_fma_f32 v216, v216, v196, v196
  s_waitcnt lgkmcnt(2)
  v_mfma_f32_32x32x16_bf16 v[96:111], v[136:139], a[24:27], v[96:111]
  ds_read_b128 v[128:131], v10 offset:10240
  v_fma_f32 v217, v217, v196, v196
  v_fma_f32 v218, v218, v196, v196
  v_fma_f32 v219, v219, v196, v196
  v_mfma_f32_32x32x16_bf16 v[96:111], v[140:143], a[28:31], v[96:111]
  ds_read_b128 v[132:135], v10 offset:11264
  v_rcp_f32 v216, v216
  v_rcp_f32 v217, v217
  s_waitcnt lgkmcnt(2)
  v_mfma_f32_32x32x16_bf16 v[96:111], v[144:147], a[32:35], v[96:111]
  ds_read_b128 v[136:139], v10 offset:12288
  v_rcp_f32 v218, v218
  v_rcp_f32 v219, v219
  v_mfma_f32_32x32x16_bf16 v[96:111], v[148:151], a[36:39], v[96:111]
  ds_read_b128 v[140:143], v10 offset:13312
  v_mul_f32 v216, v216, v72
  v_mul_f32 v217, v217, v73
  v_mul_f32 v218, v218, v74
  v_mul_f32 v219, v219, v75
  v_cvt_pk_bf16_f32 v228, v216, v217
  s_waitcnt lgkmcnt(2)
  v_mfma_f32_32x32x16_bf16 v[96:111], v[128:131], a[40:43], v[96:111]
  ds_read_b128 v[144:147], v10 offset:14336
  v_cvt_pk_bf16_f32 v229, v218, v219
  v_mul_f32 v220, v197, v68
  v_mul_f32 v221, v197, v69
  v_mul_f32 v222, v197, v70
  v_mfma_f32_32x32x16_bf16 v[96:111], v[132:135], a[44:47], v[96:111]
  ds_read_b128 v[148:151], v10 offset:15360
  v_mul_f32 v223, v197, v71
  v_exp_f32 v220, v220
  v_exp_f32 v221, v221
  s_waitcnt lgkmcnt(2)
  v_mfma_f32_32x32x16_bf16 v[96:111], v[136:139], a[48:51], v[96:111]
  ds_read_b128 v[128:131], v10 offset:16384
  v_exp_f32 v222, v222
  v_exp_f32 v223, v223
  v_mfma_f32_32x32x16_bf16 v[96:111], v[140:143], a[52:55], v[96:111]
  ds_read_b128 v[132:135], v10 offset:17408
  v_fma_f32 v220, v220, v196, v196
  v_fma_f32 v221, v221, v196, v196
  v_fma_f32 v222, v222, v196, v196
  v_fma_f32 v223, v223, v196, v196
  s_waitcnt lgkmcnt(2)
  v_mfma_f32_32x32x16_bf16 v[96:111], v[144:147], a[56:59], v[96:111]
  ds_read_b128 v[136:139], v10 offset:18432
  v_rcp_f32 v220, v220
  v_rcp_f32 v221, v221
  v_mfma_f32_32x32x16_bf16 v[96:111], v[148:151], a[60:63], v[96:111]
  ds_read_b128 v[140:143], v10 offset:19456
  v_rcp_f32 v222, v222
  v_rcp_f32 v223, v223
  v_mul_f32 v220, v220, v76
  s_waitcnt lgkmcnt(2)
  v_mfma_f32_32x32x16_bf16 v[96:111], v[128:131], a[64:67], v[96:111]
  ds_read_b128 v[144:147], v10 offset:20480
  v_mul_f32 v221, v221, v77
  v_mul_f32 v222, v222, v78
  v_mul_f32 v223, v223, v79
  v_cvt_pk_bf16_f32 v230, v220, v221
  v_mfma_f32_32x32x16_bf16 v[96:111], v[132:135], a[68:71], v[96:111]
  ds_read_b128 v[148:151], v10 offset:21504
  v_cvt_pk_bf16_f32 v231, v222, v223
  buffer_store_dwordx4 v[228:231], v9, s[16:19], s33 offen offset:3072 sc1
  s_waitcnt lgkmcnt(2)
  v_mfma_f32_32x32x16_bf16 v[96:111], v[136:139], a[72:75], v[96:111]
  ds_read_b128 v[128:131], v10 offset:22528
  s_add_u32 s96, s96, 11264
  buffer_load_dwordx4 v[16:19], v9, s[16:19], s96 offen offset:1024 sc1
  v_mfma_f32_32x32x16_bf16 v[96:111], v[140:143], a[76:79], v[96:111]
  ds_read_b128 v[132:135], v10 offset:23552
  s_add_u32 s97, s97, 11264
  buffer_load_dwordx4 v[20:23], v9, s[16:19], s97 offen offset:1024 sc1
  s_waitcnt lgkmcnt(2)
  v_mfma_f32_32x32x16_bf16 v[96:111], v[144:147], a[80:83], v[96:111]
  ds_read_b128 v[136:139], v10 offset:24576
  buffer_load_dwordx4 v[24:27], v9, s[16:19], s96 offen offset:2048 sc1
  v_mfma_f32_32x32x16_bf16 v[96:111], v[148:151], a[84:87], v[96:111]
  ds_read_b128 v[140:143], v10 offset:25600
  buffer_load_dwordx4 v[28:31], v9, s[16:19], s97 offen offset:2048 sc1
  s_waitcnt lgkmcnt(2)
  v_mfma_f32_32x32x16_bf16 v[96:111], v[128:131], a[88:91], v[96:111]
  ds_read_b128 v[144:147], v10 offset:26624
  s_add_u32 s96, s96, 7168
  buffer_load_dwordx4 v[32:35], v9, s[16:19], s96 offen offset:0 sc1
  v_mfma_f32_32x32x16_bf16 v[96:111], v[132:135], a[92:95], v[96:111]
  ds_read_b128 v[148:151], v10 offset:27648
  s_add_u32 s97, s97, 7168
  buffer_load_dwordx4 v[36:39], v9, s[16:19], s97 offen offset:0 sc1
  s_waitcnt lgkmcnt(2)
  v_mfma_f32_32x32x16_bf16 v[96:111], v[136:139], a[96:99], v[96:111]
  s_waitcnt vmcnt(10)
  s_barrier
  ds_read_b128 v[128:131], v10 offset:28672
  v_mfma_f32_32x32x16_bf16 v[96:111], v[140:143], a[100:103], v[96:111]
  ds_read_b128 v[132:135], v10 offset:29696
  buffer_load_dwordx4 v[40:43], v9, s[16:19], s96 offen offset:1024 sc1
  s_waitcnt lgkmcnt(2)
  v_mfma_f32_32x32x16_bf16 v[96:111], v[144:147], a[104:107], v[96:111]
  ds_read_b128 v[136:139], v10 offset:30720
  buffer_load_dwordx4 v[44:47], v9, s[16:19], s97 offen offset:1024 sc1
  v_mfma_f32_32x32x16_bf16 v[96:111], v[148:151], a[108:111], v[96:111]
  ds_read_b128 v[140:143], v10 offset:31744
  buffer_load_dwordx4 v[48:51], v9, s[16:19], s96 offen offset:2048 sc1
  v_mfma_f32_32x32x16_bf16 v[96:111], v[180:183], v[192:195], v[96:111]
  buffer_load_dwordx4 v[52:55], v9, s[16:19], s97 offen offset:2048 sc1
  s_waitcnt lgkmcnt(2)
  v_mfma_f32_32x32x16_bf16 v[112:127], v[128:131], a[0:3], 0
  ds_read_b128 v[144:147], v10 offset:32768
  s_waitcnt vmcnt(10)
  s_add_u32 s38, s9, 21594112
  s_add_u32 s38, s38, s15
  v_mov_b32 v14, s14
  v_mov_b32 v15, 0
  v_mov_b32 v1, 0
  s_mov_b64 exec, 1
  s_cmp_eq_u32 s61, 0
  s_cbranch_scc1 S44
  buffer_store_dwordx2 v[14:15], v1, s[16:19], s38 offen
S44b:
  s_mov_b64 exec, -1
  v_mfma_f32_32x32x16_bf16 v[112:127], v[132:135], a[4:7], v[112:127]
  ds_read_b128 v[148:151], v10 offset:33792
  s_add_u32 s96, s96, 7168
  buffer_load_dwordx4 v[56:59], v9, s[16:19], s96 offen offset:0 sc1
  s_waitcnt lgkmcnt(2)
  v_mfma_f32_32x32x16_bf16 v[112:127], v[136:139], a[8:11], v[112:127]
  ds_read_b128 v[128:131], v10 offset:34816
  s_add_u32 s97, s97, 7168
  buffer_load_dwordx4 v[60:63], v9, s[16:19], s97 offen offset:0 sc1
  v_mfma_f32_32x32x16_bf16 v[112:127], v[140:143], a[12:15], v[112:127]
  ds_read_b128 v[132:135], v10 offset:35840
  buffer_load_dwordx4 v[64:67], v9, s[16:19], s96 offen offset:1024 sc1
  s_waitcnt lgkmcnt(2)
  v_mfma_f32_32x32x16_bf16 v[112:127], v[144:147], a[16:19], v[112:127]
  ds_read_b128 v[136:139], v10 offset:36864
  buffer_load_dwordx4 v[68:71], v9, s[16:19], s97 offen offset:1024 sc1
  v_mfma_f32_32x32x16_bf16 v[112:127], v[148:151], a[20:23], v[112:127]
  ds_read_b128 v[140:143], v10 offset:37888
  buffer_load_dwordx4 v[72:75], v9, s[16:19], s96 offen offset:2048 sc1
  s_waitcnt lgkmcnt(2)
  v_mfma_f32_32x32x16_bf16 v[112:127], v[128:131], a[24:27], v[112:127]
  ds_read_b128 v[144:147], v10 offset:38912
  buffer_load_dwordx4 v[76:79], v9, s[16:19], s97 offen offset:2048 sc1
  v_mfma_f32_32x32x16_bf16 v[112:127], v[132:135], a[28:31], v[112:127]
  ds_read_b128 v[148:151], v10 offset:39936
  v_mul_f32 v216, v197, v80
  v_mul_f32 v217, v197, v81
  v_mul_f32 v218, v197, v82
  v_mul_f32 v219, v197, v83
  s_waitcnt lgkmcnt(2)
  v_mfma_f32_32x32x16_bf16 v[112:127], v[136:139], a[32:35], v[112:127]
  ds_read_b128 v[128:131], v10 offset:40960
  v_exp_f32 v216, v216
  v_exp_f32 v217, v217
  v_mfma_f32_32x32x16_bf16 v[112:127], v[140:143], a[36:39], v[112:127]
  ds_read_b128 v[132:135], v10 offset:41984
  v_exp_f32 v218, v218
  v_exp_f32 v219, v219
  v_fma_f32 v216, v216, v196, v196
  s_waitcnt lgkmcnt(2)
  v_mfma_f32_32x32x16_bf16 v[112:127], v[144:147], a[40:43], v[112:127]
  ds_read_b128 v[136:139], v10 offset:43008
  v_fma_f32 v217, v217, v196, v196
  v_fma_f32 v218, v218, v196, v196
  v_fma_f32 v219, v219, v196, v196
  v_mfma_f32_32x32x16_bf16 v[112:127], v[148:151], a[44:47], v[112:127]
  ds_read_b128 v[140:143], v10 offset:44032
  v_rcp_f32 v216, v216
  v_rcp_f32 v217, v217
  s_waitcnt lgkmcnt(2)
  v_mfma_f32_32x32x16_bf16 v[112:127], v[128:131], a[48:51], v[112:127]
  ds_read_b128 v[144:147], v10 offset:45056
  v_rcp_f32 v218, v218
  v_rcp_f32 v219, v219
  v_mfma_f32_32x32x16_bf16 v[112:127], v[132:135], a[52:55], v[112:127]
  ds_read_b128 v[148:151], v10 offset:46080
  v_mul_f32 v216, v216, v88
  v_mul_f32 v217, v217, v89
  v_mul_f32 v218, v218, v90
  v_mul_f32 v219, v219, v91
  v_cvt_pk_bf16_f32 v224, v216, v217
  s_waitcnt lgkmcnt(2)
  v_mfma_f32_32x32x16_bf16 v[112:127], v[136:139], a[56:59], v[112:127]
  ds_read_b128 v[128:131], v10 offset:47104
  v_cvt_pk_bf16_f32 v225, v218, v219
  v_mul_f32 v220, v197, v84
  v_mul_f32 v221, v197, v85
  v_mul_f32 v222, v197, v86
  v_mfma_f32_32x32x16_bf16 v[112:127], v[140:143], a[60:63], v[112:127]
  ds_read_b128 v[132:135], v10 offset:48128
  v_mul_f32 v223, v197, v87
  v_exp_f32 v220, v220
  v_exp_f32 v221, v221
  s_waitcnt lgkmcnt(2)
  v_mfma_f32_32x32x16_bf16 v[112:127], v[144:147], a[64:67], v[112:127]
  ds_read_b128 v[136:139], v10 offset:49152
  v_exp_f32 v222, v222
  v_exp_f32 v223, v223
  v_mfma_f32_32x32x16_bf16 v[112:127], v[148:151], a[68:71], v[112:127]
  ds_read_b128 v[140:143], v10 offset:50176
  v_fma_f32 v220, v220, v196, v196
  v_fma_f32 v221, v221, v196, v196
  v_fma_f32 v222, v222, v196, v196
  v_fma_f32 v223, v223, v196, v196
  s_waitcnt lgkmcnt(2)
  v_mfma_f32_32x32x16_bf16 v[112:127], v[128:131], a[72:75], v[112:127]
  ds_read_b128 v[144:147], v10 offset:51200
  v_rcp_f32 v220, v220
  v_rcp_f32 v221, v221
  v_mfma_f32_32x32x16_bf16 v[112:127], v[132:135], a[76:79], v[112:127]
  ds_read_b128 v[148:151], v10 offset:52224
  v_rcp_f32 v222, v222
  v_rcp_f32 v223, v223
  v_mul_f32 v220, v220, v92
  s_waitcnt lgkmcnt(2)
  v_mfma_f32_32x32x16_bf16 v[112:127], v[136:139], a[80:83], v[112:127]
  ds_read_b128 v[128:131], v10 offset:53248
  v_mul_f32 v221, v221, v93
  v_mul_f32 v222, v222, v94
  v_mul_f32 v223, v223, v95
  v_cvt_pk_bf16_f32 v226, v220, v221
  v_mfma_f32_32x32x16_bf16 v[112:127], v[140:143], a[84:87], v[112:127]
  ds_read_b128 v[132:135], v10 offset:54272
  v_cvt_pk_bf16_f32 v227, v222, v223
  buffer_store_dwordx4 v[224:227], v9, s[16:19], s34 offen offset:0 sc1
  s_waitcnt lgkmcnt(2)
  v_mfma_f32_32x32x16_bf16 v[112:127], v[144:147], a[88:91], v[112:127]
  ds_read_b128 v[136:139], v10 offset:55296
  v_mul_f32 v216, v197, v96
  v_mul_f32 v217, v197, v97
  v_mul_f32 v218, v197, v98
  v_mul_f32 v219, v197, v99
  v_mfma_f32_32x32x16_bf16 v[112:127], v[148:151], a[92:95], v[112:127]
  ds_read_b128 v[140:143], v10 offset:56320
  v_exp_f32 v216, v216
  v_exp_f32 v217, v217
  s_waitcnt lgkmcnt(2)
  v_mfma_f32_32x32x16_bf16 v[112:127], v[128:131], a[96:99], v[112:127]
  v_exp_f32 v218, v218
  v_exp_f32 v219, v219
  v_mfma_f32_32x32x16_bf16 v[112:127], v[132:135], a[100:103], v[112:127]
  v_fma_f32 v216, v216, v196, v196
  v_fma_f32 v217, v217, v196, v196
  v_fma_f32 v218, v218, v196, v196
  v_fma_f32 v219, v219, v196, v196
  s_waitcnt lgkmcnt(0)
  v_mfma_f32_32x32x16_bf16 v[112:127], v[136:139], a[104:107], v[112:127]
  v_rcp_f32 v216, v216
  v_rcp_f32 v217, v217
  v_mfma_f32_32x32x16_bf16 v[112:127], v[140:143], a[108:111], v[112:127]
  v_rcp_f32 v218, v218
  v_rcp_f32 v219, v219
  v_mul_f32 v216, v216, v104
  v_mfma_f32_32x32x16_bf16 v[112:127], v[184:187], v[192:195], v[112:127]
  v_mul_f32 v217, v217, v105
  v_mul_f32 v218, v218, v106
  v_mul_f32 v219, v219, v107
  v_cvt_pk_bf16_f32 v228, v216, v217
  v_cvt_pk_bf16_f32 v229, v218, v219
  s_lshr_b32 s11, s2, 3
  s_mul_i32 s26, s11, 9363
  s_lshr_b32 s26, s26, 16
  s_mul_i32 s27, s26, 7
  s_sub_u32 s25, s11, s27
  s_min_u32 s26, s26, 3
  s_and_b32 s24, s2, 7
  s_lshl_b32 s24, s24, 2
  s_add_u32 s24, s24, s26
  s_lshr_b32 s26, s3, 1
  s_and_b32 s27, s3, 1
  s_lshl_b32 s24, s24, 1
  s_lshl_b32 s25, s25, 1
  s_add_u32 s24, s24, s26
  s_add_u32 s25, s25, s27
  s_xor_b32 s26, s24, 1
  s_xor_b32 s27, s25, 1
  s_bfe_u32 s36, s24, 0x10002
  s_lshl_b32 s36, s36, 2
  s_add_u32 s36, s36, s3
  s_lshl_b32 s36, s36, 2
  v_and_b32 v7, 3, v2
  v_add_u32 v7, s36, v7
  v_bfe_u32 v6, v2, 2, 1
  s_and_b32 s36, s24, 2
  v_add_u32 v6, s36, v6
  s_and_b32 s38, s2, 7
  s_lshl_b32 s38, s38, 10
  v_lshl_add_u32 v8, v7, 2, v6
  v_lshl_add_u32 v8, v8, 3, s38
  s_mul_i32 s30, s24, 112
  s_mul_i32 s36, s3, 28
  s_add_u32 s30, s30, s36
  s_lshl_b32 s30, s30, 10
  s_add_u32 s30, s30, 14229504
  s_mul_i32 s31, s26, 112
  s_mul_i32 s36, s3, 28
  s_add_u32 s31, s31, s36
  s_lshl_b32 s31, s31, 10
  s_add_u32 s31, s31, 14229504
  s_add_u32 s30, s30, 0
  s_add_u32 s31, s31, 0
  s_add_u32 s35, s15, 21594112
  v_mul_f32 v220, v197, v100
  v_mul_f32 v221, v197, v101
  v_mul_f32 v222, v197, v102
  v_mul_f32 v223, v197, v103
  v_exp_f32 v220, v220
  v_exp_f32 v221, v221
  v_exp_f32 v222, v222
  v_exp_f32 v223, v223
  v_fma_f32 v220, v220, v196, v196
  v_fma_f32 v221, v221, v196, v196
  v_fma_f32 v222, v222, v196, v196
  v_fma_f32 v223, v223, v196, v196
  v_rcp_f32 v220, v220
  v_rcp_f32 v221, v221
  v_rcp_f32 v222, v222
  v_rcp_f32 v223, v223
  v_mul_f32 v220, v220, v108
  v_mul_f32 v221, v221, v109
  v_mul_f32 v222, v222, v110
  v_mul_f32 v223, v223, v111
  v_cvt_pk_bf16_f32 v230, v220, v221
  v_cvt_pk_bf16_f32 v231, v222, v223
  buffer_store_dwordx4 v[228:231], v9, s[16:19], s33 offen offset:0 sc1
  v_pk_mul_f32 v[216:217], v[112:113], v[196:197] op_sel:[0,1] op_sel_hi:[1,1]
  v_pk_mul_f32 v[218:219], v[114:115], v[196:197] op_sel:[0,1] op_sel_hi:[1,1]
  v_exp_f32 v216, v216
  buffer_load_dwordx2 v[6:7], v8, s[16:19], s35 offen sc1
  v_exp_f32 v217, v217
  v_exp_f32 v218, v218
  v_exp_f32 v219, v219
  v_pk_fma_f32 v[216:217], v[216:217], v[196:197], v[196:197] op_sel_hi:[1,0,0]
  v_pk_fma_f32 v[218:219], v[218:219], v[196:197], v[196:197] op_sel_hi:[1,0,0]
  v_rcp_f32 v216, v216
  v_rcp_f32 v217, v217
  v_rcp_f32 v218, v218
  v_rcp_f32 v219, v219
  v_pk_mul_f32 v[216:217], v[216:217], v[120:121]
  v_pk_mul_f32 v[218:219], v[218:219], v[122:123]
  v_cvt_pk_bf16_f32 v224, v216, v217
  v_cvt_pk_bf16_f32 v225, v218, v219
  v_pk_mul_f32 v[220:221], v[116:117], v[196:197] op_sel:[0,1] op_sel_hi:[1,1]
  v_pk_mul_f32 v[222:223], v[118:119], v[196:197] op_sel:[0,1] op_sel_hi:[1,1]
  v_exp_f32 v220, v220
  v_exp_f32 v221, v221
  v_exp_f32 v222, v222
  v_exp_f32 v223, v223
  v_pk_fma_f32 v[220:221], v[220:221], v[196:197], v[196:197] op_sel_hi:[1,0,0]
  v_pk_fma_f32 v[222:223], v[222:223], v[196:197], v[196:197] op_sel_hi:[1,0,0]
  v_rcp_f32 v220, v220
  v_rcp_f32 v221, v221
  v_rcp_f32 v222, v222
  v_rcp_f32 v223, v223
  v_pk_mul_f32 v[220:221], v[220:221], v[124:125]
  v_pk_mul_f32 v[222:223], v[222:223], v[126:127]
  v_cvt_pk_bf16_f32 v226, v220, v221
  v_cvt_pk_bf16_f32 v227, v222, v223
  buffer_store_dwordx4 v[224:227], v9, s[16:19], s33 offen offset:1024 sc1
  s_waitcnt vmcnt(1)
  v_cmp_ne_u32 vcc, s14, v6
  s_nop 4
  s_cbranch_vccnz Da_pw1
  buffer_load_dwordx4 v[80:83], v9, s[16:19], s30 offen offset:2048 sc1
  buffer_load_dwordx4 v[84:87], v9, s[16:19], s31 offen offset:2048 sc1
  buffer_load_dwordx4 v[88:91], v9, s[16:19], s30 offen offset:3072 sc1
  buffer_load_dwordx4 v[92:95], v9, s[16:19], s31 offen offset:3072 sc1
  s_add_u32 s30, s30, 5120
  s_add_u32 s31, s31, 5120
  buffer_load_dwordx4 v[96:99], v9, s[16:19], s30 offen offset:0 sc1
  buffer_load_dwordx4 v[100:103], v9, s[16:19], s31 offen offset:0 sc1
  buffer_load_dwordx4 v[104:107], v9, s[16:19], s30 offen offset:1024 sc1
  buffer_load_dwordx4 v[108:111], v9, s[16:19], s31 offen offset:1024 sc1
  s_add_u32 s30, s30, 4096
  s_add_u32 s31, s31, 4096
  buffer_load_dwordx4 v[112:115], v9, s[16:19], s30 offen offset:0 sc1
  buffer_load_dwordx4 v[116:119], v9, s[16:19], s31 offen offset:0 sc1
  s_waitcnt vmcnt(10)
  s_add_u32 s38, s9, 21602304
  s_add_u32 s38, s38, s15
  v_mov_b32 v10, s14
  v_mov_b32 v11, 0
  v_mov_b32 v1, 0
  s_mov_b64 exec, 1
  s_cmp_eq_u32 s61, 0
  s_cbranch_scc1 S45
  buffer_store_dwordx2 v[10:11], v1, s[16:19], s38 offen
S45b:
  s_mov_b64 exec, -1
Da_pb1:
  buffer_load_dwordx4 v[120:123], v9, s[16:19], s30 offen offset:1024 sc1
  buffer_load_dwordx4 v[124:127], v9, s[16:19], s31 offen offset:1024 sc1
  buffer_load_dwordx4 v[128:131], v9, s[16:19], s30 offen offset:3072 sc1
  buffer_load_dwordx4 v[132:135], v9, s[16:19], s31 offen offset:3072 sc1
  s_add_u32 s30, s30, 4096
  s_add_u32 s31, s31, 4096
  buffer_load_dwordx4 v[136:139], v9, s[16:19], s30 offen offset:0 sc1
  buffer_load_dwordx4 v[140:143], v9, s[16:19], s31 offen offset:0 sc1
  s_cmp_ge_u32 s11, 28
  s_cbranch_scc1 D_skip1
  s_xor_b32 s39, s3, 0
  s_mul_i32 s39, s39, 12288
  s_add_u32 s39, s39, 114688
  v_add_u32 v10, s39, v9
  s_xor_b32 s39, s3, 1
  s_mul_i32 s39, s39, 12288
  s_add_u32 s39, s39, 114688
  v_add_u32 v11, s39, v9
  s_xor_b32 s39, s3, 2
  s_mul_i32 s39, s39, 12288
  s_add_u32 s39, s39, 114688
  v_add_u32 v12, s39, v9
  s_xor_b32 s39, s3, 3
  s_mul_i32 s39, s39, 12288
  s_add_u32 s39, s39, 114688
  v_add_u32 v13, s39, v9
  s_waitcnt vmcnt(16)
  v_mfma_f32_32x32x16_bf16 a[0:15], a[128:131], v[80:83], 0
  v_mfma_f32_32x32x16_bf16 a[16:31], a[132:135], v[80:83], 0
  buffer_load_dwordx4 v[144:147], v9, s[16:19], s30 offen offset:3072 sc1
  buffer_load_dwordx4 v[148:151], v9, s[16:19], s31 offen offset:3072 sc1
  s_waitcnt vmcnt(17)
  v_mfma_f32_32x32x16_bf16 a[32:47], a[128:131], v[84:87], 0
  v_mfma_f32_32x32x16_bf16 a[48:63], a[132:135], v[84:87], 0
  s_waitcnt vmcnt(16)
  v_mfma_f32_32x32x16_bf16 a[0:15], a[136:139], v[88:91], a[0:15]
  v_mfma_f32_32x32x16_bf16 a[16:31], a[140:143], v[88:91], a[16:31]
  s_add_u32 s30, s30, 4096
  s_add_u32 s31, s31, 4096
  buffer_load_dwordx4 v[152:155], v9, s[16:19], s30 offen offset:0 sc1
  buffer_load_dwordx4 v[156:159], v9, s[16:19], s31 offen offset:0 sc1
  s_waitcnt vmcnt(17)
  v_mfma_f32_32x32x16_bf16 a[32:47], a[136:139], v[92:95], a[32:47]
  v_mfma_f32_32x32x16_bf16 a[48:63], a[140:143], v[92:95], a[48:63]
  s_waitcnt vmcnt(16)
  v_mfma_f32_32x32x16_bf16 a[0:15], v[232:235], v[96:99], a[0:15]
  v_mfma_f32_32x32x16_bf16 a[16:31], v[236:239], v[96:99], a[16:31]
  buffer_load_dwordx4 v[80:83], v9, s[16:19], s30 offen offset:2048 sc1
  buffer_load_dwordx4 v[84:87], v9, s[16:19], s31 offen offset:2048 sc1
  s_waitcnt vmcnt(17)
  v_mfma_f32_32x32x16_bf16 a[32:47], v[232:235], v[100:103], a[32:47]
  v_mfma_f32_32x32x16_bf16 a[48:63], v[236:239], v[100:103], a[48:63]
  s_waitcnt vmcnt(16)
  v_mfma_f32_32x32x16_bf16 a[0:15], v[240:243], v[104:107], a[0:15]
  v_mfma_f32_32x32x16_bf16 a[16:31], v[244:247], v[104:107], a[16:31]
  buffer_load_dwordx4 v[88:91], v9, s[16:19], s30 offen offset:3072 sc1
  buffer_load_dwordx4 v[92:95], v9, s[16:19], s31 offen offset:3072 sc1
  s_waitcnt vmcnt(17)
  v_mfma_f32_32x32x16_bf16 a[32:47], v[240:243], v[108:111], a[32:47]
  v_mfma_f32_32x32x16_bf16 a[48:63], v[244:247], v[108:111], a[48:63]
  s_waitcnt vmcnt(16)
  v_mfma_f32_32x32x16_bf16 a[0:15], a[160:163], v[112:115], a[0:15]
  v_mfma_f32_32x32x16_bf16 a[16:31], a[164:167], v[112:115], a[16:31]
  s_add_u32 s30, s30, 6144
  s_add_u32 s31, s31, 6144
  buffer_load_dwordx4 v[96:99], v9, s[16:19], s30 offen offset:0 sc1
  buffer_load_dwordx4 v[100:103], v9, s[16:19], s31 offen offset:0 sc1
  s_waitcnt vmcnt(17)
  v_mfma_f32_32x32x16_bf16 a[32:47], a[160:163], v[116:119], a[32:47]
  v_mfma_f32_32x32x16_bf16 a[48:63], a[164:167], v[116:119], a[48:63]
  s_add_u32 s35, s15, 21602304
  buffer_load_dwordx2 v[6:7], v8, s[16:19], s35 offen sc1
  s_waitcnt vmcnt(16)
  v_mfma_f32_32x32x16_bf16 a[0:15], a[168:171], v[120:123], a[0:15]
  v_mfma_f32_32x32x16_bf16 a[16:31], a[172:175], v[120:123], a[16:31]
  buffer_load_dwordx4 v[104:107], v9, s[16:19], s30 offen offset:1024 sc1
  buffer_load_dwordx4 v[108:111], v9, s[16:19], s31 offen offset:1024 sc1
  s_waitcnt vmcnt(17)
  v_mfma_f32_32x32x16_bf16 a[32:47], a[168:171], v[124:127], a[32:47]
  v_mfma_f32_32x32x16_bf16 a[48:63], a[172:175], v[124:127], a[48:63]
  s_waitcnt vmcnt(16)
  v_mfma_f32_32x32x16_bf16 a[0:15], v[16:19], v[128:131], a[0:15]
  v_mfma_f32_32x32x16_bf16 a[16:31], v[20:23], v[128:131], a[16:31]
  buffer_load_dwordx4 v[112:115], v9, s[16:19], s30 offen offset:3072 sc1
  buffer_load_dwordx4 v[116:119], v9, s[16:19], s31 offen offset:3072 sc1
  s_waitcnt vmcnt(17)
  v_mfma_f32_32x32x16_bf16 a[32:47], v[16:19], v[132:135], a[32:47]
  v_mfma_f32_32x32x16_bf16 a[48:63], v[20:23], v[132:135], a[48:63]
  s_waitcnt vmcnt(16)
  v_mfma_f32_32x32x16_bf16 a[0:15], v[24:27], v[136:139], a[0:15]
  v_mfma_f32_32x32x16_bf16 a[16:31], v[28:31], v[136:139], a[16:31]
  s_add_u32 s30, s30, 4096
  s_add_u32 s31, s31, 4096
  buffer_load_dwordx4 v[120:123], v9, s[16:19], s30 offen offset:0 sc1
  buffer_load_dwordx4 v[124:127], v9, s[16:19], s31 offen offset:0 sc1
  s_waitcnt vmcnt(17)
  v_mfma_f32_32x32x16_bf16 a[32:47], v[24:27], v[140:143], a[32:47]
  v_mfma_f32_32x32x16_bf16 a[48:63], v[28:31], v[140:143], a[48:63]
  s_waitcnt vmcnt(6)
  v_cmp_ne_u32 vcc, s14, v6
  s_nop 4
  s_cbranch_vccnz D_pw1
D_pb1:
  v_mfma_f32_32x32x16_bf16 a[0:15], a[192:195], v[144:147], a[0:15]
  v_mfma_f32_32x32x16_bf16 a[16:31], a[196:199], v[144:147], a[16:31]
  s_add_u32 s30, s30, 4294939648
  s_add_u32 s31, s31, 4294939648
  buffer_load_dwordx4 v[128:131], v9, s[16:19], s30 offen offset:0 sc1
  buffer_load_dwordx4 v[132:135], v9, s[16:19], s31 offen offset:0 sc1
  v_mfma_f32_32x32x16_bf16 a[32:47], a[192:195], v[148:151], a[32:47]
  v_mfma_f32_32x32x16_bf16 a[48:63], a[196:199], v[148:151], a[48:63]
  v_mfma_f32_32x32x16_bf16 a[0:15], a[200:203], v[152:155], a[0:15]
  v_mfma_f32_32x32x16_bf16 a[16:31], a[204:207], v[152:155], a[16:31]
  buffer_load_dwordx4 v[136:139], v9, s[16:19], s30 offen offset:1024 sc1
  buffer_load_dwordx4 v[140:143], v9, s[16:19], s31 offen offset:1024 sc1
  v_mfma_f32_32x32x16_bf16 a[32:47], a[200:203], v[156:159], a[32:47]
  v_mfma_f32_32x32x16_bf16 a[48:63], a[204:207], v[156:159], a[48:63]
  v_mfma_f32_32x32x16_bf16 a[0:15], v[40:43], v[80:83], a[0:15]
  v_mfma_f32_32x32x16_bf16 a[16:31], v[44:47], v[80:83], a[16:31]
  s_add_u32 s30, s30, 4096
  s_add_u32 s31, s31, 4096
  buffer_load_dwordx4 v[144:147], v9, s[16:19], s30 offen offset:0 sc1
  buffer_load_dwordx4 v[148:151], v9, s[16:19], s31 offen offset:0 sc1
  v_mfma_f32_32x32x16_bf16 a[32:47], v[40:43], v[84:87], a[32:47]
  v_mfma_f32_32x32x16_bf16 a[48:63], v[44:47], v[84:87], a[48:63]
  v_mfma_f32_32x32x16_bf16 a[0:15], v[48:51], v[88:91], a[0:15]
  v_mfma_f32_32x32x16_bf16 a[16:31], v[52:55], v[88:91], a[16:31]
  buffer_load_dwordx4 v[152:155], v9, s[16:19], s30 offen offset:3072 sc1
  buffer_load_dwordx4 v[156:159], v9, s[16:19], s31 offen offset:3072 sc1
  v_mfma_f32_32x32x16_bf16 a[32:47], v[48:51], v[92:95], a[32:47]
  v_mfma_f32_32x32x16_bf16 a[48:63], v[52:55], v[92:95], a[48:63]
  v_mfma_f32_32x32x16_bf16 a[0:15], a[224:227], v[96:99], a[0:15]
  v_mfma_f32_32x32x16_bf16 a[16:31], a[228:231], v[96:99], a[16:31]
  s_add_u32 s30, s30, 4096
  s_add_u32 s31, s31, 4096
  buffer_load_dwordx4 v[80:83], v9, s[16:19], s30 offen offset:0 sc1
  buffer_load_dwordx4 v[84:87], v9, s[16:19], s31 offen offset:0 sc1
  v_mfma_f32_32x32x16_bf16 a[32:47], a[224:227], v[100:103], a[32:47]
  v_mfma_f32_32x32x16_bf16 a[48:63], a[228:231], v[100:103], a[48:63]
  s_waitcnt vmcnt(15)
  v_mfma_f32_32x32x16_bf16 a[0:15], a[232:235], v[104:107], a[0:15]
  v_mfma_f32_32x32x16_bf16 a[16:31], a[236:239], v[104:107], a[16:31]
  buffer_load_dwordx4 v[88:91], v9, s[16:19], s30 offen offset:3072 sc1
  buffer_load_dwordx4 v[92:95], v9, s[16:19], s31 offen offset:3072 sc1
  s_waitcnt vmcnt(16)
  v_mfma_f32_32x32x16_bf16 a[32:47], a[232:235], v[108:111], a[32:47]
  v_mfma_f32_32x32x16_bf16 a[48:63], a[236:239], v[108:111], a[48:63]
  s_waitcnt vmcnt(15)
  v_mfma_f32_32x32x16_bf16 a[0:15], v[64:67], v[112:115], a[0:15]
  v_mfma_f32_32x32x16_bf16 a[16:31], v[68:71], v[112:115], a[16:31]
  s_add_u32 s30, s30, 6144
  s_add_u32 s31, s31, 6144
  buffer_load_dwordx4 v[96:99], v9, s[16:19], s30 offen offset:0 sc1
  buffer_load_dwordx4 v[100:103], v9, s[16:19], s31 offen offset:0 sc1
  s_waitcnt vmcnt(16)
  v_mfma_f32_32x32x16_bf16 a[32:47], v[64:67], v[116:119], a[32:47]
  v_mfma_f32_32x32x16_bf16 a[48:63], v[68:71], v[116:119], a[48:63]
  s_waitcnt vmcnt(15)
  v_mfma_f32_32x32x16_bf16 a[0:15], v[72:75], v[120:123], a[0:15]
  v_mfma_f32_32x32x16_bf16 a[16:31], v[76:79], v[120:123], a[16:31]
  buffer_load_dwordx4 v[104:107], v9, s[16:19], s30 offen offset:1024 sc1
  buffer_load_dwordx4 v[108:111], v9, s[16:19], s31 offen offset:1024 sc1
  s_waitcnt vmcnt(16)
  v_mfma_f32_32x32x16_bf16 a[32:47], v[72:75], v[124:127], a[32:47]
  v_mfma_f32_32x32x16_bf16 a[48:63], v[76:79], v[124:127], a[48:63]
  s_waitcnt vmcnt(15)
  v_mfma_f32_32x32x16_bf16 a[0:15], a[112:115], v[128:131], a[0:15]
  v_mfma_f32_32x32x16_bf16 a[16:31], a[116:119], v[128:131], a[16:31]
  s_add_u32 s30, s30, 4096
  s_add_u32 s31, s31, 4096
  buffer_load_dwordx4 v[112:115], v9, s[16:19], s30 offen offset:0 sc1
  buffer_load_dwordx4 v[116:119], v9, s[16:19], s31 offen offset:0 sc1
  s_waitcnt vmcnt(16)
  v_mfma_f32_32x32x16_bf16 a[32:47], a[112:115], v[132:135], a[32:47]
  v_mfma_f32_32x32x16_bf16 a[48:63], a[116:119], v[132:135], a[48:63]
  s_waitcnt vmcnt(15)
  v_mfma_f32_32x32x16_bf16 a[0:15], a[120:123], v[136:139], a[0:15]
  v_mfma_f32_32x32x16_bf16 a[16:31], a[124:127], v[136:139], a[16:31]
  buffer_load_dwordx4 v[120:123], v9, s[16:19], s30 offen offset:3072 sc1
  buffer_load_dwordx4 v[124:127], v9, s[16:19], s31 offen offset:3072 sc1
  s_waitcnt vmcnt(16)
  v_mfma_f32_32x32x16_bf16 a[32:47], a[120:123], v[140:143], a[32:47]
  v_mfma_f32_32x32x16_bf16 a[48:63], a[124:127], v[140:143], a[48:63]
  s_waitcnt vmcnt(15)
  v_mfma_f32_32x32x16_bf16 a[0:15], a[240:243], v[144:147], a[0:15]
  v_mfma_f32_32x32x16_bf16 a[16:31], a[244:247], v[144:147], a[16:31]
  s_add_u32 s30, s30, 4096
  s_add_u32 s31, s31, 4096
  buffer_load_dwordx4 v[128:131], v9, s[16:19], s30 offen offset:0 sc1
  buffer_load_dwordx4 v[132:135], v9, s[16:19], s31 offen offset:0 sc1
  s_waitcnt vmcnt(16)
  v_mfma_f32_32x32x16_bf16 a[32:47], a[240:243], v[148:151], a[32:47]
  v_mfma_f32_32x32x16_bf16 a[48:63], a[244:247], v[148:151], a[48:63]
  s_waitcnt vmcnt(15)
  v_mfma_f32_32x32x16_bf16 a[0:15], a[144:147], v[152:155], a[0:15]
  v_mfma_f32_32x32x16_bf16 a[16:31], a[148:151], v[152:155], a[16:31]
  buffer_load_dwordx4 v[136:139], v9, s[16:19], s30 offen offset:3072 sc1
  buffer_load_dwordx4 v[140:143], v9, s[16:19], s31 offen offset:3072 sc1
  s_waitcnt vmcnt(16)
  v_mfma_f32_32x32x16_bf16 a[32:47], a[144:147], v[156:159], a[32:47]
  v_mfma_f32_32x32x16_bf16 a[48:63], a[148:151], v[156:159], a[48:63]
  s_waitcnt vmcnt(15)
  v_mfma_f32_32x32x16_bf16 a[0:15], a[152:155], v[80:83], a[0:15]
  v_mfma_f32_32x32x16_bf16 a[16:31], a[156:159], v[80:83], a[16:31]
  s_waitcnt vmcnt(14)
  v_mfma_f32_32x32x16_bf16 a[32:47], a[152:155], v[84:87], a[32:47]
  v_mfma_f32_32x32x16_bf16 a[48:63], a[156:159], v[84:87], a[48:63]
  s_waitcnt vmcnt(13)
  v_mfma_f32_32x32x16_bf16 a[0:15], v[248:251], v[88:91], a[0:15]
  v_mfma_f32_32x32x16_bf16 a[16:31], v[252:255], v[88:91], a[16:31]
  s_waitcnt vmcnt(12)
  v_mfma_f32_32x32x16_bf16 a[32:47], v[248:251], v[92:95], a[32:47]
  v_mfma_f32_32x32x16_bf16 a[48:63], v[252:255], v[92:95], a[48:63]
  s_waitcnt vmcnt(11)
  v_mfma_f32_32x32x16_bf16 a[0:15], a[176:179], v[96:99], a[0:15]
  v_mfma_f32_32x32x16_bf16 a[16:31], a[180:183], v[96:99], a[16:31]
  s_waitcnt vmcnt(10)
  v_mfma_f32_32x32x16_bf16 a[32:47], a[176:179], v[100:103], a[32:47]
  v_mfma_f32_32x32x16_bf16 a[48:63], a[180:183], v[100:103], a[48:63]
  s_waitcnt vmcnt(9)
  v_mfma_f32_32x32x16_bf16 a[0:15], a[184:187], v[104:107], a[0:15]
  v_mfma_f32_32x32x16_bf16 a[16:31], a[188:191], v[104:107], a[16:31]
  s_waitcnt vmcnt(8)
  v_mfma_f32_32x32x16_bf16 a[32:47], a[184:187], v[108:111], a[32:47]
  v_mfma_f32_32x32x16_bf16 a[48:63], a[188:191], v[108:111], a[48:63]
  s_waitcnt vmcnt(7)
  v_mfma_f32_32x32x16_bf16 a[0:15], v[32:35], v[112:115], a[0:15]
  v_mfma_f32_32x32x16_bf16 a[16:31], v[36:39], v[112:115], a[16:31]
  s_waitcnt vmcnt(6)
  v_mfma_f32_32x32x16_bf16 a[32:47], v[32:35], v[116:119], a[32:47]
  v_mfma_f32_32x32x16_bf16 a[48:63], v[36:39], v[116:119], a[48:63]
  s_waitcnt vmcnt(5)
  v_mfma_f32_32x32x16_bf16 a[0:15], a[208:211], v[120:123], a[0:15]
  v_mfma_f32_32x32x16_bf16 a[16:31], a[212:215], v[120:123], a[16:31]
  s_waitcnt vmcnt(4)
  v_mfma_f32_32x32x16_bf16 a[32:47], a[208:211], v[124:127], a[32:47]
  v_mfma_f32_32x32x16_bf16 a[48:63], a[212:215], v[124:127], a[48:63]
  s_waitcnt vmcnt(3)
  v_mfma_f32_32x32x16_bf16 a[0:15], a[216:219], v[128:131], a[0:15]
  v_mfma_f32_32x32x16_bf16 a[16:31], a[220:223], v[128:131], a[16:31]
  s_waitcnt vmcnt(2)
  v_mfma_f32_32x32x16_bf16 a[32:47], a[216:219], v[132:135], a[32:47]
  v_mfma_f32_32x32x16_bf16 a[48:63], a[220:223], v[132:135], a[48:63]
  s_waitcnt vmcnt(1)
  v_mfma_f32_32x32x16_bf16 a[0:15], v[56:59], v[136:139], a[0:15]
  v_mfma_f32_32x32x16_bf16 a[16:31], v[60:63], v[136:139], a[16:31]
  s_waitcnt vmcnt(0)
  v_mfma_f32_32x32x16_bf16 a[32:47], v[56:59], v[140:143], a[32:47]
  v_mfma_f32_32x32x16_bf16 a[48:63], v[60:63], v[140:143], a[48:63]
  s_nop 3
  ds_write_b128 v11, a[16:19] offset:0
  ds_write_b128 v11, a[20:23] offset:1024
  ds_write_b128 v11, a[24:27] offset:2048
  ds_write_b128 v11, a[28:31] offset:3072
  ds_write_b128 v12, a[32:35] offset:4096
  ds_write_b128 v12, a[36:39] offset:5120
  ds_write_b128 v12, a[40:43] offset:6144
  ds_write_b128 v12, a[44:47] offset:7168
  s_nop 7
  ds_write_b128 v13, a[48:51] offset:8192
  ds_write_b128 v13, a[52:55] offset:9216
  ds_write_b128 v13, a[56:59] offset:10240
  ds_write_b128 v13, a[60:63] offset:11264
  v_accvgpr_read_b32 v14, a248
  v_lshlrev_b32 v15, 16, v14
  v_and_b32 v14, 0xffff0000, v14
  v_accvgpr_read_b32 v80, a0
  v_accvgpr_read_b32 v81, a1
  v_pk_add_f32 v[80:81], v[80:81], v[14:15] op_sel:[0,1] op_sel_hi:[1,0]
  v_accvgpr_read_b32 v14, a249
  v_lshlrev_b32 v15, 16, v14
  v_and_b32 v14, 0xffff0000, v14
  v_accvgpr_read_b32 v82, a2
  v_accvgpr_read_b32 v83, a3
  v_pk_add_f32 v[82:83], v[82:83], v[14:15] op_sel:[0,1] op_sel_hi:[1,0]
  v_accvgpr_read_b32 v14, a250
  v_lshlrev_b32 v15, 16, v14
  v_and_b32 v14, 0xffff0000, v14
  v_accvgpr_read_b32 v84, a4
  v_accvgpr_read_b32 v85, a5
  v_pk_add_f32 v[84:85], v[84:85], v[14:15] op_sel:[0,1] op_sel_hi:[1,0]
  v_accvgpr_read_b32 v14, a251
  v_lshlrev_b32 v15, 16, v14
  v_and_b32 v14, 0xffff0000, v14
  v_accvgpr_read_b32 v86, a6
  v_accvgpr_read_b32 v87, a7
  v_pk_add_f32 v[86:87], v[86:87], v[14:15] op_sel:[0,1] op_sel_hi:[1,0]
  v_accvgpr_read_b32 v14, a252
  v_lshlrev_b32 v15, 16, v14
  v_and_b32 v14, 0xffff0000, v14
  v_accvgpr_read_b32 v88, a8
  v_accvgpr_read_b32 v89, a9
  v_pk_add_f32 v[88:89], v[88:89], v[14:15] op_sel:[0,1] op_sel_hi:[1,0]
  v_accvgpr_read_b32 v14, a253
  v_lshlrev_b32 v15, 16, v14
  v_and_b32 v14, 0xffff0000, v14
  v_accvgpr_read_b32 v90, a10
  v_accvgpr_read_b32 v91, a11
  v_pk_add_f32 v[90:91], v[90:91], v[14:15] op_sel:[0,1] op_sel_hi:[1,0]
  v_accvgpr_read_b32 v14, a254
  v_lshlrev_b32 v15, 16, v14
  v_and_b32 v14, 0xffff0000, v14
  v_accvgpr_read_b32 v92, a12
  v_accvgpr_read_b32 v93, a13
  v_pk_add_f32 v[92:93], v[92:93], v[14:15] op_sel:[0,1] op_sel_hi:[1,0]
  v_accvgpr_read_b32 v14, a255
  v_lshlrev_b32 v15, 16, v14
  v_and_b32 v14, 0xffff0000, v14
  v_accvgpr_read_b32 v94, a14
  v_accvgpr_read_b32 v95, a15
  v_pk_add_f32 v[94:95], v[94:95], v[14:15] op_sel:[0,1] op_sel_hi:[1,0]
  s_waitcnt lgkmcnt(0)
  s_barrier
  ds_read_b128 v[96:99], v10 offset:0
  ds_read_b128 v[100:103], v10 offset:1024
  ds_read_b128 v[104:107], v10 offset:2048
  ds_read_b128 v[108:111], v10 offset:3072
  ds_read_b128 v[112:115], v10 offset:4096
  ds_read_b128 v[116:119], v10 offset:5120
  ds_read_b128 v[120:123], v10 offset:6144
  ds_read_b128 v[124:127], v10 offset:7168
  ds_read_b128 v[128:131], v10 offset:8192
  ds_read_b128 v[132:135], v10 offset:9216
  ds_read_b128 v[136:139], v10 offset:10240
  ds_read_b128 v[140:143], v10 offset:11264
  s_waitcnt lgkmcnt(8)
  v_pk_add_f32 v[80:81], v[80:81], v[96:97]
  v_pk_add_f32 v[82:83], v[82:83], v[98:99]
  v_pk_add_f32 v[84:85], v[84:85], v[100:101]
  v_pk_add_f32 v[86:87], v[86:87], v[102:103]
  v_pk_add_f32 v[88:89], v[88:89], v[104:105]
  v_pk_add_f32 v[90:91], v[90:91], v[106:107]
  v_pk_add_f32 v[92:93], v[92:93], v[108:109]
  v_pk_add_f32 v[94:95], v[94:95], v[110:111]
  s_waitcnt lgkmcnt(4)
  v_pk_add_f32 v[80:81], v[80:81], v[112:113]
  v_pk_add_f32 v[82:83], v[82:83], v[114:115]
  v_pk_add_f32 v[84:85], v[84:85], v[116:117]
  v_pk_add_f32 v[86:87], v[86:87], v[118:119]
  v_pk_add_f32 v[88:89], v[88:89], v[120:121]
  v_pk_add_f32 v[90:91], v[90:91], v[122:123]
  v_pk_add_f32 v[92:93], v[92:93], v[124:125]
  v_pk_add_f32 v[94:95], v[94:95], v[126:127]
  s_waitcnt lgkmcnt(0)
  v_pk_add_f32 v[80:81], v[80:81], v[128:129]
  v_pk_add_f32 v[82:83], v[82:83], v[130:131]
  v_pk_add_f32 v[84:85], v[84:85], v[132:133]
  v_pk_add_f32 v[86:87], v[86:87], v[134:135]
  v_pk_add_f32 v[88:89], v[88:89], v[136:137]
  v_pk_add_f32 v[90:91], v[90:91], v[138:139]
  v_pk_add_f32 v[92:93], v[92:93], v[140:141]
  v_pk_add_f32 v[94:95], v[94:95], v[142:143]
  v_cvt_pk_bf16_f32 v96, v80, v81
  v_cvt_pk_bf16_f32 v97, v82, v83
  v_cvt_pk_bf16_f32 v98, v84, v85
  v_cvt_pk_bf16_f32 v99, v86, v87
  v_cvt_pk_bf16_f32 v100, v88, v89
  v_cvt_pk_bf16_f32 v101, v90, v91
  v_cvt_pk_bf16_f32 v102, v92, v93
  v_cvt_pk_bf16_f32 v103, v94, v95
  s_mov_b32 s20, s58
  s_mov_b32 s21, s59
  s_mov_b32 s22, 0x1c0000
  s_mov_b32 s23, 0x20000
  v_mul_u32_u24 v5, 896, v3
  v_lshl_add_u32 v5, v4, 3, v5
  s_mul_i32 s37, s24, 28672
  s_lshl_b32 s38, s25, 6
  s_add_u32 s37, s37, s38
  buffer_store_dwordx2 v[96:97], v5, s[20:23], s37 offen offset:0
  buffer_store_dwordx2 v[98:99], v5, s[20:23], s37 offen offset:16
  buffer_store_dwordx2 v[100:101], v5, s[20:23], s37 offen offset:32
  buffer_store_dwordx2 v[102:103], v5, s[20:23], s37 offen offset:48
D_fin1:
  s_endpgm
A_pw:
  s_mov_b32 s34, 200000
A_pw1:
  buffer_load_dwordx4 v[232:235], v9, s[16:19], s31 offen sc1
  s_waitcnt vmcnt(0)
  v_and_b32 v236, -16, v232
  v_and_b32 v237, -16, v233
  v_and_b32 v238, -16, v234
  v_and_b32 v239, -16, v235
  v_cmp_ne_u32 vcc, s14, v236
  v_cmp_ne_u32 s[36:37], s14, v237
  v_cmp_ne_u32 s[38:39], s14, v238
  v_cmp_ne_u32 s[32:33], s14, v239
  s_or_b64 vcc, vcc, s[36:37]
  s_nop 0
  s_or_b64 s[38:39], s[38:39], s[32:33]
  s_or_b64 vcc, vcc, s[38:39]
  s_cbranch_scc0 A_pb
  s_sub_u32 s34, s34, 1
  s_cmp_lg_u32 s34, 0
  s_cbranch_scc1 A_pw1
  s_branch A_pb
D_pw0:
  s_mov_b32 s39, 200000
D_pw0x:
  buffer_load_dwordx2 v[6:7], v8, s[16:19], s35 offen sc1
  s_waitcnt vmcnt(0)
  v_cmp_ne_u32 vcc, s14, v6
  s_nop 4
  s_cbranch_vccz D_pb0
  s_sub_u32 s39, s39, 1
  s_cmp_lg_u32 s39, 0
  s_cbranch_scc1 D_pw0x
  s_branch D_pb0
D_pw1:
  s_mov_b32 s39, 200000
D_pw1x:
  buffer_load_dwordx2 v[6:7], v8, s[16:19], s35 offen sc1
  s_waitcnt vmcnt(0)
  v_cmp_ne_u32 vcc, s14, v6
  s_nop 4
  s_cbranch_vccz D_pb1
  s_sub_u32 s39, s39, 1
  s_cmp_lg_u32 s39, 0
  s_cbranch_scc1 D_pw1x
  s_branch D_pb1
A_fb0:
  v_mov_b32 v144, 0xff800000
  v_mov_b32 v145, 0xff800000
  v_mov_b32 v146, 0xff800000
  v_mov_b32 v147, 0xff800000
  s_mov_b32 s36, 0
A_mx0:
  buffer_load_dwordx4 v[96:99], v9, s[20:23], s36 offen sc1
  buffer_load_dwordx4 v[100:103], v9, s[20:23], s36 offen offset:1024 sc1
  s_waitcnt vmcnt(0)
  v_mfma_f32_32x32x16_bf16 v[112:127], v[96:99], v[16:19], 0
  v_mfma_f32_32x32x16_bf16 v[112:127], v[100:103], v[20:23], v[112:127]
  s_nop 15
  v_max3_f32 v144, v144, v112, v113
  v_max3_f32 v144, v144, v114, v115
  v_max3_f32 v144, v144, v116, v117
  v_max3_f32 v144, v144, v118, v119
  v_max3_f32 v144, v144, v120, v121
  v_max3_f32 v144, v144, v122, v123
  v_max3_f32 v144, v144, v124, v125
  v_max3_f32 v144, v144, v126, v127
  v_mfma_f32_32x32x16_bf16 v[112:127], v[96:99], v[24:27], 0
  v_mfma_f32_32x32x16_bf16 v[112:127], v[100:103], v[28:31], v[112:127]
  s_nop 15
  v_max3_f32 v145, v145, v112, v113
  v_max3_f32 v145, v145, v114, v115
  v_max3_f32 v145, v145, v116, v117
  v_max3_f32 v145, v145, v118, v119
  v_max3_f32 v145, v145, v120, v121
  v_max3_f32 v145, v145, v122, v123
  v_max3_f32 v145, v145, v124, v125
  v_max3_f32 v145, v145, v126, v127
  v_mfma_f32_32x32x16_bf16 v[112:127], v[96:99], v[32:35], 0
  v_mfma_f32_32x32x16_bf16 v[112:127], v[100:103], v[36:39], v[112:127]
  s_nop 15
  v_max3_f32 v146, v146, v112, v113
  v_max3_f32 v146, v146, v114, v115
  v_max3_f32 v146, v146, v116, v117
  v_max3_f32 v146, v146, v118, v119
  v_max3_f32 v146, v146, v120, v121
  v_max3_f32 v146, v146, v122, v123
  v_max3_f32 v146, v146, v124, v125
  v_max3_f32 v146, v146, v126, v127
  v_mfma_f32_32x32x16_bf16 v[112:127], v[96:99], v[40:43], 0
  v_mfma_f32_32x32x16_bf16 v[112:127], v[100:103], v[44:47], v[112:127]
  s_nop 15
  v_max3_f32 v147, v147, v112, v113
  v_max3_f32 v147, v147, v114, v115
  v_max3_f32 v147, v147, v116, v117
  v_max3_f32 v147, v147, v118, v119
  v_max3_f32 v147, v147, v120, v121
  v_max3_f32 v147, v147, v122, v123
  v_max3_f32 v147, v147, v124, v125
  v_max3_f32 v147, v147, v126, v127
  s_add_u32 s36, s36, 4096
  s_cmp_lt_u32 s36, 65536
  s_cbranch_scc1 A_mx0
  s_add_u32 s28, s3, 1
  s_and_b32 s28, s28, 3
  s_lshl_b32 s28, s28, 10
  s_add_u32 s28, s28, 114688
  s_lshl_b32 s29, s3, 8
  s_add_u32 s29, s29, s28
  v_add_u32 v14, s29, v8
  ds_write_b32 v14, v144
  v_lshl_add_u32 v148, v3, 2, s28
  s_add_u32 s28, s3, 2
  s_and_b32 s28, s28, 3
  s_lshl_b32 s28, s28, 10
  s_add_u32 s28, s28, 114688
  s_lshl_b32 s29, s3, 8
  s_add_u32 s29, s29, s28
  v_add_u32 v14, s29, v8
  ds_write_b32 v14, v145
  v_lshl_add_u32 v149, v3, 2, s28
  s_add_u32 s28, s3, 3
  s_and_b32 s28, s28, 3
  s_lshl_b32 s28, s28, 10
  s_add_u32 s28, s28, 114688
  s_lshl_b32 s29, s3, 8
  s_add_u32 s29, s29, s28
  v_add_u32 v14, s29, v8
  ds_write_b32 v14, v146
  v_lshl_add_u32 v150, v3, 2, s28
  s_add_u32 s28, s3, 4
  s_and_b32 s28, s28, 3
  s_lshl_b32 s28, s28, 10
  s_add_u32 s28, s28, 114688
  s_lshl_b32 s29, s3, 8
  s_add_u32 s29, s29, s28
  v_add_u32 v14, s29, v8
  ds_write_b32 v14, v147
  v_lshl_add_u32 v151, v3, 2, s28
  s_waitcnt lgkmcnt(0)
  s_barrier
  ds_read_b32 v112, v148 offset:0
  ds_read_b32 v113, v148 offset:128
  ds_read_b32 v114, v148 offset:256
  ds_read_b32 v115, v148 offset:384
  ds_read_b32 v116, v148 offset:512
  ds_read_b32 v117, v148 offset:640
  ds_read_b32 v118, v148 offset:768
  ds_read_b32 v119, v148 offset:896
  s_waitcnt lgkmcnt(0)
  v_max3_f32 v112, v112, v113, v114
  v_max3_f32 v112, v112, v115, v116
  v_max3_f32 v112, v112, v117, v118
  v_max_f32 v112, v112, v119
  v_sub_f32 v112, 0, v112
  v_cvt_pk_bf16_f32 v113, v112, 0
  v_lshlrev_b32 v114, 16, v113
  v_sub_f32 v114, v112, v114
  v_cvt_pk_bf16_f32 v113, v112, v114
  v_and_b32 v115, 0xffff0000, v113
  v_sub_f32 v114, v114, v115
  v_cvt_pk_bf16_f32 v114, v114, 0
  v_cndmask_b32 v22, v22, v113, s[62:63]
  v_cndmask_b32 v23, v23, v114, s[62:63]
  ds_read_b32 v112, v149 offset:0
  ds_read_b32 v113, v149 offset:128
  ds_read_b32 v114, v149 offset:256
  ds_read_b32 v115, v149 offset:384
  ds_read_b32 v116, v149 offset:512
  ds_read_b32 v117, v149 offset:640
  ds_read_b32 v118, v149 offset:768
  ds_read_b32 v119, v149 offset:896
  s_waitcnt lgkmcnt(0)
  v_max3_f32 v112, v112, v113, v114
  v_max3_f32 v112, v112, v115, v116
  v_max3_f32 v112, v112, v117, v118
  v_max_f32 v112, v112, v119
  v_sub_f32 v112, 0, v112
  v_cvt_pk_bf16_f32 v113, v112, 0
  v_lshlrev_b32 v114, 16, v113
  v_sub_f32 v114, v112, v114
  v_cvt_pk_bf16_f32 v113, v112, v114
  v_and_b32 v115, 0xffff0000, v113
  v_sub_f32 v114, v114, v115
  v_cvt_pk_bf16_f32 v114, v114, 0
  v_cndmask_b32 v30, v30, v113, s[62:63]
  v_cndmask_b32 v31, v31, v114, s[62:63]
  ds_read_b32 v112, v150 offset:0
  ds_read_b32 v113, v150 offset:128
  ds_read_b32 v114, v150 offset:256
  ds_read_b32 v115, v150 offset:384
  ds_read_b32 v116, v150 offset:512
  ds_read_b32 v117, v150 offset:640
  ds_read_b32 v118, v150 offset:768
  ds_read_b32 v119, v150 offset:896
  s_waitcnt lgkmcnt(0)
  v_max3_f32 v112, v112, v113, v114
  v_max3_f32 v112, v112, v115, v116
  v_max3_f32 v112, v112, v117, v118
  v_max_f32 v112, v112, v119
  v_sub_f32 v112, 0, v112
  v_cvt_pk_bf16_f32 v113, v112, 0
  v_lshlrev_b32 v114, 16, v113
  v_sub_f32 v114, v112, v114
  v_cvt_pk_bf16_f32 v113, v112, v114
  v_and_b32 v115, 0xffff0000, v113
  v_sub_f32 v114, v114, v115
  v_cvt_pk_bf16_f32 v114, v114, 0
  v_cndmask_b32 v38, v38, v113, s[62:63]
  v_cndmask_b32 v39, v39, v114, s[62:63]
  ds_read_b32 v112, v151 offset:0
  ds_read_b32 v113, v151 offset:128
  ds_read_b32 v114, v151 offset:256
  ds_read_b32 v115, v151 offset:384
  ds_read_b32 v116, v151 offset:512
  ds_read_b32 v117, v151 offset:640
  ds_read_b32 v118, v151 offset:768
  ds_read_b32 v119, v151 offset:896
  s_waitcnt lgkmcnt(0)
  v_max3_f32 v112, v112, v113, v114
  v_max3_f32 v112, v112, v115, v116
  v_max3_f32 v112, v112, v117, v118
  v_max_f32 v112, v112, v119
  v_sub_f32 v112, 0, v112
  v_cvt_pk_bf16_f32 v113, v112, 0
  v_lshlrev_b32 v114, 16, v113
  v_sub_f32 v114, v112, v114
  v_cvt_pk_bf16_f32 v113, v112, v114
  v_and_b32 v115, 0xffff0000, v113
  v_sub_f32 v114, v114, v115
  v_cvt_pk_bf16_f32 v114, v114, 0
  v_cndmask_b32 v46, v46, v113, s[62:63]
  v_cndmask_b32 v47, v47, v114, s[62:63]
  s_barrier
  s_branch A_go0
S5:
  buffer_store_dwordx4 v[160:163], v9, s[16:19], s27 offen sc1
  buffer_store_dwordx4 v[164:167], v9, s[16:19], s27 offen offset:1024 sc1
  s_branch S5b
S6:
  buffer_store_dwordx2 v[6:7], v1, s[16:19], s38 offen sc1
  s_branch S6b
S9:
  buffer_store_dwordx4 v[96:99], v9, s[16:19], s38 offen offset:0 sc1
  buffer_store_dwordx4 v[100:103], v9, s[16:19], s38 offen offset:1024 sc1
  s_branch S9b
S10:
  buffer_store_dwordx2 v[24:25], v6, s[16:19], s38 offen sc1
  s_branch S10b
S11:
  buffer_store_dwordx2 v[10:11], v1, s[16:19], s38 offen sc1
  s_branch S11b
O_skip0:
  s_sub_u32 s36, s11, 28
  s_lshl_b32 s36, s36, 2
  s_add_u32 s36, s36, s3
  s_mul_i32 s36, s36, 200704
  v_lshlrev_b32 v8, 7, v2
  v_and_b32 v6, 0xfff, v8
  s_add_u32 s37, s36, 114688
  buffer_load_dword v7, v8, s[16:19], s37 offen sc1
  s_add_u32 s37, s36, 122880
  buffer_load_dword v7, v8, s[16:19], s37 offen sc1
  s_add_u32 s37, s36, 131072
  buffer_load_dword v7, v8, s[16:19], s37 offen sc1
  s_add_u32 s37, s36, 139264
  buffer_load_dword v7, v6, s[16:19], s37 offen sc1
  s_add_u32 s37, s36, 143360
  buffer_load_dword v7, v8, s[16:19], s37 offen sc1
  s_add_u32 s37, s36, 151552
  buffer_load_dword v7, v8, s[16:19], s37 offen sc1
  s_add_u32 s37, s36, 159744
  buffer_load_dword v7, v8, s[16:19], s37 offen sc1
  s_add_u32 s37, s36, 167936
  buffer_load_dword v7, v6, s[16:19], s37 offen sc1
  s_branch O_join0
S14:
  buffer_store_dwordx4 v[224:227], v9, s[16:19], s33 offen offset:0 sc1
  s_branch S14b
S15:
  buffer_store_dwordx4 v[228:231], v9, s[16:19], s33 offen offset:1024 sc1
  s_branch S15b
S16:
  buffer_store_dwordx4 v[224:227], v9, s[16:19], s33 offen offset:2048 sc1
  s_branch S16b
S17:
  buffer_store_dwordx4 v[228:231], v9, s[16:19], s33 offen offset:3072 sc1
  s_branch S17b
S18:
  buffer_store_dwordx2 v[14:15], v1, s[16:19], s38 offen sc1
  s_branch S18b
S19:
  buffer_store_dwordx4 v[224:227], v9, s[16:19], s34 offen offset:0 sc1
  s_branch S19b
S20:
  buffer_store_dwordx4 v[228:231], v9, s[16:19], s34 offen offset:1024 sc1
  s_branch S20b
S21:
  buffer_store_dwordx4 v[224:227], v9, s[16:19], s34 offen offset:2048 sc1
  s_branch S21b
S22:
  buffer_store_dwordx2 v[10:11], v1, s[16:19], s38 offen sc1
  s_branch S22b
S23:
  buffer_store_dwordx2 v[10:11], v1, s[16:19], s38 offen sc1
  s_branch S23b
Da_pw0:
  s_add_u32 s38, s9, 21602304
  s_add_u32 s38, s38, s15
  v_mov_b32 v10, s14
  v_mov_b32 v11, 0
  v_mov_b32 v1, 0
  s_waitcnt vmcnt(0)
  s_mov_b64 exec, 1
  s_cmp_eq_u32 s61, 0
  s_cbranch_scc1 S23
  buffer_store_dwordx2 v[10:11], v1, s[16:19], s38 offen
S23b:
  s_mov_b64 exec, -1
  s_mov_b32 s39, 200000
W24:
  s_add_u32 s38, s15, 21594112
  buffer_load_dwordx2 v[6:7], v8, s[16:19], s38 offen sc1
  s_waitcnt vmcnt(0)
  v_cmp_ne_u32 vcc, s14, v6
  s_nop 1
  s_cmp_eq_u64 vcc, 0
  s_cbranch_scc1 Wd25
  s_sub_u32 s39, s39, 1
  s_cmp_lg_u32 s39, 0
  s_cbranch_scc1 W24
Wd25:
  buffer_load_dwordx4 v[80:83], v9, s[16:19], s30 offen offset:0 sc1
  buffer_load_dwordx4 v[84:87], v9, s[16:19], s31 offen offset:0 sc1
  buffer_load_dwordx4 v[88:91], v9, s[16:19], s30 offen offset:1024 sc1
  buffer_load_dwordx4 v[92:95], v9, s[16:19], s31 offen offset:1024 sc1
  buffer_load_dwordx4 v[96:99], v9, s[16:19], s30 offen offset:2048 sc1
  buffer_load_dwordx4 v[100:103], v9, s[16:19], s31 offen offset:2048 sc1
  buffer_load_dwordx4 v[104:107], v9, s[16:19], s30 offen offset:3072 sc1
  buffer_load_dwordx4 v[108:111], v9, s[16:19], s31 offen offset:3072 sc1
  s_add_u32 s30, s30, 7168
  s_add_u32 s31, s31, 7168
  buffer_load_dwordx4 v[112:115], v9, s[16:19], s30 offen offset:0 sc1
  buffer_load_dwordx4 v[116:119], v9, s[16:19], s31 offen offset:0 sc1
  s_waitcnt vmcnt(0)
  s_branch Da_pb0
S26:
  buffer_store_dwordx4 v[96:99], v9, s[16:19], s38 offen offset:0 sc1
  buffer_store_dwordx4 v[100:103], v9, s[16:19], s38 offen offset:1024 sc1
  s_branch S26b
S27:
  buffer_store_dwordx2 v[24:25], v6, s[16:19], s38 offen sc1
  s_branch S27b
S28:
  buffer_store_dwordx2 v[10:11], v1, s[16:19], s38 offen sc1
  s_branch S28b
S31:
  buffer_store_dwordx2 v[32:33], v16, s[16:19], s27 offen sc1
  buffer_store_dwordx2 v[34:35], v17, s[16:19], s27 offen sc1
  buffer_store_dwordx2 v[36:37], v18, s[16:19], s27 offen sc1
  buffer_store_dwordx2 v[38:39], v19, s[16:19], s27 offen sc1
  s_branch S31b
S32:
  buffer_store_dwordx2 v[10:11], v1, s[16:19], s38 offen sc1
  s_branch S32b
A_fb1:
  v_mov_b32 v144, 0xff800000
  v_mov_b32 v145, 0xff800000
  v_mov_b32 v146, 0xff800000
  v_mov_b32 v147, 0xff800000
  s_mov_b32 s36, 0
A_mx1:
  buffer_load_dwordx4 v[96:99], v9, s[20:23], s36 offen sc1
  buffer_load_dwordx4 v[100:103], v9, s[20:23], s36 offen offset:1024 sc1
  s_waitcnt vmcnt(0)
  v_mfma_f32_32x32x16_bf16 v[112:127], v[96:99], v[16:19], 0
  v_mfma_f32_32x32x16_bf16 v[112:127], v[100:103], v[20:23], v[112:127]
  s_nop 15
  v_max3_f32 v144, v144, v112, v113
  v_max3_f32 v144, v144, v114, v115
  v_max3_f32 v144, v144, v116, v117
  v_max3_f32 v144, v144, v118, v119
  v_max3_f32 v144, v144, v120, v121
  v_max3_f32 v144, v144, v122, v123
  v_max3_f32 v144, v144, v124, v125
  v_max3_f32 v144, v144, v126, v127
  v_mfma_f32_32x32x16_bf16 v[112:127], v[96:99], v[24:27], 0
  v_mfma_f32_32x32x16_bf16 v[112:127], v[100:103], v[28:31], v[112:127]
  s_nop 15
  v_max3_f32 v145, v145, v112, v113
  v_max3_f32 v145, v145, v114, v115
  v_max3_f32 v145, v145, v116, v117
  v_max3_f32 v145, v145, v118, v119
  v_max3_f32 v145, v145, v120, v121
  v_max3_f32 v145, v145, v122, v123
  v_max3_f32 v145, v145, v124, v125
  v_max3_f32 v145, v145, v126, v127
  v_mfma_f32_32x32x16_bf16 v[112:127], v[96:99], v[32:35], 0
  v_mfma_f32_32x32x16_bf16 v[112:127], v[100:103], v[36:39], v[112:127]
  s_nop 15
  v_max3_f32 v146, v146, v112, v113
  v_max3_f32 v146, v146, v114, v115
  v_max3_f32 v146, v146, v116, v117
  v_max3_f32 v146, v146, v118, v119
  v_max3_f32 v146, v146, v120, v121
  v_max3_f32 v146, v146, v122, v123
  v_max3_f32 v146, v146, v124, v125
  v_max3_f32 v146, v146, v126, v127
  v_mfma_f32_32x32x16_bf16 v[112:127], v[96:99], v[40:43], 0
  v_mfma_f32_32x32x16_bf16 v[112:127], v[100:103], v[44:47], v[112:127]
  s_nop 15
  v_max3_f32 v147, v147, v112, v113
  v_max3_f32 v147, v147, v114, v115
  v_max3_f32 v147, v147, v116, v117
  v_max3_f32 v147, v147, v118, v119
  v_max3_f32 v147, v147, v120, v121
  v_max3_f32 v147, v147, v122, v123
  v_max3_f32 v147, v147, v124, v125
  v_max3_f32 v147, v147, v126, v127
  s_add_u32 s36, s36, 4096
  s_cmp_lt_u32 s36, 65536
  s_cbranch_scc1 A_mx1
  s_add_u32 s28, s3, 1
  s_and_b32 s28, s28, 3
  s_lshl_b32 s28, s28, 10
  s_add_u32 s28, s28, 114688
  s_lshl_b32 s29, s3, 8
  s_add_u32 s29, s29, s28
  v_add_u32 v14, s29, v8
  ds_write_b32 v14, v144
  v_lshl_add_u32 v148, v3, 2, s28
  s_add_u32 s28, s3, 2
  s_and_b32 s28, s28, 3
  s_lshl_b32 s28, s28, 10
  s_add_u32 s28, s28, 114688
  s_lshl_b32 s29, s3, 8
  s_add_u32 s29, s29, s28
  v_add_u32 v14, s29, v8
  ds_write_b32 v14, v145
  v_lshl_add_u32 v149, v3, 2, s28
  s_add_u32 s28, s3, 3
  s_and_b32 s28, s28, 3
  s_lshl_b32 s28, s28, 10
  s_add_u32 s28, s28, 114688
  s_lshl_b32 s29, s3, 8
  s_add_u32 s29, s29, s28
  v_add_u32 v14, s29, v8
  ds_write_b32 v14, v146
  v_lshl_add_u32 v150, v3, 2, s28
  s_add_u32 s28, s3, 4
  s_and_b32 s28, s28, 3
  s_lshl_b32 s28, s28, 10
  s_add_u32 s28, s28, 114688
  s_lshl_b32 s29, s3, 8
  s_add_u32 s29, s29, s28
  v_add_u32 v14, s29, v8
  ds_write_b32 v14, v147
  v_lshl_add_u32 v151, v3, 2, s28
  s_waitcnt lgkmcnt(0)
  s_barrier
  ds_read_b32 v112, v148 offset:0
  ds_read_b32 v113, v148 offset:128
  ds_read_b32 v114, v148 offset:256
  ds_read_b32 v115, v148 offset:384
  ds_read_b32 v116, v148 offset:512
  ds_read_b32 v117, v148 offset:640
  ds_read_b32 v118, v148 offset:768
  ds_read_b32 v119, v148 offset:896
  s_waitcnt lgkmcnt(0)
  v_max3_f32 v112, v112, v113, v114
  v_max3_f32 v112, v112, v115, v116
  v_max3_f32 v112, v112, v117, v118
  v_max_f32 v112, v112, v119
  v_sub_f32 v112, 0, v112
  v_cvt_pk_bf16_f32 v113, v112, 0
  v_lshlrev_b32 v114, 16, v113
  v_sub_f32 v114, v112, v114
  v_cvt_pk_bf16_f32 v113, v112, v114
  v_and_b32 v115, 0xffff0000, v113
  v_sub_f32 v114, v114, v115
  v_cvt_pk_bf16_f32 v114, v114, 0
  v_cndmask_b32 v22, v22, v113, s[62:63]
  v_cndmask_b32 v23, v23, v114, s[62:63]
  ds_read_b32 v112, v149 offset:0
  ds_read_b32 v113, v149 offset:128
  ds_read_b32 v114, v149 offset:256
  ds_read_b32 v115, v149 offset:384
  ds_read_b32 v116, v149 offset:512
  ds_read_b32 v117, v149 offset:640
  ds_read_b32 v118, v149 offset:768
  ds_read_b32 v119, v149 offset:896
  s_waitcnt lgkmcnt(0)
  v_max3_f32 v112, v112, v113, v114
  v_max3_f32 v112, v112, v115, v116
  v_max3_f32 v112, v112, v117, v118
  v_max_f32 v112, v112, v119
  v_sub_f32 v112, 0, v112
  v_cvt_pk_bf16_f32 v113, v112, 0
  v_lshlrev_b32 v114, 16, v113
  v_sub_f32 v114, v112, v114
  v_cvt_pk_bf16_f32 v113, v112, v114
  v_and_b32 v115, 0xffff0000, v113
  v_sub_f32 v114, v114, v115
  v_cvt_pk_bf16_f32 v114, v114, 0
  v_cndmask_b32 v30, v30, v113, s[62:63]
  v_cndmask_b32 v31, v31, v114, s[62:63]
  ds_read_b32 v112, v150 offset:0
  ds_read_b32 v113, v150 offset:128
  ds_read_b32 v114, v150 offset:256
  ds_read_b32 v115, v150 offset:384
  ds_read_b32 v116, v150 offset:512
  ds_read_b32 v117, v150 offset:640
  ds_read_b32 v118, v150 offset:768
  ds_read_b32 v119, v150 offset:896
  s_waitcnt lgkmcnt(0)
  v_max3_f32 v112, v112, v113, v114
  v_max3_f32 v112, v112, v115, v116
  v_max3_f32 v112, v112, v117, v118
  v_max_f32 v112, v112, v119
  v_sub_f32 v112, 0, v112
  v_cvt_pk_bf16_f32 v113, v112, 0
  v_lshlrev_b32 v114, 16, v113
  v_sub_f32 v114, v112, v114
  v_cvt_pk_bf16_f32 v113, v112, v114
  v_and_b32 v115, 0xffff0000, v113
  v_sub_f32 v114, v114, v115
  v_cvt_pk_bf16_f32 v114, v114, 0
  v_cndmask_b32 v38, v38, v113, s[62:63]
  v_cndmask_b32 v39, v39, v114, s[62:63]
  ds_read_b32 v112, v151 offset:0
  ds_read_b32 v113, v151 offset:128
  ds_read_b32 v114, v151 offset:256
  ds_read_b32 v115, v151 offset:384
  ds_read_b32 v116, v151 offset:512
  ds_read_b32 v117, v151 offset:640
  ds_read_b32 v118, v151 offset:768
  ds_read_b32 v119, v151 offset:896
  s_waitcnt lgkmcnt(0)
  v_max3_f32 v112, v112, v113, v114
  v_max3_f32 v112, v112, v115, v116
  v_max3_f32 v112, v112, v117, v118
  v_max_f32 v112, v112, v119
  v_sub_f32 v112, 0, v112
  v_cvt_pk_bf16_f32 v113, v112, 0
  v_lshlrev_b32 v114, 16, v113
  v_sub_f32 v114, v112, v114
  v_cvt_pk_bf16_f32 v113, v112, v114
  v_and_b32 v115, 0xffff0000, v113
  v_sub_f32 v114, v114, v115
  v_cvt_pk_bf16_f32 v114, v114, 0
  v_cndmask_b32 v46, v46, v113, s[62:63]
  v_cndmask_b32 v47, v47, v114, s[62:63]
  s_barrier
  s_branch A_go1
S35:
  buffer_store_dwordx4 v[160:163], v9, s[16:19], s27 offen sc1
  buffer_store_dwordx4 v[164:167], v9, s[16:19], s27 offen offset:1024 sc1
  s_branch S35b
S36:
  buffer_store_dwordx2 v[6:7], v1, s[16:19], s38 offen sc1
  s_branch S36b
S39:
  buffer_store_dwordx4 v[96:99], v9, s[16:19], s38 offen offset:0 sc1
  buffer_store_dwordx4 v[100:103], v9, s[16:19], s38 offen offset:1024 sc1
  s_branch S39b
S40:
  buffer_store_dwordx2 v[24:25], v6, s[16:19], s38 offen sc1
  s_branch S40b
S41:
  buffer_store_dwordx2 v[10:11], v1, s[16:19], s38 offen sc1
  s_branch S41b
S44:
  buffer_store_dwordx2 v[14:15], v1, s[16:19], s38 offen sc1
  s_branch S44b
S45:
  buffer_store_dwordx2 v[10:11], v1, s[16:19], s38 offen sc1
  s_branch S45b
S46:
  buffer_store_dwordx2 v[10:11], v1, s[16:19], s38 offen sc1
  s_branch S46b
Da_pw1:
  s_add_u32 s38, s9, 21602304
  s_add_u32 s38, s38, s15
  v_mov_b32 v10, s14
  v_mov_b32 v11, 0
  v_mov_b32 v1, 0
  s_waitcnt vmcnt(0)
  s_mov_b64 exec, 1
  s_cmp_eq_u32 s61, 0
  s_cbranch_scc1 S46
  buffer_store_dwordx2 v[10:11], v1, s[16:19], s38 offen
S46b:
  s_mov_b64 exec, -1
  s_mov_b32 s39, 200000
W47:
  s_add_u32 s38, s15, 21594112
  buffer_load_dwordx2 v[6:7], v8, s[16:19], s38 offen sc1
  s_waitcnt vmcnt(0)
  v_cmp_ne_u32 vcc, s14, v6
  s_nop 1
  s_cmp_eq_u64 vcc, 0
  s_cbranch_scc1 Wd48
  s_sub_u32 s39, s39, 1
  s_cmp_lg_u32 s39, 0
  s_cbranch_scc1 W47
Wd48:
  buffer_load_dwordx4 v[80:83], v9, s[16:19], s30 offen offset:2048 sc1
  buffer_load_dwordx4 v[84:87], v9, s[16:19], s31 offen offset:2048 sc1
  buffer_load_dwordx4 v[88:91], v9, s[16:19], s30 offen offset:3072 sc1
  buffer_load_dwordx4 v[92:95], v9, s[16:19], s31 offen offset:3072 sc1
  s_add_u32 s30, s30, 5120
  s_add_u32 s31, s31, 5120
  buffer_load_dwordx4 v[96:99], v9, s[16:19], s30 offen offset:0 sc1
  buffer_load_dwordx4 v[100:103], v9, s[16:19], s31 offen offset:0 sc1
  buffer_load_dwordx4 v[104:107], v9, s[16:19], s30 offen offset:1024 sc1
  buffer_load_dwordx4 v[108:111], v9, s[16:19], s31 offen offset:1024 sc1
  s_add_u32 s30, s30, 4096
  s_add_u32 s31, s31, 4096
  buffer_load_dwordx4 v[112:115], v9, s[16:19], s30 offen offset:0 sc1
  buffer_load_dwordx4 v[116:119], v9, s[16:19], s31 offen offset:0 sc1
  s_waitcnt vmcnt(0)
  s_branch Da_pb1
D_skip1:
  s_waitcnt vmcnt(0)
  s_branch D_fin1
L_exit:
  s_endpgm
L_end:
.section .rodata,"a"
.p2align 6
.amdhsa_kernel interleave_layers__grouped_kv_mqa__glu_gated_glu__prompt_kernel
  .amdhsa_next_free_vgpr 512
  .amdhsa_next_free_sgpr 102
  .amdhsa_accum_offset 256
  .amdhsa_group_segment_fixed_size 0
  .amdhsa_kernarg_size 96
  .amdhsa_user_sgpr_count 2
  .amdhsa_user_sgpr_kernarg_segment_ptr 1
  .amdhsa_system_sgpr_workgroup_id_x 1
.end_amdhsa_kernel
```
